```python
import torch

def _softmax(x, axis=-1):
    return torch.softmax(x, dim=axis)

def _gelu(x):
    return torch.nn.functional.gelu(x, approximate='tanh')

def _silu(x):
    return torch.nn.functional.silu(x)

def _sigmoid(x):
    return torch.sigmoid(x)

def _layernorm(x, axis=-1, eps=1e-05):
    m = x.mean(dim=axis, keepdim=True)
    v = x.var(dim=axis, keepdim=True, unbiased=False)
    return (x - m) / torch.sqrt(v + eps)

def _scatter_add(tgt, idx, src, axis=0):
    return tgt.clone().index_add_(axis, idx, src)

def _segment_sum(src, seg, n):
    out = torch.zeros((n,) + src.shape[1:], dtype=src.dtype)
    return out.index_add_(0, seg, src)

def _pad(x, pw):
    flat = tuple((v for pair in reversed(pw) for v in pair))
    return torch.nn.functional.pad(x, flat)
kernel_name = 'adaLN_cond__grouped_kv_mqa__mixer_gmlp__prompt'

def setup_inputs():

    _w = lambda a: (lambda t: t.to(torch.bfloat16) if t.is_floating_point() else t)(torch.as_tensor(a))

    def _A_setup():
        B, S, D, H = (1, 2048, 640, 32)
        Dh = D // H
        return {'x': _w((lambda *s: torch.randn(*s, dtype=torch.bfloat16) * 0.05)(B, S, D)), 'wq': _w((lambda *s: torch.randn(*s, dtype=torch.bfloat16) * 0.05)(D, H * Dh)), 'wk': _w((lambda *s: torch.randn(*s, dtype=torch.bfloat16) * 0.05)(D, Dh)), 'wv': _w((lambda *s: torch.randn(*s, dtype=torch.bfloat16) * 0.05)(D, Dh)), 'wo': _w((lambda *s: torch.randn(*s, dtype=torch.bfloat16) * 0.05)(H * Dh, D))}
    _A_in = _A_setup()

    def _B_setup():
        B, S, D, F = (1, 2048, 640, 1536)
        Fh = F // 2
        return {'x': _w((lambda *s: torch.randn(*s, dtype=torch.bfloat16) * 0.05)(B, S, D)), 'w_in': _w((lambda *s: torch.randn(*s, dtype=torch.bfloat16) * 0.4)(D, 2 * Fh)), 'w_sp': _w(0.01 * (lambda *s: torch.randn(*s, dtype=torch.bfloat16) * 0.4)(S, S)), 'b_sp': _w(1.0 + 0.01 * (lambda *s: torch.randn(*s, dtype=torch.bfloat16) * 0.05)(S)), 'w_out': _w((lambda *s: torch.randn(*s, dtype=torch.bfloat16) * 0.05)(Fh, D))}
    _B_in = _B_setup()
    return {'A_x': _A_in['x'], 'A_wq': _A_in['wq'], 'A_wk': _A_in['wk'], 'A_wv': _A_in['wv'], 'A_wo': _A_in['wo'], 'B_x': _B_in['x'], 'B_w_in': _B_in['w_in'], 'B_w_sp': _B_in['w_sp'], 'B_b_sp': _B_in['b_sp'], 'B_w_out': _B_in['w_out'], 'c': _w((lambda *s: torch.randn(*s, dtype=torch.bfloat16) * 0.1)(1, 640) * 8.0), 'w_mod': _w((lambda *s: torch.randn(*s, dtype=torch.bfloat16) * 0.1)(640, 6 * 640) * 640 ** (-0.5) * 8.0)}

def reference(A_x, A_wq, A_wk, A_wv, A_wo, B_x, B_w_in, B_w_sp, B_b_sp, B_w_out, c, w_mod):

    def _A_ref(x, wq, wk, wv, wo):
        B, S, D = x.shape
        H = 32
        Dh = D // H
        q = (lambda x, *d: x.permute(*d))((x @ wq).reshape(B, S, H, Dh), 0, 2, 1, 3)
        k = x @ wk
        v = x @ wv
        scores = torch.einsum('bhqd,bkd->bhqk', q, k) * Dh ** (-0.5)
        p = _softmax(scores, axis=-1)
        o = torch.einsum('bhqk,bkd->bhqd', p, v)
        return (lambda x, *d: x.permute(*d))(o, 0, 2, 1, 3).reshape(B, S, H * Dh) @ wo

    def _B_ref(x, w_in, w_sp, b_sp, w_out):
        B, S, D = x.shape
        F = w_in.shape[-1]
        Fh = F // 2
        z = _gelu(torch.einsum('bsd,df->bsf', x, w_in))
        z1 = z[..., :Fh].clone()
        z2 = _layernorm(z[..., Fh:], axis=-1)
        g = torch.einsum('ts,bsf->btf', w_sp, z2) + b_sp[None, :, None]
        return torch.einsum('bsf,fd->bsd', z1 * g, w_out)
    x = A_x
    mod = (_silu(c) @ w_mod).reshape(c.shape[0], 6, 1, -1)
    sa, ca, ga, sb, cb, gb = (mod[:, 0].clone(), mod[:, 1].clone(), mod[:, 2].clone(), mod[:, 3].clone(), mod[:, 4].clone(), mod[:, 5].clone())
    h = _layernorm(x, axis=-1) * (1 + ca) + sa
    x = x + ga * _A_ref(h, A_wq, A_wk, A_wv, A_wo)
    h = _layernorm(x, axis=-1) * (1 + cb) + sb
    x = x + gb * _B_ref(h, B_w_in, B_w_sp, B_b_sp, B_w_out)
    return x
```

```asm
; @launch grid=(256,1,1) block=(512,1,1) lds=163840
.amdgcn_target "amdgcn-amd-amdhsa--gfx950"
.text
.globl adaLN_cond__grouped_kv_mqa__mixer_gmlp__prompt_kernel
.p2align 8
.type adaLN_cond__grouped_kv_mqa__mixer_gmlp__prompt_kernel,@function
adaLN_cond__grouped_kv_mqa__mixer_gmlp__prompt_kernel:
    s_cmp_ge_u32 s2, 256
    s_cbranch_scc1 k2_end
    s_load_dwordx2 s[8:9], s[0:1], 112
    s_load_dwordx8 s[40:47], s[0:1], 0
    s_load_dwordx4 s[48:51], s[0:1], 80
    s_load_dwordx2 s[52:53], s[0:1], 32
    v_lshrrev_b32 v1, 6, v0
    s_and_b32 s3, s2, 7
    v_readfirstlane_b32 s5, v1
    s_lshl_b32 s3, s3, 2
    s_bfe_u32 s4, s2, 0x20003
    s_add_u32 s3, s3, s4
    s_lshr_b32 s4, s2, 5
    v_and_b32 v1, 63, v0
    v_lshlrev_b32 v1, 4, v1
    s_lshr_b32 s33, s5, 2
    s_and_b32 s5, s5, 3
    s_lshl_b32 s6, s3, 2
    s_add_u32 s6, s6, s5
    s_lshl_b32 s22, s5, 2
    s_add_u32 s22, s22, 1024
    v_and_b32 v2, 48, v1
    v_add_u32 v2, s22, v2
    v_mov_b32 v3, 0
    ds_write_b32 v2, v3
    s_and_b32 s21, s2, 3
    s_lshr_b32 s20, s2, 2
    v_lshrrev_b32 v9, 3, v0
    v_and_b32 v16, 7, v0
    v_mul_u32_u24 v13, 7680, v9
    v_lshl_add_u32 v13, v16, 4, v13
    v_lshlrev_b32 v17, 1, v9
    s_mul_i32 s60, s21, 1228800
    s_lshl_b32 s23, s20, 7
    s_add_u32 s60, s60, s23
    s_cmp_lt_u32 s20, 60
    s_cselect_b32 s35, 0, 0x40000000
    s_add_u32 s60, s60, s35
    s_mul_i32 s61, s21, 320
    s_lshl_b32 s34, s2, 2
    s_add_u32 s34, s34, s5
    s_mul_i32 s37, s34, 3277
    s_lshr_b32 s37, s37, 16
    s_mul_i32 s38, s37, 20
    s_sub_u32 s38, s34, s38
    s_cmp_ge_u32 s37, 42
    s_cselect_b32 s23, 32, 0
    s_cselect_b32 s24, 4, 16
    s_lshl_b32 s25, s37, 5
    s_cmp_ge_u32 s37, 40
    s_cselect_b32 s23, s23, s25
    s_movk_i32 s22, 1280
    s_cselect_b32 s22, 40, s22
    s_mov_b32 s14, 819200
    s_cselect_b32 s14, 25600, s14
    s_cmp_lt_u32 s37, 44
    s_cselect_b32 s14, s14, 0
    s_cselect_b32 s39, 0, 0x40000000
    s_mov_b32 s15, 0x20000
    s_lshl_b32 s27, s22, 3
    s_lshl_b32 s25, s38, 5
    s_mul_i32 s25, s25, s22
    s_add_u32 s25, s25, s23
    v_and_b32 v6, 15, v0
    v_bfe_u32 v5, v0, 4, 2
    v_mul_u32_u24 v4, s27, v5
    v_lshl_add_u32 v4, v6, 1, v4
    v_cmp_gt_u32 vcc, s24, v6
    v_mov_b32 v5, 0x40000000
    s_mul_i32 s26, s37, 52
    s_lshr_b32 s26, s26, 8
    v_cndmask_b32 v4, v5, v4, vcc
    s_waitcnt lgkmcnt(0)
    s_barrier
    s_cmp_eq_u32 s33, 0
    s_cbranch_scc0 f_loader
    s_mov_b32 s16, s50
    s_mov_b32 s17, s51
    s_mov_b32 s18, 0x4b0000
    s_mov_b32 s19, 0x20000
    s_mov_b32 s64, s48
    s_mov_b32 s65, s49
    s_mov_b32 s66, 0x500
    s_mov_b32 s67, 0x20000
    s_cmp_ge_u32 s37, 40
    s_cselect_b32 s12, s44, s42
    s_cselect_b32 s13, s45, s43
    s_and_b32 s36, s37, 41
    s_cmp_eq_u32 s36, 41
    s_cselect_b32 s12, s46, s12
    s_cselect_b32 s13, s47, s13
    buffer_load_ushort v120, v4, s[12:15], s25 offen
    s_add_u32 s25, s25, s22
    buffer_load_ushort v121, v4, s[12:15], s25 offen
    s_add_u32 s25, s25, s22
    buffer_load_ushort v122, v4, s[12:15], s25 offen
    s_add_u32 s25, s25, s22
    buffer_load_ushort v123, v4, s[12:15], s25 offen
    s_add_u32 s25, s25, s22
    buffer_load_ushort v124, v4, s[12:15], s25 offen
    s_add_u32 s25, s25, s22
    buffer_load_ushort v125, v4, s[12:15], s25 offen
    s_add_u32 s25, s25, s22
    buffer_load_ushort v126, v4, s[12:15], s25 offen
    s_add_u32 s25, s25, s22
    buffer_load_ushort v127, v4, s[12:15], s25 offen
    buffer_load_dwordx4 v[20:23], v13, s[16:19], s60 offen
    s_add_u32 s60, s60, 245760
    buffer_load_ushort v8, v17, s[64:67], s61 offen offset:0
    buffer_load_dwordx4 v[24:27], v13, s[16:19], s60 offen
    s_add_u32 s60, s60, 245760
    buffer_load_ushort v9, v17, s[64:67], s61 offen offset:64
    buffer_load_dwordx4 v[28:31], v13, s[16:19], s60 offen
    s_add_u32 s60, s60, 245760
    buffer_load_ushort v10, v17, s[64:67], s61 offen offset:128
    buffer_load_dwordx4 v[32:35], v13, s[16:19], s60 offen
    s_add_u32 s60, s60, 245760
    buffer_load_ushort v11, v17, s[64:67], s61 offen offset:192
    buffer_load_dwordx4 v[36:39], v13, s[16:19], s60 offen
    buffer_load_ushort v12, v17, s[64:67], s61 offen offset:256
    s_mul_i32 s27, s26, 5
    s_sub_u32 s27, s37, s27
    s_sub_u32 s25, s37, 40
    s_cmp_ge_u32 s37, 40
    s_cselect_b32 s26, s25, s26
    s_cselect_b32 s27, 5, s27
    s_mul_i32 s26, s26, 20
    s_add_u32 s26, s26, s38
    s_mul_i32 s26, s26, 6
    s_add_u32 s26, s26, s27
    s_lshl_b32 s26, s26, 10
    s_add_u32 s26, s26, 688128
    s_add_u32 s26, s26, s39
    s_mov_b32 s28, s8
    s_mov_b32 s29, s9
    s_mov_b32 s30, 0x2300000
    s_mov_b32 s31, 0x20000
    s_mov_b32 s22, 11567104
    buffer_load_dword v14, off, s[28:31], s22 sc1
    v_and_b32 v3, 7, v0
    v_lshlrev_b32 v5, 3, v3
    v_bfe_u32 v6, v0, 5, 1
    v_lshl_add_u32 v5, v6, 2, v5
    v_bfe_u32 v6, v0, 4, 1
    v_lshl_add_u32 v5, v6, 1, v5
    v_bfe_u32 v6, v0, 3, 1
    v_add_u32 v5, v5, v6
    v_lshlrev_b32 v5, 2, v5
    s_lshl_b32 s22, s5, 8
    s_add_u32 s22, s22, 0
    v_add_u32 v5, s22, v5
    v_lshrrev_b32 v7, 2, v1
    s_mul_i32 s24, s21, 15360
    s_add_u32 s24, s24, 11272192
    s_add_u32 s24, s24, s35
    s_cmp_lt_u32 s20, 20
    s_cbranch_scc1 f_t1
    s_lshl_b32 s22, s20, 8
    v_add_u32 v19, s22, v7
    s_branch f_st
f_t1:
    s_cmp_lt_u32 s20, 10
    s_cselect_b32 s23, 2560, 0
    s_cselect_b32 s22, 0, 10
    s_sub_u32 s22, s20, s22
    s_lshl_b32 s22, s22, 7
    s_add_u32 s22, s22, s23
    v_bfe_u32 v19, v0, 2, 1
    v_mul_u32_u24 v19, 1280, v19
    v_bfe_u32 v18, v0, 3, 3
    v_lshl_add_u32 v19, v18, 4, v19
    v_and_b32 v18, 3, v0
    v_lshl_add_u32 v19, v18, 2, v19
    v_add_u32 v19, s22, v19
f_st:
    s_waitcnt vmcnt(11)
    v_lshl_or_b32 v120, v121, 16, v120
    v_lshl_or_b32 v121, v123, 16, v122
    v_lshl_or_b32 v122, v125, 16, v124
    v_lshl_or_b32 v123, v127, 16, v126
    buffer_store_dwordx4 v[120:123], v1, s[28:31], s26 offen sc1
    s_waitcnt vmcnt(2)
    v_lshlrev_b32 v8, 16, v8
    v_lshlrev_b32 v9, 16, v9
    v_lshlrev_b32 v10, 16, v10
    v_lshlrev_b32 v11, 16, v11
    v_lshlrev_b32 v12, 16, v12
    v_mul_f32 v60, 0xbfb8aa3b, v8
    v_mul_f32 v61, 0xbfb8aa3b, v9
    v_mul_f32 v62, 0xbfb8aa3b, v10
    v_mul_f32 v63, 0xbfb8aa3b, v11
    v_mul_f32 v64, 0xbfb8aa3b, v12
    v_exp_f32 v60, v60
    v_exp_f32 v61, v61
    v_exp_f32 v62, v62
    v_exp_f32 v63, v63
    v_exp_f32 v64, v64
    v_add_f32 v60, 1.0, v60
    v_add_f32 v61, 1.0, v61
    v_add_f32 v62, 1.0, v62
    v_add_f32 v63, 1.0, v63
    v_add_f32 v64, 1.0, v64
    v_rcp_f32 v60, v60
    v_rcp_f32 v61, v61
    v_rcp_f32 v62, v62
    v_rcp_f32 v63, v63
    v_rcp_f32 v64, v64
    v_mul_f32 v8, v8, v60
    v_mul_f32 v9, v9, v61
    v_mul_f32 v10, v10, v62
    v_mul_f32 v11, v11, v63
    v_mul_f32 v12, v12, v64
    v_cvt_pk_bf16_f32 v8, v8, v8
    v_cvt_pk_bf16_f32 v9, v9, v9
    v_cvt_pk_bf16_f32 v10, v10, v10
    v_cvt_pk_bf16_f32 v11, v11, v11
    v_cvt_pk_bf16_f32 v12, v12, v12
    v_and_b32 v8, 0xffff0000, v8
    v_and_b32 v9, 0xffff0000, v9
    v_and_b32 v10, 0xffff0000, v10
    v_and_b32 v11, 0xffff0000, v11
    v_and_b32 v12, 0xffff0000, v12
    v_lshlrev_b32 v60, 16, v20
    v_and_b32 v61, 0xffff0000, v20
    v_lshlrev_b32 v62, 16, v21
    v_and_b32 v63, 0xffff0000, v21
    v_lshlrev_b32 v64, 16, v22
    v_and_b32 v65, 0xffff0000, v22
    v_lshlrev_b32 v66, 16, v23
    v_and_b32 v67, 0xffff0000, v23
    v_pk_mul_f32 v[72:73], v[60:61], v[8:9] op_sel_hi:[1,0]
    v_pk_mul_f32 v[74:75], v[62:63], v[8:9] op_sel_hi:[1,0]
    v_pk_mul_f32 v[76:77], v[64:65], v[8:9] op_sel_hi:[1,0]
    v_pk_mul_f32 v[78:79], v[66:67], v[8:9] op_sel_hi:[1,0]
    v_lshlrev_b32 v60, 16, v24
    v_and_b32 v61, 0xffff0000, v24
    v_lshlrev_b32 v62, 16, v25
    v_and_b32 v63, 0xffff0000, v25
    v_lshlrev_b32 v64, 16, v26
    v_and_b32 v65, 0xffff0000, v26
    v_lshlrev_b32 v66, 16, v27
    v_and_b32 v67, 0xffff0000, v27
    v_pk_fma_f32 v[72:73], v[60:61], v[8:9], v[72:73] op_sel:[0,1,0] op_sel_hi:[1,1,1]
    v_pk_fma_f32 v[74:75], v[62:63], v[8:9], v[74:75] op_sel:[0,1,0] op_sel_hi:[1,1,1]
    v_pk_fma_f32 v[76:77], v[64:65], v[8:9], v[76:77] op_sel:[0,1,0] op_sel_hi:[1,1,1]
    v_pk_fma_f32 v[78:79], v[66:67], v[8:9], v[78:79] op_sel:[0,1,0] op_sel_hi:[1,1,1]
    v_lshlrev_b32 v60, 16, v28
    v_and_b32 v61, 0xffff0000, v28
    v_lshlrev_b32 v62, 16, v29
    v_and_b32 v63, 0xffff0000, v29
    v_lshlrev_b32 v64, 16, v30
    v_and_b32 v65, 0xffff0000, v30
    v_lshlrev_b32 v66, 16, v31
    v_and_b32 v67, 0xffff0000, v31
    v_pk_fma_f32 v[72:73], v[60:61], v[10:11], v[72:73] op_sel_hi:[1,0,1]
    v_pk_fma_f32 v[74:75], v[62:63], v[10:11], v[74:75] op_sel_hi:[1,0,1]
    v_pk_fma_f32 v[76:77], v[64:65], v[10:11], v[76:77] op_sel_hi:[1,0,1]
    v_pk_fma_f32 v[78:79], v[66:67], v[10:11], v[78:79] op_sel_hi:[1,0,1]
    v_lshlrev_b32 v60, 16, v32
    v_and_b32 v61, 0xffff0000, v32
    v_lshlrev_b32 v62, 16, v33
    v_and_b32 v63, 0xffff0000, v33
    v_lshlrev_b32 v64, 16, v34
    v_and_b32 v65, 0xffff0000, v34
    v_lshlrev_b32 v66, 16, v35
    v_and_b32 v67, 0xffff0000, v35
    v_pk_fma_f32 v[72:73], v[60:61], v[10:11], v[72:73] op_sel:[0,1,0] op_sel_hi:[1,1,1]
    v_pk_fma_f32 v[74:75], v[62:63], v[10:11], v[74:75] op_sel:[0,1,0] op_sel_hi:[1,1,1]
    v_pk_fma_f32 v[76:77], v[64:65], v[10:11], v[76:77] op_sel:[0,1,0] op_sel_hi:[1,1,1]
    v_pk_fma_f32 v[78:79], v[66:67], v[10:11], v[78:79] op_sel:[0,1,0] op_sel_hi:[1,1,1]
    v_lshlrev_b32 v60, 16, v36
    v_and_b32 v61, 0xffff0000, v36
    v_lshlrev_b32 v62, 16, v37
    v_and_b32 v63, 0xffff0000, v37
    v_lshlrev_b32 v64, 16, v38
    v_and_b32 v65, 0xffff0000, v38
    v_lshlrev_b32 v66, 16, v39
    v_and_b32 v67, 0xffff0000, v39
    v_pk_fma_f32 v[72:73], v[60:61], v[12:13], v[72:73] op_sel_hi:[1,0,1]
    v_pk_fma_f32 v[74:75], v[62:63], v[12:13], v[74:75] op_sel_hi:[1,0,1]
    v_pk_fma_f32 v[76:77], v[64:65], v[12:13], v[76:77] op_sel_hi:[1,0,1]
    v_pk_fma_f32 v[78:79], v[66:67], v[12:13], v[78:79] op_sel_hi:[1,0,1]
    s_nop 0
    v_permlane32_swap_b32 v72, v76
    v_permlane32_swap_b32 v73, v77
    v_permlane32_swap_b32 v74, v78
    v_permlane32_swap_b32 v75, v79
    v_add_f32 v72, v72, v76
    v_add_f32 v73, v73, v77
    v_add_f32 v74, v74, v78
    v_add_f32 v75, v75, v79
    s_nop 0
    v_permlane16_swap_b32 v72, v74
    v_permlane16_swap_b32 v73, v75
    v_add_f32 v72, v72, v74
    v_add_f32 v73, v73, v75
    s_nop 1
    v_add_f32_dpp v72, v72, v72 row_ror:8 row_mask:0xf bank_mask:0x3
    s_nop 1
    v_add_f32_dpp v72, v73, v73 row_ror:8 row_mask:0xf bank_mask:0xc
    ds_write_b32 v5, v72
    v_add_u32 v6, 0, v7
    s_lshl_b32 s22, s5, 2
    s_add_u32 s22, s22, 1024
    v_mov_b32 v15, s22
    v_mov_b32 v25, 1
    s_waitcnt lgkmcnt(0)
    ds_write_b32 v15, v25
    s_cmp_eq_u32 s5, 0
    s_cbranch_scc1 f_pub
    s_waitcnt vmcnt(0)
    ds_write_b32 v15, v25 offset:16
    s_branch f_nopub
f_pub:
    ds_write_b32 v15, v25 offset:16
    v_and_b32 v15, 12, v7
    v_add_u32 v15, 1024, v15
    s_mov_b32 s23, 0
f_join:
    ds_read_b32 v24, v15 offset:0
    s_add_u32 s23, s23, 1
    s_waitcnt lgkmcnt(0)
    v_cmp_eq_u32 vcc, 1, v24
    s_cmp_eq_u64 vcc, -1
    s_cbranch_scc1 f_join_ok
    s_cmp_lt_u32 s23, 0x400000
    s_cbranch_scc1 f_join
f_join_ok:
    ds_read_b32 v20, v6 offset:0
    ds_read_b32 v21, v6 offset:256
    ds_read_b32 v22, v6 offset:512
    ds_read_b32 v23, v6 offset:768
    s_waitcnt lgkmcnt(0)
    v_add_f32 v20, v20, v21
    v_add_f32 v22, v22, v23
    v_add_f32 v20, v20, v22
    buffer_store_dword v20, v19, s[28:31], s24 offen sc1
    s_lshl_b32 s22, s2, 5
    s_add_u32 s22, s22, 11534336
    v_and_b32 v15, 28, v7
    v_add_u32 v15, 1024, v15
    s_mov_b32 s23, 0
f_join2:
    ds_read_b32 v24, v15 offset:16
    s_add_u32 s23, s23, 1
    s_waitcnt lgkmcnt(0)
    v_cmp_eq_u32 vcc, 1, v24
    s_cmp_eq_u64 vcc, -1
    s_cbranch_scc1 f_join2_ok
    s_cmp_lt_u32 s23, 0x400000
    s_cbranch_scc1 f_join2
f_join2_ok:
    s_waitcnt vmcnt(0)
    v_readfirstlane_b32 s54, v14
    s_mul_i32 s54, s54, 0x9e3779b1
    s_add_u32 s54, s54, 0x7f4a7c15
    v_mov_b32 v14, s54
    s_mov_b64 exec, 1
    buffer_store_dword v14, off, s[28:31], s22 sc1
    s_mov_b64 exec, -1
    v_mov_b32 v20, 1072
    ds_write_b32 v20, v25
    v_lshrrev_b32 v20, 4, v1
    v_lshlrev_b32 v20, 5, v20
    s_mov_b32 s60, 11534336
    s_mov_b32 s61, 11536384
    s_mov_b32 s62, 11538432
    s_mov_b32 s63, 11540480
    s_sleep 40
    v_not_b32 v21, s54
    v_not_b32 v22, s54
    v_not_b32 v23, s54
    v_not_b32 v24, s54
    s_mov_b32 s38, 0
    s_mov_b64 s[70:71], 0
f_p0:
    v_cmp_ne_u32 vcc, s54, v21
    s_or_b64 s[70:71], s[70:71], vcc
    s_cmp_eq_u64 vcc, 0
    s_cbranch_scc1 f_p0_s0
    s_mov_b64 exec, vcc
    buffer_load_dword v21, v20, s[28:31], s60 offen sc1
    s_mov_b64 exec, -1
f_p0_s0:
    v_cmp_ne_u32 vcc, s54, v22
    s_or_b64 s[70:71], s[70:71], vcc
    s_cmp_eq_u64 vcc, 0
    s_cbranch_scc1 f_p0_s1
    s_mov_b64 exec, vcc
    buffer_load_dword v22, v20, s[28:31], s61 offen sc1
    s_mov_b64 exec, -1
f_p0_s1:
    v_cmp_ne_u32 vcc, s54, v23
    s_or_b64 s[70:71], s[70:71], vcc
    s_cmp_eq_u64 vcc, 0
    s_cbranch_scc1 f_p0_s2
    s_mov_b64 exec, vcc
    buffer_load_dword v23, v20, s[28:31], s62 offen sc1
    s_mov_b64 exec, -1
f_p0_s2:
    v_cmp_ne_u32 vcc, s54, v24
    s_or_b64 s[70:71], s[70:71], vcc
    s_cmp_eq_u64 vcc, 0
    s_cbranch_scc1 f_p0_s3
    s_mov_b64 exec, vcc
    buffer_load_dword v24, v20, s[28:31], s63 offen sc1
    s_mov_b64 exec, -1
f_p0_s3:
    s_cmp_eq_u64 s[70:71], 0
    s_cbranch_scc1 f_p0_ok
    s_mov_b64 s[70:71], 0
    s_add_u32 s38, s38, 1
    s_sleep 1
    s_waitcnt vmcnt(0)
    s_cmp_lt_u32 s38, 200000
    s_cbranch_scc1 f_p0
f_p0_ok:
f_nopub:
    v_bfe_u32 v3, v0, 4, 2
    v_and_b32 v5, 15, v0
    s_mul_i32 s37, s34, 3277
    s_lshr_b32 s37, s37, 16
    s_mul_i32 s38, s37, 20
    s_sub_u32 s38, s34, s38
    s_cmp_lt_u32 s34, 800
    s_cselect_b32 s39, 0, 0x40000000
    s_mul_i32 s22, s38, 40960
    s_lshl_b32 s23, s37, 5
    s_add_u32 s22, s22, s23
    s_add_u32 s22, s22, s39
    s_add_u32 s23, s22, 5120
    v_mul_u32_u24 v6, 10240, v3
    v_lshl_add_u32 v6, v5, 1, v6
    s_mov_b32 s12, s52
    s_mov_b32 s13, s53
    s_mov_b32 s14, 0xc8000
    s_mov_b32 s15, 0x20000
    buffer_load_ushort v120, v6, s[12:15], s22 offen offset:0
    buffer_load_ushort v121, v6, s[12:15], s22 offen offset:1280
    buffer_load_ushort v122, v6, s[12:15], s22 offen offset:2560
    buffer_load_ushort v123, v6, s[12:15], s22 offen offset:3840
    buffer_load_ushort v124, v6, s[12:15], s23 offen offset:0
    buffer_load_ushort v125, v6, s[12:15], s23 offen offset:1280
    buffer_load_ushort v126, v6, s[12:15], s23 offen offset:2560
    buffer_load_ushort v127, v6, s[12:15], s23 offen offset:3840
    s_mul_i32 s36, s37, 52
    s_lshr_b32 s36, s36, 8
    s_mul_i32 s22, s36, 5
    s_sub_u32 s22, s37, s22
    s_mul_i32 s36, s36, 20
    s_add_u32 s36, s36, s38
    s_mul_i32 s36, s36, 5
    s_add_u32 s36, s36, s22
    s_lshl_b32 s36, s36, 10
    s_add_u32 s36, s36, 1671168
    s_add_u32 s55, s36, s39
    s_and_b32 s36, s6, 1
    s_lshl_b32 s36, s36, 4
    v_add_u32 v6, s36, v5
    s_lshr_b32 s40, s5, 1
    s_mul_i32 s40, s40, 1280
    s_add_u32 s40, s40, 36864
    v_add_u32 v4, 0, v3
    v_mul_u32_u24 v2, 52, v4
    v_lshrrev_b32 v2, 8, v2
    v_mul_u32_u24 v8, 5, v2
    v_sub_u32 v4, v4, v8
    v_mul_u32_u24 v100, 2560, v2
    v_lshrrev_b32 v8, 1, v4
    v_lshl_add_u32 v100, v8, 9, v100
    v_and_b32 v8, 1, v4
    v_lshl_add_u32 v100, v8, 3, v100
    v_lshrrev_b32 v8, 2, v4
    v_sub_u32 v8, 4, v8
    v_lshlrev_b32 v8, v8, v6
    v_add3_u32 v100, v100, v8, s40
    v_add_u32 v4, 4, v3
    v_mul_u32_u24 v2, 52, v4
    v_lshrrev_b32 v2, 8, v2
    v_mul_u32_u24 v8, 5, v2
    v_sub_u32 v4, v4, v8
    v_mul_u32_u24 v101, 2560, v2
    v_lshrrev_b32 v8, 1, v4
    v_lshl_add_u32 v101, v8, 9, v101
    v_and_b32 v8, 1, v4
    v_lshl_add_u32 v101, v8, 3, v101
    v_lshrrev_b32 v8, 2, v4
    v_sub_u32 v8, 4, v8
    v_lshlrev_b32 v8, v8, v6
    v_add3_u32 v101, v101, v8, s40
    v_add_u32 v4, 8, v3
    v_mul_u32_u24 v2, 52, v4
    v_lshrrev_b32 v2, 8, v2
    v_mul_u32_u24 v8, 5, v2
    v_sub_u32 v4, v4, v8
    v_mul_u32_u24 v102, 2560, v2
    v_lshrrev_b32 v8, 1, v4
    v_lshl_add_u32 v102, v8, 9, v102
    v_and_b32 v8, 1, v4
    v_lshl_add_u32 v102, v8, 3, v102
    v_lshrrev_b32 v8, 2, v4
    v_sub_u32 v8, 4, v8
    v_lshlrev_b32 v8, v8, v6
    v_add3_u32 v102, v102, v8, s40
    v_add_u32 v4, 12, v3
    v_mul_u32_u24 v2, 52, v4
    v_lshrrev_b32 v2, 8, v2
    v_mul_u32_u24 v8, 5, v2
    v_sub_u32 v4, v4, v8
    v_mul_u32_u24 v103, 2560, v2
    v_lshrrev_b32 v8, 1, v4
    v_lshl_add_u32 v103, v8, 9, v103
    v_and_b32 v8, 1, v4
    v_lshl_add_u32 v103, v8, 3, v103
    v_lshrrev_b32 v8, 2, v4
    v_sub_u32 v8, 4, v8
    v_lshlrev_b32 v8, v8, v6
    v_add3_u32 v103, v103, v8, s40
    v_add_u32 v4, 16, v3
    v_mul_u32_u24 v2, 52, v4
    v_lshrrev_b32 v2, 8, v2
    v_mul_u32_u24 v8, 5, v2
    v_sub_u32 v4, v4, v8
    v_mul_u32_u24 v104, 2560, v2
    v_lshrrev_b32 v8, 1, v4
    v_lshl_add_u32 v104, v8, 9, v104
    v_and_b32 v8, 1, v4
    v_lshl_add_u32 v104, v8, 3, v104
    v_lshrrev_b32 v8, 2, v4
    v_sub_u32 v8, 4, v8
    v_lshlrev_b32 v8, v8, v6
    v_add3_u32 v104, v104, v8, s40
    v_add_u32 v8, 88320, v1
    s_add_u32 s16, s8, 0xa8000
    s_addc_u32 s17, s9, 0
    s_mov_b32 s18, 0xf0000
    s_mov_b32 s19, 0x20000
    s_mul_i32 s10, s4, 122880
    s_mul_i32 s11, s5, 30720
    s_add_u32 s10, s10, s11
    s_add_u32 s10, s10, 5120
    s_mul_i32 s11, s5, 5120
    s_add_u32 s11, s11, 88320
    v_mul_u32_u24 v14, 272, v3
    v_lshl_add_u32 v14, v5, 4, v14
    s_mul_i32 s36, s5, 1088
    s_add_u32 s36, s36, 0
    v_add_u32 v14, s36, v14
    v_add_u32 v15, 52992, v14
    s_barrier
    s_add_u32 m0, s11, 0
    s_nop 0
    buffer_load_dwordx4 v1, s[16:19], s10 offen sc1 lds
    s_add_u32 s10, s10, 6144
    s_add_u32 m0, s11, 1024
    s_nop 0
    buffer_load_dwordx4 v1, s[16:19], s10 offen sc1 lds
    s_add_u32 s10, s10, 6144
    s_add_u32 m0, s11, 2048
    s_nop 0
    buffer_load_dwordx4 v1, s[16:19], s10 offen sc1 lds
    s_add_u32 s10, s10, 6144
    s_add_u32 m0, s11, 3072
    s_nop 0
    buffer_load_dwordx4 v1, s[16:19], s10 offen sc1 lds
    s_add_u32 s10, s10, 6144
    s_add_u32 m0, s11, 4096
    s_nop 0
    buffer_load_dwordx4 v1, s[16:19], s10 offen sc1 lds
    s_add_u32 s10, s10, 6144
    s_sub_u32 s22, s34, 20
    s_cmp_lt_u32 s22, 10
    s_cselect_b32 s56, 1.0, 0
    s_cmp_lt_u32 s34, 40
    s_cselect_b32 s22, 0, 0x40000000
    s_lshl_b32 s57, s34, 8
    s_add_u32 s57, s57, 5120
    s_add_u32 s57, s57, s22
    s_add_u32 s22, s57, 11272192
    buffer_load_dword v108, v7, s[28:31], s22 offen sc1
    s_add_u32 s22, s22, 15360
    buffer_load_dword v109, v7, s[28:31], s22 offen sc1
    s_add_u32 s22, s22, 15360
    buffer_load_dword v110, v7, s[28:31], s22 offen sc1
    s_add_u32 s22, s22, 15360
    buffer_load_dword v111, v7, s[28:31], s22 offen sc1
    s_mul_i32 s10, s4, 122880
    s_mul_i32 s11, s5, 12288
    s_add_u32 s10, s10, s11
    s_mul_i32 s11, s5, 10240
    s_add_u32 s11, s11, 113920
    s_mov_b32 m0, s11
    s_add_u32 s37, s10, 4096
    buffer_load_dwordx4 v1, s[16:19], s10 offen offset:0 sc1 lds
    buffer_load_dwordx4 v1, s[16:19], s10 offen offset:1024 sc1 lds
    buffer_load_dwordx4 v1, s[16:19], s10 offen offset:2048 sc1 lds
    buffer_load_dwordx4 v1, s[16:19], s10 offen offset:3072 sc1 lds
    s_add_u32 m0, m0, 4096
    s_nop 0
    buffer_load_dwordx4 v1, s[16:19], s37 offen sc1 lds
    s_add_u32 s10, s10, 6144
    s_add_u32 s11, s11, 5120
    s_mov_b32 m0, s11
    s_add_u32 s37, s10, 4096
    buffer_load_dwordx4 v1, s[16:19], s10 offen offset:0 sc1 lds
    buffer_load_dwordx4 v1, s[16:19], s10 offen offset:1024 sc1 lds
    buffer_load_dwordx4 v1, s[16:19], s10 offen offset:2048 sc1 lds
    buffer_load_dwordx4 v1, s[16:19], s10 offen offset:3072 sc1 lds
    s_add_u32 m0, m0, 4096
    s_nop 0
    buffer_load_dwordx4 v1, s[16:19], s37 offen sc1 lds
    s_waitcnt vmcnt(14)
    s_barrier
    ds_read_b128 v[136:139], v8 offset:0
    ds_read_b128 v[140:143], v8 offset:1024
    ds_read_b128 v[144:147], v8 offset:2048
    ds_read_b128 v[148:151], v8 offset:3072
    s_barrier
    ds_read_b128 v[208:211], v14 offset:0
    ds_read_b128 v[212:215], v14 offset:4416
    ds_read_b128 v[216:219], v14 offset:8832
    ds_read_b128 v[220:223], v14 offset:13248
    ds_read_b128 v[152:155], v8 offset:4096
    ds_read_b128 v[156:159], v8 offset:5120
    ds_read_b128 v[160:163], v8 offset:6144
    ds_read_b128 v[164:167], v8 offset:7168
    s_waitcnt lgkmcnt(7)
    v_mfma_f32_16x16x32_bf16 v[36:39], v[136:139], v[208:211], 0
    v_mfma_f32_16x16x32_bf16 v[96:99], v[208:211], v[136:139], 0
    s_waitcnt lgkmcnt(6)
    v_mfma_f32_16x16x32_bf16 v[36:39], v[140:143], v[212:215], v[36:39]
    v_mfma_f32_16x16x32_bf16 v[96:99], v[212:215], v[140:143], v[96:99]
    s_waitcnt lgkmcnt(5)
    v_mfma_f32_16x16x32_bf16 v[36:39], v[144:147], v[216:219], v[36:39]
    v_mfma_f32_16x16x32_bf16 v[96:99], v[216:219], v[144:147], v[96:99]
    s_waitcnt lgkmcnt(4)
    v_mfma_f32_16x16x32_bf16 v[36:39], v[148:151], v[220:223], v[36:39]
    v_mfma_f32_16x16x32_bf16 v[96:99], v[220:223], v[148:151], v[96:99]
    s_barrier
    ds_read_b128 v[208:211], v14 offset:17664
    ds_read_b128 v[212:215], v14 offset:22080
    ds_read_b128 v[216:219], v14 offset:26496
    ds_read_b128 v[220:223], v14 offset:30912
    ds_read_b128 v[136:139], v8 offset:8192
    ds_read_b128 v[140:143], v8 offset:9216
    ds_read_b128 v[144:147], v8 offset:10240
    ds_read_b128 v[148:151], v8 offset:11264
    s_waitcnt lgkmcnt(7)
    v_mfma_f32_16x16x32_bf16 v[36:39], v[152:155], v[208:211], v[36:39]
    v_mfma_f32_16x16x32_bf16 v[96:99], v[208:211], v[152:155], v[96:99]
    s_waitcnt lgkmcnt(6)
    v_mfma_f32_16x16x32_bf16 v[36:39], v[156:159], v[212:215], v[36:39]
    v_mfma_f32_16x16x32_bf16 v[96:99], v[212:215], v[156:159], v[96:99]
    s_waitcnt lgkmcnt(5)
    v_mfma_f32_16x16x32_bf16 v[36:39], v[160:163], v[216:219], v[36:39]
    v_mfma_f32_16x16x32_bf16 v[96:99], v[216:219], v[160:163], v[96:99]
    s_waitcnt lgkmcnt(4)
    v_mfma_f32_16x16x32_bf16 v[36:39], v[164:167], v[220:223], v[36:39]
    v_mfma_f32_16x16x32_bf16 v[96:99], v[220:223], v[164:167], v[96:99]
    s_barrier
    ds_read_b128 v[208:211], v14 offset:35328
    ds_read_b128 v[212:215], v14 offset:39744
    ds_read_b128 v[216:219], v14 offset:44160
    ds_read_b128 v[220:223], v14 offset:48576
    ds_read_b128 v[152:155], v8 offset:12288
    ds_read_b128 v[156:159], v8 offset:13312
    ds_read_b128 v[160:163], v8 offset:14336
    ds_read_b128 v[164:167], v8 offset:15360
    s_waitcnt lgkmcnt(7)
    v_mfma_f32_16x16x32_bf16 v[36:39], v[136:139], v[208:211], v[36:39]
    v_mfma_f32_16x16x32_bf16 v[96:99], v[208:211], v[136:139], v[96:99]
    s_waitcnt lgkmcnt(6)
    v_mfma_f32_16x16x32_bf16 v[36:39], v[140:143], v[212:215], v[36:39]
    v_mfma_f32_16x16x32_bf16 v[96:99], v[212:215], v[140:143], v[96:99]
    s_waitcnt lgkmcnt(5)
    v_mfma_f32_16x16x32_bf16 v[36:39], v[144:147], v[216:219], v[36:39]
    v_mfma_f32_16x16x32_bf16 v[96:99], v[216:219], v[144:147], v[96:99]
    s_waitcnt lgkmcnt(4)
    v_mfma_f32_16x16x32_bf16 v[36:39], v[148:151], v[220:223], v[36:39]
    v_mfma_f32_16x16x32_bf16 v[96:99], v[220:223], v[148:151], v[96:99]
    s_barrier
    ds_read_b128 v[208:211], v15 offset:0
    ds_read_b128 v[212:215], v15 offset:4416
    ds_read_b128 v[216:219], v15 offset:8832
    ds_read_b128 v[220:223], v15 offset:13248
    ds_read_b128 v[136:139], v8 offset:16384
    ds_read_b128 v[140:143], v8 offset:17408
    ds_read_b128 v[144:147], v8 offset:18432
    ds_read_b128 v[148:151], v8 offset:19456
    s_waitcnt lgkmcnt(7)
    v_mfma_f32_16x16x32_bf16 v[36:39], v[152:155], v[208:211], v[36:39]
    v_mfma_f32_16x16x32_bf16 v[96:99], v[208:211], v[152:155], v[96:99]
    s_waitcnt lgkmcnt(6)
    v_mfma_f32_16x16x32_bf16 v[36:39], v[156:159], v[212:215], v[36:39]
    v_mfma_f32_16x16x32_bf16 v[96:99], v[212:215], v[156:159], v[96:99]
    s_waitcnt lgkmcnt(5)
    v_mfma_f32_16x16x32_bf16 v[36:39], v[160:163], v[216:219], v[36:39]
    v_mfma_f32_16x16x32_bf16 v[96:99], v[216:219], v[160:163], v[96:99]
    s_waitcnt lgkmcnt(4)
    v_mfma_f32_16x16x32_bf16 v[36:39], v[164:167], v[220:223], v[36:39]
    v_mfma_f32_16x16x32_bf16 v[96:99], v[220:223], v[164:167], v[96:99]
    s_waitcnt vmcnt(0)
    v_lshl_or_b32 v120, v121, 16, v120
    v_lshl_or_b32 v121, v123, 16, v122
    v_lshl_or_b32 v122, v125, 16, v124
    v_lshl_or_b32 v123, v127, 16, v126
    buffer_store_dwordx4 v[120:123], v1, s[28:31], s55 offen sc1
    s_barrier
    ds_read_b128 v[208:211], v15 offset:17664
    ds_read_b128 v[212:215], v15 offset:22080
    ds_read_b128 v[216:219], v15 offset:26496
    ds_read_b128 v[220:223], v15 offset:30912
    s_waitcnt lgkmcnt(3)
    v_mfma_f32_16x16x32_bf16 v[36:39], v[136:139], v[208:211], v[36:39]
    v_mfma_f32_16x16x32_bf16 v[96:99], v[208:211], v[136:139], v[96:99]
    s_waitcnt lgkmcnt(2)
    v_mfma_f32_16x16x32_bf16 v[36:39], v[140:143], v[212:215], v[36:39]
    v_mfma_f32_16x16x32_bf16 v[96:99], v[212:215], v[140:143], v[96:99]
    s_waitcnt lgkmcnt(1)
    v_mfma_f32_16x16x32_bf16 v[36:39], v[144:147], v[216:219], v[36:39]
    v_mfma_f32_16x16x32_bf16 v[96:99], v[216:219], v[144:147], v[96:99]
    s_waitcnt lgkmcnt(0)
    v_mfma_f32_16x16x32_bf16 v[36:39], v[148:151], v[220:223], v[36:39]
    v_mfma_f32_16x16x32_bf16 v[96:99], v[220:223], v[148:151], v[96:99]
    s_barrier
    v_add_f32 v108, v108, v109
    v_add_f32 v110, v110, v111
    v_add_f32 v108, v108, v110
    v_cvt_pk_bf16_f32 v108, v108, v108
    v_and_b32 v108, 0xffff0000, v108
    v_add_f32 v108, s56, v108
    v_cvt_pk_bf16_f32 v108, v108, v108
    v_and_b32 v108, 0xffff0000, v108
    s_cmp_ge_u32 s4, 4
    s_cbranch_scc1 k1_fin
    v_cvt_pk_bf16_f32 v52, v36, v37
    v_cvt_pk_bf16_f32 v53, v38, v39
    s_lshr_b32 s36, s6, 1
    s_mul_i32 s36, s36, 2560
    s_add_u32 s36, s36, 491520
    s_and_b32 s37, s6, 1
    v_mov_b32 v11, 0x40000000
    s_bitcmp1_b32 s4, 0
    s_cbranch_scc1 k1_V
    s_cmp_eq_u32 s4, 0
    s_cbranch_scc0 k1_K2
    v_lshrrev_b32 v10, 1, v3
    v_lshlrev_b32 v10, 9, v10
    v_lshl_add_u32 v10, v6, 4, v10
    v_and_b32 v12, 1, v3
    v_lshl_add_u32 v10, v12, 3, v10
    s_branch k1_Kst
k1_K2:
    v_cmp_eq_u32 vcc, 0, v3
    v_lshlrev_b32 v10, 3, v6
    v_add_u32 v10, 1024, v10
    v_cndmask_b32 v10, v11, v10, vcc
k1_Kst:
    buffer_store_dwordx2 v[52:53], v10, s[28:31], s36 offen sc1
    v_lshlrev_b32 v16, 16, v52
    v_and_b32 v17, 0xffff0000, v52
    v_lshlrev_b32 v18, 16, v53
    v_and_b32 v19, 0xffff0000, v53
    v_mul_f32 v16, v16, v16
    v_fmac_f32 v16, v17, v17
    v_fmac_f32 v16, v18, v18
    v_fmac_f32 v16, v19, v19
    v_mov_b32 v17, v16
    s_nop 1
    v_permlane16_swap_b32 v16, v17
    v_add_f32 v16, v16, v17
    v_mov_b32 v17, v16
    s_nop 1
    v_permlane32_swap_b32 v16, v17
    v_add_f32 v16, v16, v17
    s_nop 1
    v_max_f32_dpp v16, v16, v16 row_ror:1 row_mask:0xf bank_mask:0xf
    s_nop 1
    v_max_f32_dpp v16, v16, v16 row_ror:2 row_mask:0xf bank_mask:0xf
    s_nop 1
    v_max_f32_dpp v16, v16, v16 row_ror:4 row_mask:0xf bank_mask:0xf
    s_nop 1
    v_max_f32_dpp v16, v16, v16 row_ror:8 row_mask:0xf bank_mask:0xf
    s_lshl_b32 s36, s4, 8
    s_lshl_b32 s37, s6, 2
    s_add_u32 s36, s36, s37
    s_add_u32 s36, s36, 29696
    s_mov_b64 exec, 1
    buffer_store_dword v16, off, s[28:31], s36 sc1
    s_mov_b64 exec, -1
    s_branch k1_fin
k1_V:
    v_cvt_pk_bf16_f32 v52, v96, v97
    v_cvt_pk_bf16_f32 v53, v98, v99
    s_mul_i32 s37, s37, 640
    s_add_u32 s36, s36, s37
    s_add_u32 s36, s36, 1280
    s_cmp_eq_u32 s4, 3
    s_cselect_b32 s37, 256, 0
    s_cselect_b32 s38, 4, 16
    s_add_u32 s36, s36, s37
    v_and_b32 v9, 1, v3
    v_mul_u32_u24 v9, 320, v9
    v_lshl_add_u32 v9, v5, 4, v9
    v_cmp_gt_u32 vcc, s38, v5
    v_lshrrev_b32 v10, 1, v3
    v_lshl_add_u32 v9, v10, 3, v9
    v_cndmask_b32 v9, v11, v9, vcc
    buffer_store_dwordx2 v[52:53], v9, s[28:31], s36 offen sc1
k1_fin:
    buffer_store_dword v108, v7, s[28:31], s57 offen sc1
    s_lshl_b32 s36, s2, 7
    s_add_u32 s36, s36, 458752
    v_mov_b32 v10, 1
    v_add_u32 v11, 113920, v1
    ds_read_b128 v[208:211], v14 offset:0
    ds_read_b128 v[136:139], v11 offset:0
    ds_read_b128 v[140:143], v11 offset:1024
    ds_read_b128 v[144:147], v11 offset:2048
    ds_read_b128 v[148:151], v11 offset:3072
    ds_read_b128 v[152:155], v11 offset:4096
    ds_read_b128 v[212:215], v14 offset:4416
    ds_read_b128 v[156:159], v11 offset:5120
    ds_read_b128 v[160:163], v11 offset:6144
    ds_read_b128 v[164:167], v11 offset:7168
    ds_read_b128 v[168:171], v11 offset:8192
    ds_read_b128 v[172:175], v11 offset:9216
    s_waitcnt lgkmcnt(6)
    v_mfma_f32_16x16x32_bf16 v[16:19], v[136:139], v[208:211], 0
    ds_read_b128 v[216:219], v14 offset:8832
    ds_read_b128 v[176:179], v11 offset:10240
    v_mfma_f32_16x16x32_bf16 v[20:23], v[140:143], v[208:211], 0
    ds_read_b128 v[180:183], v11 offset:11264
    v_mfma_f32_16x16x32_bf16 v[24:27], v[144:147], v[208:211], 0
    ds_read_b128 v[184:187], v11 offset:12288
    v_mfma_f32_16x16x32_bf16 v[28:31], v[148:151], v[208:211], 0
    ds_read_b128 v[188:191], v11 offset:13312
    v_mfma_f32_16x16x32_bf16 v[32:35], v[152:155], v[208:211], 0
    ds_read_b128 v[192:195], v11 offset:14336
    s_waitcnt lgkmcnt(6)
    v_mfma_f32_16x16x32_bf16 v[16:19], v[156:159], v[212:215], v[16:19]
    ds_read_b128 v[208:211], v14 offset:13248
    ds_read_b128 v[136:139], v11 offset:15360
    v_mfma_f32_16x16x32_bf16 v[20:23], v[160:163], v[212:215], v[20:23]
    ds_read_b128 v[140:143], v11 offset:16384
    v_mfma_f32_16x16x32_bf16 v[24:27], v[164:167], v[212:215], v[24:27]
    ds_read_b128 v[144:147], v11 offset:17408
    v_mfma_f32_16x16x32_bf16 v[28:31], v[168:171], v[212:215], v[28:31]
    ds_read_b128 v[148:151], v11 offset:18432
    v_mfma_f32_16x16x32_bf16 v[32:35], v[172:175], v[212:215], v[32:35]
    ds_read_b128 v[152:155], v11 offset:19456
    s_waitcnt lgkmcnt(6)
    v_mfma_f32_16x16x32_bf16 v[16:19], v[176:179], v[216:219], v[16:19]
    ds_read_b128 v[212:215], v14 offset:17664
    ds_read_b128 v[156:159], v11 offset:20480
    v_mfma_f32_16x16x32_bf16 v[20:23], v[180:183], v[216:219], v[20:23]
    ds_read_b128 v[160:163], v11 offset:21504
    v_mfma_f32_16x16x32_bf16 v[24:27], v[184:187], v[216:219], v[24:27]
    ds_read_b128 v[164:167], v11 offset:22528
    v_mfma_f32_16x16x32_bf16 v[28:31], v[188:191], v[216:219], v[28:31]
    ds_read_b128 v[168:171], v11 offset:23552
    v_mfma_f32_16x16x32_bf16 v[32:35], v[192:195], v[216:219], v[32:35]
    ds_read_b128 v[172:175], v11 offset:24576
    s_waitcnt lgkmcnt(6)
    v_mfma_f32_16x16x32_bf16 v[16:19], v[136:139], v[208:211], v[16:19]
    ds_read_b128 v[216:219], v14 offset:22080
    ds_read_b128 v[176:179], v11 offset:25600
    v_mfma_f32_16x16x32_bf16 v[20:23], v[140:143], v[208:211], v[20:23]
    ds_read_b128 v[180:183], v11 offset:26624
    v_mfma_f32_16x16x32_bf16 v[24:27], v[144:147], v[208:211], v[24:27]
    ds_read_b128 v[184:187], v11 offset:27648
    v_mfma_f32_16x16x32_bf16 v[28:31], v[148:151], v[208:211], v[28:31]
    ds_read_b128 v[188:191], v11 offset:28672
    v_mfma_f32_16x16x32_bf16 v[32:35], v[152:155], v[208:211], v[32:35]
    ds_read_b128 v[192:195], v11 offset:29696
    s_waitcnt lgkmcnt(6)
    v_mfma_f32_16x16x32_bf16 v[16:19], v[156:159], v[212:215], v[16:19]
    ds_read_b128 v[208:211], v14 offset:26496
    ds_read_b128 v[136:139], v11 offset:30720
    v_mfma_f32_16x16x32_bf16 v[20:23], v[160:163], v[212:215], v[20:23]
    ds_read_b128 v[140:143], v11 offset:31744
    v_mfma_f32_16x16x32_bf16 v[24:27], v[164:167], v[212:215], v[24:27]
    ds_read_b128 v[144:147], v11 offset:32768
    v_mfma_f32_16x16x32_bf16 v[28:31], v[168:171], v[212:215], v[28:31]
    ds_read_b128 v[148:151], v11 offset:33792
    v_mfma_f32_16x16x32_bf16 v[32:35], v[172:175], v[212:215], v[32:35]
    ds_read_b128 v[152:155], v11 offset:34816
    s_waitcnt lgkmcnt(6)
    s_waitcnt vmcnt(0)
    s_barrier
    s_cmp_lg_u32 s5, 0
    s_cbranch_scc1 f_nof1
    s_mov_b64 exec, 1
    buffer_store_dword v10, off, s[28:31], s36 sc1
    s_mov_b64 exec, -1
f_nof1:
    v_mfma_f32_16x16x32_bf16 v[16:19], v[176:179], v[216:219], v[16:19]
    ds_read_b128 v[212:215], v14 offset:30912
    ds_read_b128 v[156:159], v11 offset:35840
    v_mfma_f32_16x16x32_bf16 v[20:23], v[180:183], v[216:219], v[20:23]
    ds_read_b128 v[160:163], v11 offset:36864
    v_mfma_f32_16x16x32_bf16 v[24:27], v[184:187], v[216:219], v[24:27]
    ds_read_b128 v[164:167], v11 offset:37888
    v_mfma_f32_16x16x32_bf16 v[28:31], v[188:191], v[216:219], v[28:31]
    ds_read_b128 v[168:171], v11 offset:38912
    v_mfma_f32_16x16x32_bf16 v[32:35], v[192:195], v[216:219], v[32:35]
    ds_read_b128 v[172:175], v11 offset:39936
    s_waitcnt lgkmcnt(6)
    s_barrier
    v_mfma_f32_16x16x32_bf16 v[16:19], v[136:139], v[208:211], v[16:19]
    ds_read_b128 v[216:219], v14 offset:35328
    ds_read_b128 v[176:179], v8 offset:0
    v_mfma_f32_16x16x32_bf16 v[20:23], v[140:143], v[208:211], v[20:23]
    ds_read_b128 v[180:183], v8 offset:1024
    v_mfma_f32_16x16x32_bf16 v[24:27], v[144:147], v[208:211], v[24:27]
    ds_read_b128 v[184:187], v8 offset:2048
    v_mfma_f32_16x16x32_bf16 v[28:31], v[148:151], v[208:211], v[28:31]
    ds_read_b128 v[188:191], v8 offset:3072
    v_mfma_f32_16x16x32_bf16 v[32:35], v[152:155], v[208:211], v[32:35]
    ds_read_b128 v[192:195], v8 offset:4096
    s_waitcnt lgkmcnt(6)
    v_mfma_f32_16x16x32_bf16 v[16:19], v[156:159], v[212:215], v[16:19]
    ds_read_b128 v[208:211], v14 offset:39744
    ds_read_b128 v[136:139], v8 offset:5120
    v_mfma_f32_16x16x32_bf16 v[20:23], v[160:163], v[212:215], v[20:23]
    ds_read_b128 v[140:143], v8 offset:6144
    v_mfma_f32_16x16x32_bf16 v[24:27], v[164:167], v[212:215], v[24:27]
    ds_read_b128 v[144:147], v8 offset:7168
    v_mfma_f32_16x16x32_bf16 v[28:31], v[168:171], v[212:215], v[28:31]
    ds_read_b128 v[148:151], v8 offset:8192
    v_mfma_f32_16x16x32_bf16 v[32:35], v[172:175], v[212:215], v[32:35]
    ds_read_b128 v[152:155], v8 offset:9216
    s_waitcnt lgkmcnt(6)
    v_mfma_f32_16x16x32_bf16 v[16:19], v[176:179], v[216:219], v[16:19]
    ds_read_b128 v[212:215], v14 offset:44160
    ds_read_b128 v[156:159], v8 offset:10240
    v_mfma_f32_16x16x32_bf16 v[20:23], v[180:183], v[216:219], v[20:23]
    ds_read_b128 v[160:163], v8 offset:11264
    v_mfma_f32_16x16x32_bf16 v[24:27], v[184:187], v[216:219], v[24:27]
    ds_read_b128 v[164:167], v8 offset:12288
    v_mfma_f32_16x16x32_bf16 v[28:31], v[188:191], v[216:219], v[28:31]
    ds_read_b128 v[168:171], v8 offset:13312
    v_mfma_f32_16x16x32_bf16 v[32:35], v[192:195], v[216:219], v[32:35]
    ds_read_b128 v[172:175], v8 offset:14336
    s_waitcnt lgkmcnt(6)
    v_mfma_f32_16x16x32_bf16 v[16:19], v[136:139], v[208:211], v[16:19]
    ds_read_b128 v[216:219], v14 offset:48576
    ds_read_b128 v[176:179], v8 offset:15360
    v_mfma_f32_16x16x32_bf16 v[20:23], v[140:143], v[208:211], v[20:23]
    ds_read_b128 v[180:183], v8 offset:16384
    v_mfma_f32_16x16x32_bf16 v[24:27], v[144:147], v[208:211], v[24:27]
    ds_read_b128 v[184:187], v8 offset:17408
    v_mfma_f32_16x16x32_bf16 v[28:31], v[148:151], v[208:211], v[28:31]
    ds_read_b128 v[188:191], v8 offset:18432
    v_mfma_f32_16x16x32_bf16 v[32:35], v[152:155], v[208:211], v[32:35]
    ds_read_b128 v[192:195], v8 offset:19456
    s_waitcnt lgkmcnt(6)
    v_mfma_f32_16x16x32_bf16 v[16:19], v[156:159], v[212:215], v[16:19]
    ds_read_b128 v[208:211], v15 offset:0
    ds_read_b128 v[136:139], v8 offset:20480
    v_mfma_f32_16x16x32_bf16 v[20:23], v[160:163], v[212:215], v[20:23]
    ds_read_b128 v[140:143], v8 offset:21504
    v_mfma_f32_16x16x32_bf16 v[24:27], v[164:167], v[212:215], v[24:27]
    ds_read_b128 v[144:147], v8 offset:22528
    v_mfma_f32_16x16x32_bf16 v[28:31], v[168:171], v[212:215], v[28:31]
    ds_read_b128 v[148:151], v8 offset:23552
    v_mfma_f32_16x16x32_bf16 v[32:35], v[172:175], v[212:215], v[32:35]
    ds_read_b128 v[152:155], v8 offset:24576
    s_waitcnt lgkmcnt(6)
    v_mfma_f32_16x16x32_bf16 v[16:19], v[176:179], v[216:219], v[16:19]
    ds_read_b128 v[212:215], v15 offset:4416
    ds_read_b128 v[156:159], v11 offset:40960
    v_mfma_f32_16x16x32_bf16 v[20:23], v[180:183], v[216:219], v[20:23]
    ds_read_b128 v[160:163], v11 offset:41984
    v_mfma_f32_16x16x32_bf16 v[24:27], v[184:187], v[216:219], v[24:27]
    ds_read_b128 v[164:167], v11 offset:43008
    v_mfma_f32_16x16x32_bf16 v[28:31], v[188:191], v[216:219], v[28:31]
    ds_read_b128 v[168:171], v11 offset:44032
    v_mfma_f32_16x16x32_bf16 v[32:35], v[192:195], v[216:219], v[32:35]
    ds_read_b128 v[172:175], v11 offset:45056
    s_waitcnt lgkmcnt(6)
    s_barrier
    v_mfma_f32_16x16x32_bf16 v[16:19], v[136:139], v[208:211], v[16:19]
    ds_read_b128 v[216:219], v15 offset:8832
    ds_read_b128 v[176:179], v11 offset:0
    v_mfma_f32_16x16x32_bf16 v[20:23], v[140:143], v[208:211], v[20:23]
    ds_read_b128 v[180:183], v11 offset:1024
    v_mfma_f32_16x16x32_bf16 v[24:27], v[144:147], v[208:211], v[24:27]
    ds_read_b128 v[184:187], v11 offset:2048
    v_mfma_f32_16x16x32_bf16 v[28:31], v[148:151], v[208:211], v[28:31]
    ds_read_b128 v[188:191], v11 offset:3072
    v_mfma_f32_16x16x32_bf16 v[32:35], v[152:155], v[208:211], v[32:35]
    ds_read_b128 v[192:195], v11 offset:4096
    s_waitcnt lgkmcnt(6)
    v_mfma_f32_16x16x32_bf16 v[16:19], v[156:159], v[212:215], v[16:19]
    ds_read_b128 v[208:211], v15 offset:13248
    ds_read_b128 v[136:139], v11 offset:5120
    v_mfma_f32_16x16x32_bf16 v[20:23], v[160:163], v[212:215], v[20:23]
    ds_read_b128 v[140:143], v11 offset:6144
    v_mfma_f32_16x16x32_bf16 v[24:27], v[164:167], v[212:215], v[24:27]
    ds_read_b128 v[144:147], v11 offset:7168
    v_mfma_f32_16x16x32_bf16 v[28:31], v[168:171], v[212:215], v[28:31]
    ds_read_b128 v[148:151], v11 offset:8192
    v_mfma_f32_16x16x32_bf16 v[32:35], v[172:175], v[212:215], v[32:35]
    ds_read_b128 v[152:155], v11 offset:9216
    s_waitcnt lgkmcnt(6)
    v_mfma_f32_16x16x32_bf16 v[16:19], v[176:179], v[216:219], v[16:19]
    ds_read_b128 v[212:215], v15 offset:17664
    ds_read_b128 v[156:159], v11 offset:10240
    v_mfma_f32_16x16x32_bf16 v[20:23], v[180:183], v[216:219], v[20:23]
    ds_read_b128 v[160:163], v11 offset:11264
    v_mfma_f32_16x16x32_bf16 v[24:27], v[184:187], v[216:219], v[24:27]
    ds_read_b128 v[164:167], v11 offset:12288
    v_mfma_f32_16x16x32_bf16 v[28:31], v[188:191], v[216:219], v[28:31]
    ds_read_b128 v[168:171], v11 offset:13312
    v_mfma_f32_16x16x32_bf16 v[32:35], v[192:195], v[216:219], v[32:35]
    ds_read_b128 v[172:175], v11 offset:14336
    s_waitcnt lgkmcnt(6)
    v_mfma_f32_16x16x32_bf16 v[16:19], v[136:139], v[208:211], v[16:19]
    ds_read_b128 v[216:219], v15 offset:22080
    ds_read_b128 v[176:179], v11 offset:15360
    v_mfma_f32_16x16x32_bf16 v[20:23], v[140:143], v[208:211], v[20:23]
    ds_read_b128 v[180:183], v11 offset:16384
    v_mfma_f32_16x16x32_bf16 v[24:27], v[144:147], v[208:211], v[24:27]
    ds_read_b128 v[184:187], v11 offset:17408
    v_mfma_f32_16x16x32_bf16 v[28:31], v[148:151], v[208:211], v[28:31]
    ds_read_b128 v[188:191], v11 offset:18432
    v_mfma_f32_16x16x32_bf16 v[32:35], v[152:155], v[208:211], v[32:35]
    ds_read_b128 v[192:195], v11 offset:19456
    s_waitcnt lgkmcnt(6)
    v_mfma_f32_16x16x32_bf16 v[16:19], v[156:159], v[212:215], v[16:19]
    ds_read_b128 v[208:211], v15 offset:26496
    ds_read_b128 v[136:139], v1 offset:0
    v_mfma_f32_16x16x32_bf16 v[20:23], v[160:163], v[212:215], v[20:23]
    ds_read_b128 v[140:143], v1 offset:1024
    v_mfma_f32_16x16x32_bf16 v[24:27], v[164:167], v[212:215], v[24:27]
    ds_read_b128 v[144:147], v1 offset:2048
    v_mfma_f32_16x16x32_bf16 v[28:31], v[168:171], v[212:215], v[28:31]
    ds_read_b128 v[148:151], v1 offset:3072
    v_mfma_f32_16x16x32_bf16 v[32:35], v[172:175], v[212:215], v[32:35]
    ds_read_b128 v[152:155], v1 offset:4096
    s_waitcnt lgkmcnt(6)
    v_mfma_f32_16x16x32_bf16 v[16:19], v[176:179], v[216:219], v[16:19]
    ds_read_b128 v[212:215], v15 offset:30912
    ds_read_b128 v[156:159], v1 offset:5120
    v_mfma_f32_16x16x32_bf16 v[20:23], v[180:183], v[216:219], v[20:23]
    ds_read_b128 v[160:163], v1 offset:6144
    v_mfma_f32_16x16x32_bf16 v[24:27], v[184:187], v[216:219], v[24:27]
    ds_read_b128 v[164:167], v1 offset:7168
    v_mfma_f32_16x16x32_bf16 v[28:31], v[188:191], v[216:219], v[28:31]
    ds_read_b128 v[168:171], v1 offset:8192
    v_mfma_f32_16x16x32_bf16 v[32:35], v[192:195], v[216:219], v[32:35]
    ds_read_b128 v[172:175], v1 offset:9216
    s_waitcnt lgkmcnt(6)
    v_mfma_f32_16x16x32_bf16 v[16:19], v[136:139], v[208:211], v[16:19]
    v_mfma_f32_16x16x32_bf16 v[20:23], v[140:143], v[208:211], v[20:23]
    v_mfma_f32_16x16x32_bf16 v[24:27], v[144:147], v[208:211], v[24:27]
    v_mfma_f32_16x16x32_bf16 v[28:31], v[148:151], v[208:211], v[28:31]
    v_mfma_f32_16x16x32_bf16 v[32:35], v[152:155], v[208:211], v[32:35]
    s_waitcnt lgkmcnt(0)
    v_mfma_f32_16x16x32_bf16 v[16:19], v[156:159], v[212:215], v[16:19]
    v_mfma_f32_16x16x32_bf16 v[20:23], v[160:163], v[212:215], v[20:23]
    v_mfma_f32_16x16x32_bf16 v[24:27], v[164:167], v[212:215], v[24:27]
    v_mfma_f32_16x16x32_bf16 v[28:31], v[168:171], v[212:215], v[28:31]
    v_mfma_f32_16x16x32_bf16 v[32:35], v[172:175], v[212:215], v[32:35]
    s_nop 5
    v_mov_b32 v8, 0x3ea52b5c
    v_pk_mul_f32 v[16:17], v[16:17], v[8:9] op_sel_hi:[1,0]
    v_pk_mul_f32 v[18:19], v[18:19], v[8:9] op_sel_hi:[1,0]
    v_cvt_pk_bf16_f32 v40, v16, v17
    v_cvt_pk_bf16_f32 v41, v18, v19
    ds_write_b64 v100, v[40:41]
    v_pk_mul_f32 v[20:21], v[20:21], v[8:9] op_sel_hi:[1,0]
    v_pk_mul_f32 v[22:23], v[22:23], v[8:9] op_sel_hi:[1,0]
    v_cvt_pk_bf16_f32 v42, v20, v21
    v_cvt_pk_bf16_f32 v43, v22, v23
    ds_write_b64 v101, v[42:43]
    v_pk_mul_f32 v[24:25], v[24:25], v[8:9] op_sel_hi:[1,0]
    v_pk_mul_f32 v[26:27], v[26:27], v[8:9] op_sel_hi:[1,0]
    v_cvt_pk_bf16_f32 v44, v24, v25
    v_cvt_pk_bf16_f32 v45, v26, v27
    ds_write_b64 v102, v[44:45]
    v_pk_mul_f32 v[28:29], v[28:29], v[8:9] op_sel_hi:[1,0]
    v_pk_mul_f32 v[30:31], v[30:31], v[8:9] op_sel_hi:[1,0]
    v_cvt_pk_bf16_f32 v46, v28, v29
    v_cvt_pk_bf16_f32 v47, v30, v31
    ds_write_b64 v103, v[46:47]
    v_pk_mul_f32 v[32:33], v[32:33], v[8:9] op_sel_hi:[1,0]
    v_pk_mul_f32 v[34:35], v[34:35], v[8:9] op_sel_hi:[1,0]
    v_cvt_pk_bf16_f32 v48, v32, v33
    v_cvt_pk_bf16_f32 v49, v34, v35
    ds_write_b64 v104, v[48:49]
    s_mov_b32 s31, s54
    s_waitcnt lgkmcnt(0)
    s_branch k1_done
f_loader:
    v_bfe_u32 v2, v0, 4, 2
    v_and_b32 v3, 15, v0
    v_mul_u32_u24 v4, 1280, v2
    v_lshl_add_u32 v4, v3, 4, v4
    s_mul_i32 s7, s6, 20480
    s_waitcnt lgkmcnt(0)
    s_mov_b32 s20, s40
    s_mov_b32 s21, s41
    s_mov_b32 s22, 0x280000
    s_mov_b32 s23, 0x20000
    s_mov_b32 s28, s8
    s_mov_b32 s29, s9
    s_mov_b32 s30, 0x2300000
    s_mov_b32 s31, 0x20000
    s_getreg_b32 s24, hwreg(HW_REG_XCC_ID, 0, 4)
    s_add_u32 s24, s24, 1
    v_mov_b32 v11, s24
    v_cmp_eq_u32 vcc, 0x100, v0
    v_mov_b32 v12, 0x40000000
    s_nop 0
    v_cndmask_b32 v12, v12, v3, vcc
    s_lshl_b32 s24, s2, 2
    s_add_u32 s24, s24, 11571200
    buffer_store_dword v11, v12, s[28:31], s24 offen sc1
    s_add_u32 s12, s8, 0x4000
    s_addc_u32 s13, s9, 0
    s_mov_b32 s14, 0x9c000
    s_mov_b32 s15, 0x20000
    s_lshl_b32 s24, s34, 10
    v_mov_b32 v16, 0
    v_mov_b32 v17, 0
    v_mov_b32 v18, 0
    v_mov_b32 v19, 0
    buffer_store_dwordx4 v[16:19], v1, s[12:15], s24 offen sc1
    buffer_load_dwordx4 v[176:179], v4, s[20:23], s7 offen offset:0
    buffer_load_dwordx4 v[180:183], v4, s[20:23], s7 offen offset:256
    buffer_load_dwordx4 v[184:187], v4, s[20:23], s7 offen offset:512
    buffer_load_dwordx4 v[188:191], v4, s[20:23], s7 offen offset:768
    buffer_load_dwordx4 v[192:195], v4, s[20:23], s7 offen offset:1024
    s_add_u32 s7, s7, 5120
    buffer_load_dwordx4 v[196:199], v4, s[20:23], s7 offen offset:0
    buffer_load_dwordx4 v[200:203], v4, s[20:23], s7 offen offset:256
    buffer_load_dwordx4 v[204:207], v4, s[20:23], s7 offen offset:512
    buffer_load_dwordx4 v[208:211], v4, s[20:23], s7 offen offset:768
    buffer_load_dwordx4 v[212:215], v4, s[20:23], s7 offen offset:1024
    s_add_u32 s7, s7, 5120
    s_getpc_b64 s[56:57]
f_pc:
    s_add_u32 s56, s56, adaLN_cond__grouped_kv_mqa__mixer_gmlp__prompt_kernel-f_pc
    s_addc_u32 s57, s57, -1
    s_mov_b32 s58, code_end-adaLN_cond__grouped_kv_mqa__mixer_gmlp__prompt_kernel
    s_mov_b32 s59, 0x20000
    s_lshr_b32 s24, s2, 3
    s_lshl_b32 s24, s24, 2
    s_add_u32 s24, s24, s5
    s_lshl_b32 s24, s24, 10
    buffer_load_dwordx4 v[236:239], v1, s[56:59], s24 offen
    v_mov_b32 v5, 0x3f803f80
    s_waitcnt vmcnt(6)
    s_lshl_b32 s24, s5, 2
    s_add_u32 s24, s24, 1056
    v_mov_b32 v12, s24
    v_mov_b32 v13, 1
    ds_write_b32 v12, v13
    v_dot2_f32_bf16 v6, v176, v5, 0
    v_dot2_f32_bf16 v8, v176, v176, 0
    v_dot2_f32_bf16 v7, v177, v5, 0
    v_dot2_f32_bf16 v9, v177, v177, 0
    v_dot2_f32_bf16 v6, v178, v5, v6
    v_dot2_f32_bf16 v8, v178, v178, v8
    v_dot2_f32_bf16 v7, v179, v5, v7
    v_dot2_f32_bf16 v9, v179, v179, v9
    v_dot2_f32_bf16 v6, v180, v5, v6
    v_dot2_f32_bf16 v8, v180, v180, v8
    v_dot2_f32_bf16 v7, v181, v5, v7
    v_dot2_f32_bf16 v9, v181, v181, v9
    v_dot2_f32_bf16 v6, v182, v5, v6
    v_dot2_f32_bf16 v8, v182, v182, v8
    v_dot2_f32_bf16 v7, v183, v5, v7
    v_dot2_f32_bf16 v9, v183, v183, v9
    v_dot2_f32_bf16 v6, v184, v5, v6
    v_dot2_f32_bf16 v8, v184, v184, v8
    v_dot2_f32_bf16 v7, v185, v5, v7
    v_dot2_f32_bf16 v9, v185, v185, v9
    v_dot2_f32_bf16 v6, v186, v5, v6
    v_dot2_f32_bf16 v8, v186, v186, v8
    v_dot2_f32_bf16 v7, v187, v5, v7
    v_dot2_f32_bf16 v9, v187, v187, v9
    v_dot2_f32_bf16 v6, v188, v5, v6
    v_dot2_f32_bf16 v8, v188, v188, v8
    v_dot2_f32_bf16 v7, v189, v5, v7
    v_dot2_f32_bf16 v9, v189, v189, v9
    v_dot2_f32_bf16 v6, v190, v5, v6
    v_dot2_f32_bf16 v8, v190, v190, v8
    v_dot2_f32_bf16 v7, v191, v5, v7
    v_dot2_f32_bf16 v9, v191, v191, v9
    v_dot2_f32_bf16 v6, v192, v5, v6
    v_dot2_f32_bf16 v8, v192, v192, v8
    v_dot2_f32_bf16 v7, v193, v5, v7
    v_dot2_f32_bf16 v9, v193, v193, v9
    v_dot2_f32_bf16 v6, v194, v5, v6
    v_dot2_f32_bf16 v8, v194, v194, v8
    v_dot2_f32_bf16 v7, v195, v5, v7
    v_dot2_f32_bf16 v9, v195, v195, v9
    v_lshlrev_b32 v16, 16, v176
    v_and_b32 v17, 0xffff0000, v176
    v_lshlrev_b32 v18, 16, v177
    v_and_b32 v19, 0xffff0000, v177
    v_lshlrev_b32 v20, 16, v178
    v_and_b32 v21, 0xffff0000, v178
    v_lshlrev_b32 v22, 16, v179
    v_and_b32 v23, 0xffff0000, v179
    v_add_f32 v6, v6, v7
    v_add_f32 v8, v8, v9
    v_lshlrev_b32 v24, 16, v180
    v_and_b32 v25, 0xffff0000, v180
    v_add_f32_dpp v6, v6, v6 row_ror:1 row_mask:0xf bank_mask:0xf
    v_add_f32_dpp v8, v8, v8 row_ror:1 row_mask:0xf bank_mask:0xf
    v_lshlrev_b32 v26, 16, v181
    v_and_b32 v27, 0xffff0000, v181
    v_lshlrev_b32 v28, 16, v182
    v_and_b32 v29, 0xffff0000, v182
    v_lshlrev_b32 v30, 16, v183
    v_and_b32 v31, 0xffff0000, v183
    v_lshlrev_b32 v32, 16, v184
    v_and_b32 v33, 0xffff0000, v184
    v_add_f32_dpp v6, v6, v6 row_ror:2 row_mask:0xf bank_mask:0xf
    v_add_f32_dpp v8, v8, v8 row_ror:2 row_mask:0xf bank_mask:0xf
    v_lshlrev_b32 v34, 16, v185
    v_and_b32 v35, 0xffff0000, v185
    v_lshlrev_b32 v36, 16, v186
    v_and_b32 v37, 0xffff0000, v186
    v_lshlrev_b32 v38, 16, v187
    v_and_b32 v39, 0xffff0000, v187
    v_lshlrev_b32 v40, 16, v188
    v_and_b32 v41, 0xffff0000, v188
    v_add_f32_dpp v6, v6, v6 row_ror:4 row_mask:0xf bank_mask:0xf
    v_add_f32_dpp v8, v8, v8 row_ror:4 row_mask:0xf bank_mask:0xf
    v_lshlrev_b32 v42, 16, v189
    v_and_b32 v43, 0xffff0000, v189
    v_lshlrev_b32 v44, 16, v190
    v_and_b32 v45, 0xffff0000, v190
    v_lshlrev_b32 v46, 16, v191
    v_and_b32 v47, 0xffff0000, v191
    v_lshlrev_b32 v48, 16, v192
    v_and_b32 v49, 0xffff0000, v192
    v_add_f32_dpp v6, v6, v6 row_ror:8 row_mask:0xf bank_mask:0xf
    v_add_f32_dpp v8, v8, v8 row_ror:8 row_mask:0xf bank_mask:0xf
    v_lshlrev_b32 v50, 16, v193
    v_and_b32 v51, 0xffff0000, v193
    v_lshlrev_b32 v52, 16, v194
    v_and_b32 v53, 0xffff0000, v194
    v_lshlrev_b32 v54, 16, v195
    v_and_b32 v55, 0xffff0000, v195
    v_mul_f32 v6, 0x3acccccd, v6
    v_mov_b32 v7, 0x3727c5ac
    v_fmac_f32 v7, 0x3acccccd, v8
    v_fma_f32 v7, -v6, v6, v7
    v_max_f32 v7, 0x3727c5ac, v7
    v_rsq_f32 v8, v7
    s_nop 0
    v_mul_f32 v9, v6, v8
    v_pk_fma_f32 v[16:17], v[16:17], v[8:9], v[8:9] op_sel:[0,0,1] op_sel_hi:[1,0,1] neg_lo:[0,0,1] neg_hi:[0,0,1]
    v_pk_fma_f32 v[18:19], v[18:19], v[8:9], v[8:9] op_sel:[0,0,1] op_sel_hi:[1,0,1] neg_lo:[0,0,1] neg_hi:[0,0,1]
    v_pk_fma_f32 v[20:21], v[20:21], v[8:9], v[8:9] op_sel:[0,0,1] op_sel_hi:[1,0,1] neg_lo:[0,0,1] neg_hi:[0,0,1]
    v_pk_fma_f32 v[22:23], v[22:23], v[8:9], v[8:9] op_sel:[0,0,1] op_sel_hi:[1,0,1] neg_lo:[0,0,1] neg_hi:[0,0,1]
    v_pk_fma_f32 v[24:25], v[24:25], v[8:9], v[8:9] op_sel:[0,0,1] op_sel_hi:[1,0,1] neg_lo:[0,0,1] neg_hi:[0,0,1]
    v_pk_fma_f32 v[26:27], v[26:27], v[8:9], v[8:9] op_sel:[0,0,1] op_sel_hi:[1,0,1] neg_lo:[0,0,1] neg_hi:[0,0,1]
    v_pk_fma_f32 v[28:29], v[28:29], v[8:9], v[8:9] op_sel:[0,0,1] op_sel_hi:[1,0,1] neg_lo:[0,0,1] neg_hi:[0,0,1]
    v_pk_fma_f32 v[30:31], v[30:31], v[8:9], v[8:9] op_sel:[0,0,1] op_sel_hi:[1,0,1] neg_lo:[0,0,1] neg_hi:[0,0,1]
    v_pk_fma_f32 v[32:33], v[32:33], v[8:9], v[8:9] op_sel:[0,0,1] op_sel_hi:[1,0,1] neg_lo:[0,0,1] neg_hi:[0,0,1]
    v_pk_fma_f32 v[34:35], v[34:35], v[8:9], v[8:9] op_sel:[0,0,1] op_sel_hi:[1,0,1] neg_lo:[0,0,1] neg_hi:[0,0,1]
    v_pk_fma_f32 v[36:37], v[36:37], v[8:9], v[8:9] op_sel:[0,0,1] op_sel_hi:[1,0,1] neg_lo:[0,0,1] neg_hi:[0,0,1]
    v_pk_fma_f32 v[38:39], v[38:39], v[8:9], v[8:9] op_sel:[0,0,1] op_sel_hi:[1,0,1] neg_lo:[0,0,1] neg_hi:[0,0,1]
    v_pk_fma_f32 v[40:41], v[40:41], v[8:9], v[8:9] op_sel:[0,0,1] op_sel_hi:[1,0,1] neg_lo:[0,0,1] neg_hi:[0,0,1]
    v_pk_fma_f32 v[42:43], v[42:43], v[8:9], v[8:9] op_sel:[0,0,1] op_sel_hi:[1,0,1] neg_lo:[0,0,1] neg_hi:[0,0,1]
    v_pk_fma_f32 v[44:45], v[44:45], v[8:9], v[8:9] op_sel:[0,0,1] op_sel_hi:[1,0,1] neg_lo:[0,0,1] neg_hi:[0,0,1]
    v_pk_fma_f32 v[46:47], v[46:47], v[8:9], v[8:9] op_sel:[0,0,1] op_sel_hi:[1,0,1] neg_lo:[0,0,1] neg_hi:[0,0,1]
    v_pk_fma_f32 v[48:49], v[48:49], v[8:9], v[8:9] op_sel:[0,0,1] op_sel_hi:[1,0,1] neg_lo:[0,0,1] neg_hi:[0,0,1]
    v_pk_fma_f32 v[50:51], v[50:51], v[8:9], v[8:9] op_sel:[0,0,1] op_sel_hi:[1,0,1] neg_lo:[0,0,1] neg_hi:[0,0,1]
    v_pk_fma_f32 v[52:53], v[52:53], v[8:9], v[8:9] op_sel:[0,0,1] op_sel_hi:[1,0,1] neg_lo:[0,0,1] neg_hi:[0,0,1]
    v_pk_fma_f32 v[54:55], v[54:55], v[8:9], v[8:9] op_sel:[0,0,1] op_sel_hi:[1,0,1] neg_lo:[0,0,1] neg_hi:[0,0,1]
    s_waitcnt vmcnt(0)
    v_dot2_f32_bf16 v6, v196, v5, 0
    v_dot2_f32_bf16 v8, v196, v196, 0
    v_dot2_f32_bf16 v7, v197, v5, 0
    v_dot2_f32_bf16 v9, v197, v197, 0
    v_dot2_f32_bf16 v6, v198, v5, v6
    v_dot2_f32_bf16 v8, v198, v198, v8
    v_dot2_f32_bf16 v7, v199, v5, v7
    v_dot2_f32_bf16 v9, v199, v199, v9
    v_dot2_f32_bf16 v6, v200, v5, v6
    v_dot2_f32_bf16 v8, v200, v200, v8
    v_dot2_f32_bf16 v7, v201, v5, v7
    v_dot2_f32_bf16 v9, v201, v201, v9
    v_dot2_f32_bf16 v6, v202, v5, v6
    v_dot2_f32_bf16 v8, v202, v202, v8
    v_dot2_f32_bf16 v7, v203, v5, v7
    v_dot2_f32_bf16 v9, v203, v203, v9
    v_dot2_f32_bf16 v6, v204, v5, v6
    v_dot2_f32_bf16 v8, v204, v204, v8
    v_dot2_f32_bf16 v7, v205, v5, v7
    v_dot2_f32_bf16 v9, v205, v205, v9
    v_dot2_f32_bf16 v6, v206, v5, v6
    v_dot2_f32_bf16 v8, v206, v206, v8
    v_dot2_f32_bf16 v7, v207, v5, v7
    v_dot2_f32_bf16 v9, v207, v207, v9
    v_dot2_f32_bf16 v6, v208, v5, v6
    v_dot2_f32_bf16 v8, v208, v208, v8
    v_dot2_f32_bf16 v7, v209, v5, v7
    v_dot2_f32_bf16 v9, v209, v209, v9
    v_dot2_f32_bf16 v6, v210, v5, v6
    v_dot2_f32_bf16 v8, v210, v210, v8
    v_dot2_f32_bf16 v7, v211, v5, v7
    v_dot2_f32_bf16 v9, v211, v211, v9
    v_dot2_f32_bf16 v6, v212, v5, v6
    v_dot2_f32_bf16 v8, v212, v212, v8
    v_dot2_f32_bf16 v7, v213, v5, v7
    v_dot2_f32_bf16 v9, v213, v213, v9
    v_dot2_f32_bf16 v6, v214, v5, v6
    v_dot2_f32_bf16 v8, v214, v214, v8
    v_dot2_f32_bf16 v7, v215, v5, v7
    v_dot2_f32_bf16 v9, v215, v215, v9
    v_lshlrev_b32 v56, 16, v196
    v_and_b32 v57, 0xffff0000, v196
    v_lshlrev_b32 v58, 16, v197
    v_and_b32 v59, 0xffff0000, v197
    v_lshlrev_b32 v60, 16, v198
    v_and_b32 v61, 0xffff0000, v198
    v_lshlrev_b32 v62, 16, v199
    v_and_b32 v63, 0xffff0000, v199
    v_add_f32 v6, v6, v7
    v_add_f32 v8, v8, v9
    v_lshlrev_b32 v64, 16, v200
    v_and_b32 v65, 0xffff0000, v200
    v_add_f32_dpp v6, v6, v6 row_ror:1 row_mask:0xf bank_mask:0xf
    v_add_f32_dpp v8, v8, v8 row_ror:1 row_mask:0xf bank_mask:0xf
    v_lshlrev_b32 v66, 16, v201
    v_and_b32 v67, 0xffff0000, v201
    v_lshlrev_b32 v68, 16, v202
    v_and_b32 v69, 0xffff0000, v202
    v_lshlrev_b32 v70, 16, v203
    v_and_b32 v71, 0xffff0000, v203
    v_lshlrev_b32 v72, 16, v204
    v_and_b32 v73, 0xffff0000, v204
    v_add_f32_dpp v6, v6, v6 row_ror:2 row_mask:0xf bank_mask:0xf
    v_add_f32_dpp v8, v8, v8 row_ror:2 row_mask:0xf bank_mask:0xf
    v_lshlrev_b32 v74, 16, v205
    v_and_b32 v75, 0xffff0000, v205
    v_lshlrev_b32 v76, 16, v206
    v_and_b32 v77, 0xffff0000, v206
    v_lshlrev_b32 v78, 16, v207
    v_and_b32 v79, 0xffff0000, v207
    v_lshlrev_b32 v80, 16, v208
    v_and_b32 v81, 0xffff0000, v208
    v_add_f32_dpp v6, v6, v6 row_ror:4 row_mask:0xf bank_mask:0xf
    v_add_f32_dpp v8, v8, v8 row_ror:4 row_mask:0xf bank_mask:0xf
    v_lshlrev_b32 v82, 16, v209
    v_and_b32 v83, 0xffff0000, v209
    v_lshlrev_b32 v84, 16, v210
    v_and_b32 v85, 0xffff0000, v210
    v_lshlrev_b32 v86, 16, v211
    v_and_b32 v87, 0xffff0000, v211
    v_lshlrev_b32 v88, 16, v212
    v_and_b32 v89, 0xffff0000, v212
    v_add_f32_dpp v6, v6, v6 row_ror:8 row_mask:0xf bank_mask:0xf
    v_add_f32_dpp v8, v8, v8 row_ror:8 row_mask:0xf bank_mask:0xf
    v_lshlrev_b32 v90, 16, v213
    v_and_b32 v91, 0xffff0000, v213
    v_lshlrev_b32 v92, 16, v214
    v_and_b32 v93, 0xffff0000, v214
    v_lshlrev_b32 v94, 16, v215
    v_and_b32 v95, 0xffff0000, v215
    v_mul_f32 v6, 0x3acccccd, v6
    v_mov_b32 v7, 0x3727c5ac
    v_fmac_f32 v7, 0x3acccccd, v8
    v_fma_f32 v7, -v6, v6, v7
    v_max_f32 v7, 0x3727c5ac, v7
    v_rsq_f32 v8, v7
    s_nop 0
    v_mul_f32 v9, v6, v8
    v_pk_fma_f32 v[56:57], v[56:57], v[8:9], v[8:9] op_sel:[0,0,1] op_sel_hi:[1,0,1] neg_lo:[0,0,1] neg_hi:[0,0,1]
    v_pk_fma_f32 v[58:59], v[58:59], v[8:9], v[8:9] op_sel:[0,0,1] op_sel_hi:[1,0,1] neg_lo:[0,0,1] neg_hi:[0,0,1]
    v_pk_fma_f32 v[60:61], v[60:61], v[8:9], v[8:9] op_sel:[0,0,1] op_sel_hi:[1,0,1] neg_lo:[0,0,1] neg_hi:[0,0,1]
    v_pk_fma_f32 v[62:63], v[62:63], v[8:9], v[8:9] op_sel:[0,0,1] op_sel_hi:[1,0,1] neg_lo:[0,0,1] neg_hi:[0,0,1]
    v_pk_fma_f32 v[64:65], v[64:65], v[8:9], v[8:9] op_sel:[0,0,1] op_sel_hi:[1,0,1] neg_lo:[0,0,1] neg_hi:[0,0,1]
    v_pk_fma_f32 v[66:67], v[66:67], v[8:9], v[8:9] op_sel:[0,0,1] op_sel_hi:[1,0,1] neg_lo:[0,0,1] neg_hi:[0,0,1]
    v_pk_fma_f32 v[68:69], v[68:69], v[8:9], v[8:9] op_sel:[0,0,1] op_sel_hi:[1,0,1] neg_lo:[0,0,1] neg_hi:[0,0,1]
    v_pk_fma_f32 v[70:71], v[70:71], v[8:9], v[8:9] op_sel:[0,0,1] op_sel_hi:[1,0,1] neg_lo:[0,0,1] neg_hi:[0,0,1]
    v_pk_fma_f32 v[72:73], v[72:73], v[8:9], v[8:9] op_sel:[0,0,1] op_sel_hi:[1,0,1] neg_lo:[0,0,1] neg_hi:[0,0,1]
    v_pk_fma_f32 v[74:75], v[74:75], v[8:9], v[8:9] op_sel:[0,0,1] op_sel_hi:[1,0,1] neg_lo:[0,0,1] neg_hi:[0,0,1]
    v_pk_fma_f32 v[76:77], v[76:77], v[8:9], v[8:9] op_sel:[0,0,1] op_sel_hi:[1,0,1] neg_lo:[0,0,1] neg_hi:[0,0,1]
    v_pk_fma_f32 v[78:79], v[78:79], v[8:9], v[8:9] op_sel:[0,0,1] op_sel_hi:[1,0,1] neg_lo:[0,0,1] neg_hi:[0,0,1]
    v_pk_fma_f32 v[80:81], v[80:81], v[8:9], v[8:9] op_sel:[0,0,1] op_sel_hi:[1,0,1] neg_lo:[0,0,1] neg_hi:[0,0,1]
    v_pk_fma_f32 v[82:83], v[82:83], v[8:9], v[8:9] op_sel:[0,0,1] op_sel_hi:[1,0,1] neg_lo:[0,0,1] neg_hi:[0,0,1]
    v_pk_fma_f32 v[84:85], v[84:85], v[8:9], v[8:9] op_sel:[0,0,1] op_sel_hi:[1,0,1] neg_lo:[0,0,1] neg_hi:[0,0,1]
    v_pk_fma_f32 v[86:87], v[86:87], v[8:9], v[8:9] op_sel:[0,0,1] op_sel_hi:[1,0,1] neg_lo:[0,0,1] neg_hi:[0,0,1]
    v_pk_fma_f32 v[88:89], v[88:89], v[8:9], v[8:9] op_sel:[0,0,1] op_sel_hi:[1,0,1] neg_lo:[0,0,1] neg_hi:[0,0,1]
    v_pk_fma_f32 v[90:91], v[90:91], v[8:9], v[8:9] op_sel:[0,0,1] op_sel_hi:[1,0,1] neg_lo:[0,0,1] neg_hi:[0,0,1]
    v_pk_fma_f32 v[92:93], v[92:93], v[8:9], v[8:9] op_sel:[0,0,1] op_sel_hi:[1,0,1] neg_lo:[0,0,1] neg_hi:[0,0,1]
    v_pk_fma_f32 v[94:95], v[94:95], v[8:9], v[8:9] op_sel:[0,0,1] op_sel_hi:[1,0,1] neg_lo:[0,0,1] neg_hi:[0,0,1]
    v_mov_b32 v12, 1072
    s_mov_b32 s24, 0
f_gate:
    ds_read_b32 v13, v12
    s_add_u32 s24, s24, 1
    s_waitcnt lgkmcnt(0)
    v_cmp_eq_u32 vcc, 1, v13
    s_cmp_eq_u64 vcc, -1
    s_cbranch_scc1 f_gate_ok
    s_sleep 1
    s_cmp_lt_u32 s24, 0x200000
    s_cbranch_scc1 f_gate
f_gate_ok:
    buffer_load_dwordx4 v[216:219], v4, s[20:23], s7 offen offset:0
    buffer_load_dwordx4 v[220:223], v4, s[20:23], s7 offen offset:256
    buffer_load_dwordx4 v[224:227], v4, s[20:23], s7 offen offset:512
    buffer_load_dwordx4 v[228:231], v4, s[20:23], s7 offen offset:768
    buffer_load_dwordx4 v[232:235], v4, s[20:23], s7 offen offset:1024
    s_add_u32 s7, s7, 5120
    buffer_load_dwordx4 v[176:179], v4, s[20:23], s7 offen offset:0
    buffer_load_dwordx4 v[180:183], v4, s[20:23], s7 offen offset:256
    buffer_load_dwordx4 v[184:187], v4, s[20:23], s7 offen offset:512
    buffer_load_dwordx4 v[188:191], v4, s[20:23], s7 offen offset:768
    buffer_load_dwordx4 v[192:195], v4, s[20:23], s7 offen offset:1024
    s_add_u32 s7, s7, 5120
    s_waitcnt vmcnt(5)
    v_dot2_f32_bf16 v6, v216, v5, 0
    v_dot2_f32_bf16 v8, v216, v216, 0
    v_dot2_f32_bf16 v7, v217, v5, 0
    v_dot2_f32_bf16 v9, v217, v217, 0
    v_dot2_f32_bf16 v6, v218, v5, v6
    v_dot2_f32_bf16 v8, v218, v218, v8
    v_dot2_f32_bf16 v7, v219, v5, v7
    v_dot2_f32_bf16 v9, v219, v219, v9
    v_dot2_f32_bf16 v6, v220, v5, v6
    v_dot2_f32_bf16 v8, v220, v220, v8
    v_dot2_f32_bf16 v7, v221, v5, v7
    v_dot2_f32_bf16 v9, v221, v221, v9
    v_dot2_f32_bf16 v6, v222, v5, v6
    v_dot2_f32_bf16 v8, v222, v222, v8
    v_dot2_f32_bf16 v7, v223, v5, v7
    v_dot2_f32_bf16 v9, v223, v223, v9
    v_dot2_f32_bf16 v6, v224, v5, v6
    v_dot2_f32_bf16 v8, v224, v224, v8
    v_dot2_f32_bf16 v7, v225, v5, v7
    v_dot2_f32_bf16 v9, v225, v225, v9
    v_dot2_f32_bf16 v6, v226, v5, v6
    v_dot2_f32_bf16 v8, v226, v226, v8
    v_dot2_f32_bf16 v7, v227, v5, v7
    v_dot2_f32_bf16 v9, v227, v227, v9
    v_dot2_f32_bf16 v6, v228, v5, v6
    v_dot2_f32_bf16 v8, v228, v228, v8
    v_dot2_f32_bf16 v7, v229, v5, v7
    v_dot2_f32_bf16 v9, v229, v229, v9
    v_dot2_f32_bf16 v6, v230, v5, v6
    v_dot2_f32_bf16 v8, v230, v230, v8
    v_dot2_f32_bf16 v7, v231, v5, v7
    v_dot2_f32_bf16 v9, v231, v231, v9
    v_dot2_f32_bf16 v6, v232, v5, v6
    v_dot2_f32_bf16 v8, v232, v232, v8
    v_dot2_f32_bf16 v7, v233, v5, v7
    v_dot2_f32_bf16 v9, v233, v233, v9
    v_dot2_f32_bf16 v6, v234, v5, v6
    v_dot2_f32_bf16 v8, v234, v234, v8
    v_dot2_f32_bf16 v7, v235, v5, v7
    v_dot2_f32_bf16 v9, v235, v235, v9
    v_lshlrev_b32 v96, 16, v216
    v_and_b32 v97, 0xffff0000, v216
    v_lshlrev_b32 v98, 16, v217
    v_and_b32 v99, 0xffff0000, v217
    v_lshlrev_b32 v100, 16, v218
    v_and_b32 v101, 0xffff0000, v218
    v_lshlrev_b32 v102, 16, v219
    v_and_b32 v103, 0xffff0000, v219
    v_add_f32 v6, v6, v7
    v_add_f32 v8, v8, v9
    v_lshlrev_b32 v104, 16, v220
    v_and_b32 v105, 0xffff0000, v220
    v_add_f32_dpp v6, v6, v6 row_ror:1 row_mask:0xf bank_mask:0xf
    v_add_f32_dpp v8, v8, v8 row_ror:1 row_mask:0xf bank_mask:0xf
    v_lshlrev_b32 v106, 16, v221
    v_and_b32 v107, 0xffff0000, v221
    v_lshlrev_b32 v108, 16, v222
    v_and_b32 v109, 0xffff0000, v222
    v_lshlrev_b32 v110, 16, v223
    v_and_b32 v111, 0xffff0000, v223
    v_lshlrev_b32 v112, 16, v224
    v_and_b32 v113, 0xffff0000, v224
    v_add_f32_dpp v6, v6, v6 row_ror:2 row_mask:0xf bank_mask:0xf
    v_add_f32_dpp v8, v8, v8 row_ror:2 row_mask:0xf bank_mask:0xf
    v_lshlrev_b32 v114, 16, v225
    v_and_b32 v115, 0xffff0000, v225
    v_lshlrev_b32 v116, 16, v226
    v_and_b32 v117, 0xffff0000, v226
    v_lshlrev_b32 v118, 16, v227
    v_and_b32 v119, 0xffff0000, v227
    v_lshlrev_b32 v120, 16, v228
    v_and_b32 v121, 0xffff0000, v228
    v_add_f32_dpp v6, v6, v6 row_ror:4 row_mask:0xf bank_mask:0xf
    v_add_f32_dpp v8, v8, v8 row_ror:4 row_mask:0xf bank_mask:0xf
    v_lshlrev_b32 v122, 16, v229
    v_and_b32 v123, 0xffff0000, v229
    v_lshlrev_b32 v124, 16, v230
    v_and_b32 v125, 0xffff0000, v230
    v_lshlrev_b32 v126, 16, v231
    v_and_b32 v127, 0xffff0000, v231
    v_lshlrev_b32 v128, 16, v232
    v_and_b32 v129, 0xffff0000, v232
    v_add_f32_dpp v6, v6, v6 row_ror:8 row_mask:0xf bank_mask:0xf
    v_add_f32_dpp v8, v8, v8 row_ror:8 row_mask:0xf bank_mask:0xf
    v_lshlrev_b32 v130, 16, v233
    v_and_b32 v131, 0xffff0000, v233
    v_lshlrev_b32 v132, 16, v234
    v_and_b32 v133, 0xffff0000, v234
    v_lshlrev_b32 v134, 16, v235
    v_and_b32 v135, 0xffff0000, v235
    v_mul_f32 v6, 0x3acccccd, v6
    v_mov_b32 v7, 0x3727c5ac
    v_fmac_f32 v7, 0x3acccccd, v8
    v_fma_f32 v7, -v6, v6, v7
    v_max_f32 v7, 0x3727c5ac, v7
    v_rsq_f32 v8, v7
    s_nop 0
    v_mul_f32 v9, v6, v8
    v_pk_fma_f32 v[96:97], v[96:97], v[8:9], v[8:9] op_sel:[0,0,1] op_sel_hi:[1,0,1] neg_lo:[0,0,1] neg_hi:[0,0,1]
    v_pk_fma_f32 v[98:99], v[98:99], v[8:9], v[8:9] op_sel:[0,0,1] op_sel_hi:[1,0,1] neg_lo:[0,0,1] neg_hi:[0,0,1]
    v_pk_fma_f32 v[100:101], v[100:101], v[8:9], v[8:9] op_sel:[0,0,1] op_sel_hi:[1,0,1] neg_lo:[0,0,1] neg_hi:[0,0,1]
    v_pk_fma_f32 v[102:103], v[102:103], v[8:9], v[8:9] op_sel:[0,0,1] op_sel_hi:[1,0,1] neg_lo:[0,0,1] neg_hi:[0,0,1]
    v_pk_fma_f32 v[104:105], v[104:105], v[8:9], v[8:9] op_sel:[0,0,1] op_sel_hi:[1,0,1] neg_lo:[0,0,1] neg_hi:[0,0,1]
    v_pk_fma_f32 v[106:107], v[106:107], v[8:9], v[8:9] op_sel:[0,0,1] op_sel_hi:[1,0,1] neg_lo:[0,0,1] neg_hi:[0,0,1]
    v_pk_fma_f32 v[108:109], v[108:109], v[8:9], v[8:9] op_sel:[0,0,1] op_sel_hi:[1,0,1] neg_lo:[0,0,1] neg_hi:[0,0,1]
    v_pk_fma_f32 v[110:111], v[110:111], v[8:9], v[8:9] op_sel:[0,0,1] op_sel_hi:[1,0,1] neg_lo:[0,0,1] neg_hi:[0,0,1]
    v_pk_fma_f32 v[112:113], v[112:113], v[8:9], v[8:9] op_sel:[0,0,1] op_sel_hi:[1,0,1] neg_lo:[0,0,1] neg_hi:[0,0,1]
    v_pk_fma_f32 v[114:115], v[114:115], v[8:9], v[8:9] op_sel:[0,0,1] op_sel_hi:[1,0,1] neg_lo:[0,0,1] neg_hi:[0,0,1]
    v_pk_fma_f32 v[116:117], v[116:117], v[8:9], v[8:9] op_sel:[0,0,1] op_sel_hi:[1,0,1] neg_lo:[0,0,1] neg_hi:[0,0,1]
    v_pk_fma_f32 v[118:119], v[118:119], v[8:9], v[8:9] op_sel:[0,0,1] op_sel_hi:[1,0,1] neg_lo:[0,0,1] neg_hi:[0,0,1]
    v_pk_fma_f32 v[120:121], v[120:121], v[8:9], v[8:9] op_sel:[0,0,1] op_sel_hi:[1,0,1] neg_lo:[0,0,1] neg_hi:[0,0,1]
    v_pk_fma_f32 v[122:123], v[122:123], v[8:9], v[8:9] op_sel:[0,0,1] op_sel_hi:[1,0,1] neg_lo:[0,0,1] neg_hi:[0,0,1]
    v_pk_fma_f32 v[124:125], v[124:125], v[8:9], v[8:9] op_sel:[0,0,1] op_sel_hi:[1,0,1] neg_lo:[0,0,1] neg_hi:[0,0,1]
    v_pk_fma_f32 v[126:127], v[126:127], v[8:9], v[8:9] op_sel:[0,0,1] op_sel_hi:[1,0,1] neg_lo:[0,0,1] neg_hi:[0,0,1]
    v_pk_fma_f32 v[128:129], v[128:129], v[8:9], v[8:9] op_sel:[0,0,1] op_sel_hi:[1,0,1] neg_lo:[0,0,1] neg_hi:[0,0,1]
    v_pk_fma_f32 v[130:131], v[130:131], v[8:9], v[8:9] op_sel:[0,0,1] op_sel_hi:[1,0,1] neg_lo:[0,0,1] neg_hi:[0,0,1]
    v_pk_fma_f32 v[132:133], v[132:133], v[8:9], v[8:9] op_sel:[0,0,1] op_sel_hi:[1,0,1] neg_lo:[0,0,1] neg_hi:[0,0,1]
    v_pk_fma_f32 v[134:135], v[134:135], v[8:9], v[8:9] op_sel:[0,0,1] op_sel_hi:[1,0,1] neg_lo:[0,0,1] neg_hi:[0,0,1]
    s_waitcnt vmcnt(0)
    v_dot2_f32_bf16 v6, v176, v5, 0
    v_dot2_f32_bf16 v8, v176, v176, 0
    v_dot2_f32_bf16 v7, v177, v5, 0
    v_dot2_f32_bf16 v9, v177, v177, 0
    v_dot2_f32_bf16 v6, v178, v5, v6
    v_dot2_f32_bf16 v8, v178, v178, v8
    v_dot2_f32_bf16 v7, v179, v5, v7
    v_dot2_f32_bf16 v9, v179, v179, v9
    v_dot2_f32_bf16 v6, v180, v5, v6
    v_dot2_f32_bf16 v8, v180, v180, v8
    v_dot2_f32_bf16 v7, v181, v5, v7
    v_dot2_f32_bf16 v9, v181, v181, v9
    v_dot2_f32_bf16 v6, v182, v5, v6
    v_dot2_f32_bf16 v8, v182, v182, v8
    v_dot2_f32_bf16 v7, v183, v5, v7
    v_dot2_f32_bf16 v9, v183, v183, v9
    v_dot2_f32_bf16 v6, v184, v5, v6
    v_dot2_f32_bf16 v8, v184, v184, v8
    v_dot2_f32_bf16 v7, v185, v5, v7
    v_dot2_f32_bf16 v9, v185, v185, v9
    v_dot2_f32_bf16 v6, v186, v5, v6
    v_dot2_f32_bf16 v8, v186, v186, v8
    v_dot2_f32_bf16 v7, v187, v5, v7
    v_dot2_f32_bf16 v9, v187, v187, v9
    v_dot2_f32_bf16 v6, v188, v5, v6
    v_dot2_f32_bf16 v8, v188, v188, v8
    v_dot2_f32_bf16 v7, v189, v5, v7
    v_dot2_f32_bf16 v9, v189, v189, v9
    v_dot2_f32_bf16 v6, v190, v5, v6
    v_dot2_f32_bf16 v8, v190, v190, v8
    v_dot2_f32_bf16 v7, v191, v5, v7
    v_dot2_f32_bf16 v9, v191, v191, v9
    v_dot2_f32_bf16 v6, v192, v5, v6
    v_dot2_f32_bf16 v8, v192, v192, v8
    v_dot2_f32_bf16 v7, v193, v5, v7
    v_dot2_f32_bf16 v9, v193, v193, v9
    v_dot2_f32_bf16 v6, v194, v5, v6
    v_dot2_f32_bf16 v8, v194, v194, v8
    v_dot2_f32_bf16 v7, v195, v5, v7
    v_dot2_f32_bf16 v9, v195, v195, v9
    v_lshlrev_b32 v136, 16, v176
    v_and_b32 v137, 0xffff0000, v176
    v_lshlrev_b32 v138, 16, v177
    v_and_b32 v139, 0xffff0000, v177
    v_lshlrev_b32 v140, 16, v178
    v_and_b32 v141, 0xffff0000, v178
    v_lshlrev_b32 v142, 16, v179
    v_and_b32 v143, 0xffff0000, v179
    v_add_f32 v6, v6, v7
    v_add_f32 v8, v8, v9
    v_lshlrev_b32 v144, 16, v180
    v_and_b32 v145, 0xffff0000, v180
    v_add_f32_dpp v6, v6, v6 row_ror:1 row_mask:0xf bank_mask:0xf
    v_add_f32_dpp v8, v8, v8 row_ror:1 row_mask:0xf bank_mask:0xf
    v_lshlrev_b32 v146, 16, v181
    v_and_b32 v147, 0xffff0000, v181
    v_lshlrev_b32 v148, 16, v182
    v_and_b32 v149, 0xffff0000, v182
    v_lshlrev_b32 v150, 16, v183
    v_and_b32 v151, 0xffff0000, v183
    v_lshlrev_b32 v152, 16, v184
    v_and_b32 v153, 0xffff0000, v184
    v_add_f32_dpp v6, v6, v6 row_ror:2 row_mask:0xf bank_mask:0xf
    v_add_f32_dpp v8, v8, v8 row_ror:2 row_mask:0xf bank_mask:0xf
    v_lshlrev_b32 v154, 16, v185
    v_and_b32 v155, 0xffff0000, v185
    v_lshlrev_b32 v156, 16, v186
    v_and_b32 v157, 0xffff0000, v186
    v_lshlrev_b32 v158, 16, v187
    v_and_b32 v159, 0xffff0000, v187
    v_lshlrev_b32 v160, 16, v188
    v_and_b32 v161, 0xffff0000, v188
    v_add_f32_dpp v6, v6, v6 row_ror:4 row_mask:0xf bank_mask:0xf
    v_add_f32_dpp v8, v8, v8 row_ror:4 row_mask:0xf bank_mask:0xf
    v_lshlrev_b32 v162, 16, v189
    v_and_b32 v163, 0xffff0000, v189
    v_lshlrev_b32 v164, 16, v190
    v_and_b32 v165, 0xffff0000, v190
    v_lshlrev_b32 v166, 16, v191
    v_and_b32 v167, 0xffff0000, v191
    v_lshlrev_b32 v168, 16, v192
    v_and_b32 v169, 0xffff0000, v192
    v_add_f32_dpp v6, v6, v6 row_ror:8 row_mask:0xf bank_mask:0xf
    v_add_f32_dpp v8, v8, v8 row_ror:8 row_mask:0xf bank_mask:0xf
    v_lshlrev_b32 v170, 16, v193
    v_and_b32 v171, 0xffff0000, v193
    v_lshlrev_b32 v172, 16, v194
    v_and_b32 v173, 0xffff0000, v194
    v_lshlrev_b32 v174, 16, v195
    v_and_b32 v175, 0xffff0000, v195
    v_mul_f32 v6, 0x3acccccd, v6
    v_mov_b32 v7, 0x3727c5ac
    v_fmac_f32 v7, 0x3acccccd, v8
    v_fma_f32 v7, -v6, v6, v7
    v_max_f32 v7, 0x3727c5ac, v7
    v_rsq_f32 v8, v7
    s_nop 0
    v_mul_f32 v9, v6, v8
    v_pk_fma_f32 v[136:137], v[136:137], v[8:9], v[8:9] op_sel:[0,0,1] op_sel_hi:[1,0,1] neg_lo:[0,0,1] neg_hi:[0,0,1]
    v_pk_fma_f32 v[138:139], v[138:139], v[8:9], v[8:9] op_sel:[0,0,1] op_sel_hi:[1,0,1] neg_lo:[0,0,1] neg_hi:[0,0,1]
    v_pk_fma_f32 v[140:141], v[140:141], v[8:9], v[8:9] op_sel:[0,0,1] op_sel_hi:[1,0,1] neg_lo:[0,0,1] neg_hi:[0,0,1]
    v_pk_fma_f32 v[142:143], v[142:143], v[8:9], v[8:9] op_sel:[0,0,1] op_sel_hi:[1,0,1] neg_lo:[0,0,1] neg_hi:[0,0,1]
    v_pk_fma_f32 v[144:145], v[144:145], v[8:9], v[8:9] op_sel:[0,0,1] op_sel_hi:[1,0,1] neg_lo:[0,0,1] neg_hi:[0,0,1]
    v_pk_fma_f32 v[146:147], v[146:147], v[8:9], v[8:9] op_sel:[0,0,1] op_sel_hi:[1,0,1] neg_lo:[0,0,1] neg_hi:[0,0,1]
    v_pk_fma_f32 v[148:149], v[148:149], v[8:9], v[8:9] op_sel:[0,0,1] op_sel_hi:[1,0,1] neg_lo:[0,0,1] neg_hi:[0,0,1]
    v_pk_fma_f32 v[150:151], v[150:151], v[8:9], v[8:9] op_sel:[0,0,1] op_sel_hi:[1,0,1] neg_lo:[0,0,1] neg_hi:[0,0,1]
    v_pk_fma_f32 v[152:153], v[152:153], v[8:9], v[8:9] op_sel:[0,0,1] op_sel_hi:[1,0,1] neg_lo:[0,0,1] neg_hi:[0,0,1]
    v_pk_fma_f32 v[154:155], v[154:155], v[8:9], v[8:9] op_sel:[0,0,1] op_sel_hi:[1,0,1] neg_lo:[0,0,1] neg_hi:[0,0,1]
    v_pk_fma_f32 v[156:157], v[156:157], v[8:9], v[8:9] op_sel:[0,0,1] op_sel_hi:[1,0,1] neg_lo:[0,0,1] neg_hi:[0,0,1]
    v_pk_fma_f32 v[158:159], v[158:159], v[8:9], v[8:9] op_sel:[0,0,1] op_sel_hi:[1,0,1] neg_lo:[0,0,1] neg_hi:[0,0,1]
    v_pk_fma_f32 v[160:161], v[160:161], v[8:9], v[8:9] op_sel:[0,0,1] op_sel_hi:[1,0,1] neg_lo:[0,0,1] neg_hi:[0,0,1]
    v_pk_fma_f32 v[162:163], v[162:163], v[8:9], v[8:9] op_sel:[0,0,1] op_sel_hi:[1,0,1] neg_lo:[0,0,1] neg_hi:[0,0,1]
    v_pk_fma_f32 v[164:165], v[164:165], v[8:9], v[8:9] op_sel:[0,0,1] op_sel_hi:[1,0,1] neg_lo:[0,0,1] neg_hi:[0,0,1]
    v_pk_fma_f32 v[166:167], v[166:167], v[8:9], v[8:9] op_sel:[0,0,1] op_sel_hi:[1,0,1] neg_lo:[0,0,1] neg_hi:[0,0,1]
    v_pk_fma_f32 v[168:169], v[168:169], v[8:9], v[8:9] op_sel:[0,0,1] op_sel_hi:[1,0,1] neg_lo:[0,0,1] neg_hi:[0,0,1]
    v_pk_fma_f32 v[170:171], v[170:171], v[8:9], v[8:9] op_sel:[0,0,1] op_sel_hi:[1,0,1] neg_lo:[0,0,1] neg_hi:[0,0,1]
    v_pk_fma_f32 v[172:173], v[172:173], v[8:9], v[8:9] op_sel:[0,0,1] op_sel_hi:[1,0,1] neg_lo:[0,0,1] neg_hi:[0,0,1]
    v_pk_fma_f32 v[174:175], v[174:175], v[8:9], v[8:9] op_sel:[0,0,1] op_sel_hi:[1,0,1] neg_lo:[0,0,1] neg_hi:[0,0,1]
    v_lshrrev_b32 v6, 2, v3
    v_mul_u32_u24 v6, 4416, v6
    v_and_b32 v7, 3, v3
    v_mul_u32_u24 v7, 272, v7
    v_lshl_add_u32 v7, v2, 4, v7
    s_mul_i32 s36, s5, 1088
    s_add_u32 s36, s36, 0
    v_add3_u32 v6, v6, v7, s36
    v_lshlrev_b32 v10, 4, v3
    v_add_u32 v10, 108800, v10
    s_mul_i32 s34, s5, 1280
    s_add_u32 s35, s34, 108800
    v_add_u32 v11, s35, v1
    v_lshrrev_b32 v5, 2, v1
    v_add_u32 v12, s35, v5
    s_add_u32 s34, s34, 11272192
    s_cmp_lt_u32 s5, 2
    s_cselect_b32 s36, 1.0, 0
    s_add_u32 s16, s8, 0xa8000
    s_addc_u32 s17, s9, 0
    s_mov_b32 s18, 0xf0000
    s_mov_b32 s19, 0x20000
    v_add_u32 v7, 0x10000, v6
    s_mul_i32 s10, s4, 122880
    s_setprio 3
    s_barrier
    buffer_load_dwordx4 v[176:179], v1, s[28:31], s34 offen sc1
    buffer_load_dword v192, v5, s[28:31], s34 offen offset:1024 sc1
    s_add_u32 s34, s34, 15360
    buffer_load_dwordx4 v[180:183], v1, s[28:31], s34 offen sc1
    buffer_load_dword v193, v5, s[28:31], s34 offen offset:1024 sc1
    s_add_u32 s34, s34, 15360
    buffer_load_dwordx4 v[184:187], v1, s[28:31], s34 offen sc1
    buffer_load_dword v194, v5, s[28:31], s34 offen offset:1024 sc1
    s_add_u32 s34, s34, 15360
    buffer_load_dwordx4 v[188:191], v1, s[28:31], s34 offen sc1
    buffer_load_dword v195, v5, s[28:31], s34 offen offset:1024 sc1
    s_waitcnt vmcnt(0)
    v_pk_add_f32 v[176:177], v[176:177], v[180:181]
    v_pk_add_f32 v[184:185], v[184:185], v[188:189]
    v_pk_add_f32 v[178:179], v[178:179], v[182:183]
    v_pk_add_f32 v[186:187], v[186:187], v[190:191]
    v_add_f32 v192, v192, v193
    v_add_f32 v194, v194, v195
    v_pk_add_f32 v[176:177], v[176:177], v[184:185]
    v_pk_add_f32 v[178:179], v[178:179], v[186:187]
    v_add_f32 v180, v192, v194
    v_cvt_pk_bf16_f32 v176, v176, v176
    v_cvt_pk_bf16_f32 v177, v177, v177
    v_cvt_pk_bf16_f32 v178, v178, v178
    v_cvt_pk_bf16_f32 v179, v179, v179
    v_cvt_pk_bf16_f32 v180, v180, v180
    v_and_b32 v176, 0xffff0000, v176
    v_and_b32 v177, 0xffff0000, v177
    v_and_b32 v178, 0xffff0000, v178
    v_and_b32 v179, 0xffff0000, v179
    v_and_b32 v180, 0xffff0000, v180
    v_add_f32 v176, s36, v176
    v_add_f32 v177, s36, v177
    v_add_f32 v178, s36, v178
    v_add_f32 v179, s36, v179
    v_add_f32 v180, s36, v180
    v_cvt_pk_bf16_f32 v176, v176, v176
    v_cvt_pk_bf16_f32 v177, v177, v177
    v_cvt_pk_bf16_f32 v178, v178, v178
    v_cvt_pk_bf16_f32 v179, v179, v179
    v_cvt_pk_bf16_f32 v180, v180, v180
    v_and_b32 v176, 0xffff0000, v176
    v_and_b32 v177, 0xffff0000, v177
    v_and_b32 v178, 0xffff0000, v178
    v_and_b32 v179, 0xffff0000, v179
    v_and_b32 v180, 0xffff0000, v180
    ds_write_b128 v11, v[176:179]
    ds_write_b32 v12, v180 offset:1024
    s_waitcnt lgkmcnt(0)
    s_barrier
    ds_read_b128 v[176:179], v10 offset:0
    ds_read_b128 v[180:183], v10 offset:1280
    ds_read_b128 v[184:187], v10 offset:2560
    ds_read_b128 v[188:191], v10 offset:3840
    ds_read_b128 v[194:197], v10 offset:256
    ds_read_b128 v[198:201], v10 offset:1536
    ds_read_b128 v[202:205], v10 offset:2816
    ds_read_b128 v[206:209], v10 offset:4096
    s_waitcnt lgkmcnt(4)
    v_pk_fma_f32 v[16:17], v[16:17], v[176:177], v[184:185]
    v_pk_fma_f32 v[18:19], v[18:19], v[178:179], v[186:187]
    v_pk_fma_f32 v[20:21], v[20:21], v[180:181], v[188:189]
    v_pk_fma_f32 v[22:23], v[22:23], v[182:183], v[190:191]
    v_pk_fma_f32 v[56:57], v[56:57], v[176:177], v[184:185]
    v_pk_fma_f32 v[58:59], v[58:59], v[178:179], v[186:187]
    v_pk_fma_f32 v[60:61], v[60:61], v[180:181], v[188:189]
    v_pk_fma_f32 v[62:63], v[62:63], v[182:183], v[190:191]
    v_pk_fma_f32 v[96:97], v[96:97], v[176:177], v[184:185]
    v_pk_fma_f32 v[98:99], v[98:99], v[178:179], v[186:187]
    v_pk_fma_f32 v[100:101], v[100:101], v[180:181], v[188:189]
    v_pk_fma_f32 v[102:103], v[102:103], v[182:183], v[190:191]
    v_pk_fma_f32 v[136:137], v[136:137], v[176:177], v[184:185]
    v_pk_fma_f32 v[138:139], v[138:139], v[178:179], v[186:187]
    v_pk_fma_f32 v[140:141], v[140:141], v[180:181], v[188:189]
    v_pk_fma_f32 v[142:143], v[142:143], v[182:183], v[190:191]
    v_cvt_pk_bf16_f32 v212, v16, v17
    v_cvt_pk_bf16_f32 v213, v18, v19
    v_cvt_pk_bf16_f32 v214, v20, v21
    v_cvt_pk_bf16_f32 v215, v22, v23
    ds_write_b128 v6, v[212:215] offset:0
    v_cvt_pk_bf16_f32 v216, v56, v57
    v_cvt_pk_bf16_f32 v217, v58, v59
    v_cvt_pk_bf16_f32 v218, v60, v61
    v_cvt_pk_bf16_f32 v219, v62, v63
    ds_write_b128 v6, v[216:219] offset:64
    v_cvt_pk_bf16_f32 v220, v96, v97
    v_cvt_pk_bf16_f32 v221, v98, v99
    v_cvt_pk_bf16_f32 v222, v100, v101
    v_cvt_pk_bf16_f32 v223, v102, v103
    ds_write_b128 v6, v[220:223] offset:128
    v_cvt_pk_bf16_f32 v224, v136, v137
    v_cvt_pk_bf16_f32 v225, v138, v139
    v_cvt_pk_bf16_f32 v226, v140, v141
    v_cvt_pk_bf16_f32 v227, v142, v143
    ds_write_b128 v6, v[224:227] offset:192
    s_waitcnt lgkmcnt(4)
    ds_read_b128 v[176:179], v10 offset:512
    ds_read_b128 v[180:183], v10 offset:1792
    ds_read_b128 v[184:187], v10 offset:3072
    ds_read_b128 v[188:191], v10 offset:4352
    v_pk_fma_f32 v[24:25], v[24:25], v[194:195], v[202:203]
    v_pk_fma_f32 v[26:27], v[26:27], v[196:197], v[204:205]
    v_pk_fma_f32 v[28:29], v[28:29], v[198:199], v[206:207]
    v_pk_fma_f32 v[30:31], v[30:31], v[200:201], v[208:209]
    v_pk_fma_f32 v[64:65], v[64:65], v[194:195], v[202:203]
    v_pk_fma_f32 v[66:67], v[66:67], v[196:197], v[204:205]
    v_pk_fma_f32 v[68:69], v[68:69], v[198:199], v[206:207]
    v_pk_fma_f32 v[70:71], v[70:71], v[200:201], v[208:209]
    v_pk_fma_f32 v[104:105], v[104:105], v[194:195], v[202:203]
    v_pk_fma_f32 v[106:107], v[106:107], v[196:197], v[204:205]
    v_pk_fma_f32 v[108:109], v[108:109], v[198:199], v[206:207]
    v_pk_fma_f32 v[110:111], v[110:111], v[200:201], v[208:209]
    v_pk_fma_f32 v[144:145], v[144:145], v[194:195], v[202:203]
    v_pk_fma_f32 v[146:147], v[146:147], v[196:197], v[204:205]
    v_pk_fma_f32 v[148:149], v[148:149], v[198:199], v[206:207]
    v_pk_fma_f32 v[150:151], v[150:151], v[200:201], v[208:209]
    v_cvt_pk_bf16_f32 v228, v24, v25
    v_cvt_pk_bf16_f32 v229, v26, v27
    v_cvt_pk_bf16_f32 v230, v28, v29
    v_cvt_pk_bf16_f32 v231, v30, v31
    ds_write_b128 v6, v[228:231] offset:17664
    v_cvt_pk_bf16_f32 v232, v64, v65
    v_cvt_pk_bf16_f32 v233, v66, v67
    v_cvt_pk_bf16_f32 v234, v68, v69
    v_cvt_pk_bf16_f32 v235, v70, v71
    ds_write_b128 v6, v[232:235] offset:17728
    v_cvt_pk_bf16_f32 v236, v104, v105
    v_cvt_pk_bf16_f32 v237, v106, v107
    v_cvt_pk_bf16_f32 v238, v108, v109
    v_cvt_pk_bf16_f32 v239, v110, v111
    ds_write_b128 v6, v[236:239] offset:17792
    v_cvt_pk_bf16_f32 v240, v144, v145
    v_cvt_pk_bf16_f32 v241, v146, v147
    v_cvt_pk_bf16_f32 v242, v148, v149
    v_cvt_pk_bf16_f32 v243, v150, v151
    ds_write_b128 v6, v[240:243] offset:17856
    s_waitcnt lgkmcnt(4)
    s_barrier
    ds_read_b128 v[194:197], v10 offset:768
    ds_read_b128 v[198:201], v10 offset:2048
    ds_read_b128 v[202:205], v10 offset:3328
    ds_read_b128 v[206:209], v10 offset:4608
    v_pk_fma_f32 v[32:33], v[32:33], v[176:177], v[184:185]
    v_pk_fma_f32 v[34:35], v[34:35], v[178:179], v[186:187]
    v_pk_fma_f32 v[36:37], v[36:37], v[180:181], v[188:189]
    v_pk_fma_f32 v[38:39], v[38:39], v[182:183], v[190:191]
    v_pk_fma_f32 v[72:73], v[72:73], v[176:177], v[184:185]
    v_pk_fma_f32 v[74:75], v[74:75], v[178:179], v[186:187]
    v_pk_fma_f32 v[76:77], v[76:77], v[180:181], v[188:189]
    v_pk_fma_f32 v[78:79], v[78:79], v[182:183], v[190:191]
    v_pk_fma_f32 v[112:113], v[112:113], v[176:177], v[184:185]
    v_pk_fma_f32 v[114:115], v[114:115], v[178:179], v[186:187]
    v_pk_fma_f32 v[116:117], v[116:117], v[180:181], v[188:189]
    v_pk_fma_f32 v[118:119], v[118:119], v[182:183], v[190:191]
    v_pk_fma_f32 v[152:153], v[152:153], v[176:177], v[184:185]
    v_pk_fma_f32 v[154:155], v[154:155], v[178:179], v[186:187]
    v_pk_fma_f32 v[156:157], v[156:157], v[180:181], v[188:189]
    v_pk_fma_f32 v[158:159], v[158:159], v[182:183], v[190:191]
    v_cvt_pk_bf16_f32 v212, v32, v33
    v_cvt_pk_bf16_f32 v213, v34, v35
    v_cvt_pk_bf16_f32 v214, v36, v37
    v_cvt_pk_bf16_f32 v215, v38, v39
    ds_write_b128 v6, v[212:215] offset:35328
    v_cvt_pk_bf16_f32 v216, v72, v73
    v_cvt_pk_bf16_f32 v217, v74, v75
    v_cvt_pk_bf16_f32 v218, v76, v77
    v_cvt_pk_bf16_f32 v219, v78, v79
    ds_write_b128 v6, v[216:219] offset:35392
    v_cvt_pk_bf16_f32 v220, v112, v113
    v_cvt_pk_bf16_f32 v221, v114, v115
    v_cvt_pk_bf16_f32 v222, v116, v117
    v_cvt_pk_bf16_f32 v223, v118, v119
    ds_write_b128 v6, v[220:223] offset:35456
    v_cvt_pk_bf16_f32 v224, v152, v153
    v_cvt_pk_bf16_f32 v225, v154, v155
    v_cvt_pk_bf16_f32 v226, v156, v157
    v_cvt_pk_bf16_f32 v227, v158, v159
    ds_write_b128 v6, v[224:227] offset:35520
    s_waitcnt lgkmcnt(4)
    s_barrier
    ds_read_b128 v[176:179], v10 offset:1024
    ds_read_b128 v[180:183], v10 offset:2304
    ds_read_b128 v[184:187], v10 offset:3584
    ds_read_b128 v[188:191], v10 offset:4864
    v_pk_fma_f32 v[40:41], v[40:41], v[194:195], v[202:203]
    v_pk_fma_f32 v[42:43], v[42:43], v[196:197], v[204:205]
    v_pk_fma_f32 v[44:45], v[44:45], v[198:199], v[206:207]
    v_pk_fma_f32 v[46:47], v[46:47], v[200:201], v[208:209]
    v_pk_fma_f32 v[80:81], v[80:81], v[194:195], v[202:203]
    v_pk_fma_f32 v[82:83], v[82:83], v[196:197], v[204:205]
    v_pk_fma_f32 v[84:85], v[84:85], v[198:199], v[206:207]
    v_pk_fma_f32 v[86:87], v[86:87], v[200:201], v[208:209]
    v_pk_fma_f32 v[120:121], v[120:121], v[194:195], v[202:203]
    v_pk_fma_f32 v[122:123], v[122:123], v[196:197], v[204:205]
    v_pk_fma_f32 v[124:125], v[124:125], v[198:199], v[206:207]
    v_pk_fma_f32 v[126:127], v[126:127], v[200:201], v[208:209]
    v_pk_fma_f32 v[160:161], v[160:161], v[194:195], v[202:203]
    v_pk_fma_f32 v[162:163], v[162:163], v[196:197], v[204:205]
    v_pk_fma_f32 v[164:165], v[164:165], v[198:199], v[206:207]
    v_pk_fma_f32 v[166:167], v[166:167], v[200:201], v[208:209]
    v_cvt_pk_bf16_f32 v228, v40, v41
    v_cvt_pk_bf16_f32 v229, v42, v43
    v_cvt_pk_bf16_f32 v230, v44, v45
    v_cvt_pk_bf16_f32 v231, v46, v47
    ds_write_b128 v6, v[228:231] offset:52992
    v_cvt_pk_bf16_f32 v232, v80, v81
    v_cvt_pk_bf16_f32 v233, v82, v83
    v_cvt_pk_bf16_f32 v234, v84, v85
    v_cvt_pk_bf16_f32 v235, v86, v87
    ds_write_b128 v6, v[232:235] offset:53056
    v_cvt_pk_bf16_f32 v236, v120, v121
    v_cvt_pk_bf16_f32 v237, v122, v123
    v_cvt_pk_bf16_f32 v238, v124, v125
    v_cvt_pk_bf16_f32 v239, v126, v127
    ds_write_b128 v6, v[236:239] offset:53120
    v_cvt_pk_bf16_f32 v240, v160, v161
    v_cvt_pk_bf16_f32 v241, v162, v163
    v_cvt_pk_bf16_f32 v242, v164, v165
    v_cvt_pk_bf16_f32 v243, v166, v167
    ds_write_b128 v6, v[240:243] offset:53184
    s_waitcnt lgkmcnt(4)
    s_barrier
    v_pk_fma_f32 v[48:49], v[48:49], v[176:177], v[184:185]
    v_pk_fma_f32 v[50:51], v[50:51], v[178:179], v[186:187]
    v_pk_fma_f32 v[52:53], v[52:53], v[180:181], v[188:189]
    v_pk_fma_f32 v[54:55], v[54:55], v[182:183], v[190:191]
    v_pk_fma_f32 v[88:89], v[88:89], v[176:177], v[184:185]
    v_pk_fma_f32 v[90:91], v[90:91], v[178:179], v[186:187]
    v_pk_fma_f32 v[92:93], v[92:93], v[180:181], v[188:189]
    v_pk_fma_f32 v[94:95], v[94:95], v[182:183], v[190:191]
    v_pk_fma_f32 v[128:129], v[128:129], v[176:177], v[184:185]
    v_pk_fma_f32 v[130:131], v[130:131], v[178:179], v[186:187]
    v_pk_fma_f32 v[132:133], v[132:133], v[180:181], v[188:189]
    v_pk_fma_f32 v[134:135], v[134:135], v[182:183], v[190:191]
    v_pk_fma_f32 v[168:169], v[168:169], v[176:177], v[184:185]
    v_pk_fma_f32 v[170:171], v[170:171], v[178:179], v[186:187]
    v_pk_fma_f32 v[172:173], v[172:173], v[180:181], v[188:189]
    v_pk_fma_f32 v[174:175], v[174:175], v[182:183], v[190:191]
    v_cvt_pk_bf16_f32 v212, v48, v49
    v_cvt_pk_bf16_f32 v213, v50, v51
    v_cvt_pk_bf16_f32 v214, v52, v53
    v_cvt_pk_bf16_f32 v215, v54, v55
    ds_write_b128 v7, v[212:215] offset:5120
    v_cvt_pk_bf16_f32 v216, v88, v89
    v_cvt_pk_bf16_f32 v217, v90, v91
    v_cvt_pk_bf16_f32 v218, v92, v93
    v_cvt_pk_bf16_f32 v219, v94, v95
    ds_write_b128 v7, v[216:219] offset:5184
    v_cvt_pk_bf16_f32 v220, v128, v129
    v_cvt_pk_bf16_f32 v221, v130, v131
    v_cvt_pk_bf16_f32 v222, v132, v133
    v_cvt_pk_bf16_f32 v223, v134, v135
    ds_write_b128 v7, v[220:223] offset:5248
    v_cvt_pk_bf16_f32 v224, v168, v169
    v_cvt_pk_bf16_f32 v225, v170, v171
    v_cvt_pk_bf16_f32 v226, v172, v173
    v_cvt_pk_bf16_f32 v227, v174, v175
    ds_write_b128 v7, v[224:227] offset:5312
    s_nop 0
    s_waitcnt lgkmcnt(4)
    s_barrier
    s_mov_b32 s60, 458752
    s_mov_b32 s61, 466944
    s_mov_b32 s62, 475136
    s_mov_b32 s63, 483328
    v_lshrrev_b32 v96, 4, v1
    v_lshlrev_b32 v96, 7, v96
    s_waitcnt lgkmcnt(0)
    s_barrier
    s_barrier
    s_mov_b32 s37, 49152
    s_mov_b32 m0, 88320
    s_cmp_eq_u32 s5, 1
    s_cselect_b32 s37, 50176, s37
    s_cselect_b32 m0, 89344, m0
    s_cmp_eq_u32 s5, 2
    s_cselect_b32 s37, 51200, s37
    s_cselect_b32 m0, 90368, m0
    s_cmp_eq_u32 s5, 3
    s_cselect_b32 s37, 52224, s37
    s_cselect_b32 m0, 91392, m0
    s_add_u32 s37, s37, s10
    buffer_load_dwordx4 v1, s[16:19], s37 offen sc1 lds
    s_mov_b32 s37, 53248
    s_mov_b32 m0, 92416
    s_cmp_eq_u32 s5, 1
    s_cselect_b32 s37, 55296, s37
    s_cselect_b32 m0, 93440, m0
    s_cmp_eq_u32 s5, 2
    s_cselect_b32 s37, 56320, s37
    s_cselect_b32 m0, 94464, m0
    s_cmp_eq_u32 s5, 3
    s_cselect_b32 s37, 57344, s37
    s_cselect_b32 m0, 95488, m0
    s_add_u32 s37, s37, s10
    buffer_load_dwordx4 v1, s[16:19], s37 offen sc1 lds
    s_mov_b32 s37, 58368
    s_mov_b32 m0, 96512
    s_cmp_eq_u32 s5, 1
    s_cselect_b32 s37, 59392, s37
    s_cselect_b32 m0, 97536, m0
    s_cmp_eq_u32 s5, 2
    s_cselect_b32 s37, 61440, s37
    s_cselect_b32 m0, 98560, m0
    s_cmp_eq_u32 s5, 3
    s_cselect_b32 s37, 62464, s37
    s_cselect_b32 m0, 99584, m0
    s_add_u32 s37, s37, s10
    buffer_load_dwordx4 v1, s[16:19], s37 offen sc1 lds
    s_mov_b32 s37, 63488
    s_mov_b32 m0, 100608
    s_cmp_eq_u32 s5, 1
    s_cselect_b32 s37, 64512, s37
    s_cselect_b32 m0, 101632, m0
    s_cmp_eq_u32 s5, 2
    s_cselect_b32 s37, 65536, s37
    s_cselect_b32 m0, 102656, m0
    s_cmp_eq_u32 s5, 3
    s_cselect_b32 s37, 67584, s37
    s_cselect_b32 m0, 103680, m0
    s_add_u32 s37, s37, s10
    buffer_load_dwordx4 v1, s[16:19], s37 offen sc1 lds
    s_mov_b32 s37, 68608
    s_mov_b32 m0, 104704
    s_cmp_eq_u32 s5, 1
    s_cselect_b32 s37, 69632, s37
    s_cselect_b32 m0, 105728, m0
    s_cmp_eq_u32 s5, 2
    s_cselect_b32 s37, 70656, s37
    s_cselect_b32 m0, 106752, m0
    s_cmp_eq_u32 s5, 3
    s_cselect_b32 s37, 71680, s37
    s_cselect_b32 m0, 107776, m0
    s_add_u32 s37, s37, s10
    buffer_load_dwordx4 v1, s[16:19], s37 offen sc1 lds
    s_mov_b32 s37, 73728
    s_mov_b32 m0, 108800
    s_cmp_eq_u32 s5, 1
    s_cselect_b32 s37, 74752, s37
    s_cselect_b32 m0, 109824, m0
    s_cmp_eq_u32 s5, 2
    s_cselect_b32 s37, 75776, s37
    s_cselect_b32 m0, 110848, m0
    s_cmp_eq_u32 s5, 3
    s_cselect_b32 s37, 76800, s37
    s_cselect_b32 m0, 111872, m0
    s_add_u32 s37, s37, s10
    buffer_load_dwordx4 v1, s[16:19], s37 offen sc1 lds
    s_mov_b32 s37, 77824
    s_mov_b32 m0, 112896
    s_cmp_eq_u32 s5, 1
    s_cselect_b32 s37, 79872, s37
    s_cselect_b32 m0, 154880, m0
    s_cmp_eq_u32 s5, 2
    s_cselect_b32 s37, 80896, s37
    s_cselect_b32 m0, 155904, m0
    s_cmp_eq_u32 s5, 3
    s_cselect_b32 s37, 81920, s37
    s_cselect_b32 m0, 156928, m0
    s_add_u32 s37, s37, s10
    buffer_load_dwordx4 v1, s[16:19], s37 offen sc1 lds
    s_mov_b32 s37, 82944
    s_mov_b32 m0, 157952
    s_cmp_eq_u32 s5, 1
    s_cselect_b32 s37, 83968, s37
    s_cselect_b32 m0, 158976, m0
    s_cmp_eq_u32 s5, 2
    s_cselect_b32 s37, 1073741824, s37
    s_cselect_b32 m0, 163840, m0
    s_cmp_eq_u32 s5, 3
    s_cselect_b32 s37, 1073741824, s37
    s_cselect_b32 m0, 163840, m0
    s_add_u32 s37, s37, s10
    buffer_load_dwordx4 v1, s[16:19], s37 offen sc1 lds
    s_barrier
    s_mov_b32 s37, 86016
    s_mov_b32 m0, 113920
    s_cmp_eq_u32 s5, 1
    s_cselect_b32 s37, 87040, s37
    s_cselect_b32 m0, 114944, m0
    s_cmp_eq_u32 s5, 2
    s_cselect_b32 s37, 88064, s37
    s_cselect_b32 m0, 115968, m0
    s_cmp_eq_u32 s5, 3
    s_cselect_b32 s37, 89088, s37
    s_cselect_b32 m0, 116992, m0
    s_add_u32 s37, s37, s10
    buffer_load_dwordx4 v1, s[16:19], s37 offen sc1 lds
    s_mov_b32 s37, 90112
    s_mov_b32 m0, 118016
    s_cmp_eq_u32 s5, 1
    s_cselect_b32 s37, 92160, s37
    s_cselect_b32 m0, 119040, m0
    s_cmp_eq_u32 s5, 2
    s_cselect_b32 s37, 93184, s37
    s_cselect_b32 m0, 120064, m0
    s_cmp_eq_u32 s5, 3
    s_cselect_b32 s37, 94208, s37
    s_cselect_b32 m0, 121088, m0
    s_add_u32 s37, s37, s10
    buffer_load_dwordx4 v1, s[16:19], s37 offen sc1 lds
    s_mov_b32 s37, 95232
    s_mov_b32 m0, 122112
    s_cmp_eq_u32 s5, 1
    s_cselect_b32 s37, 96256, s37
    s_cselect_b32 m0, 123136, m0
    s_cmp_eq_u32 s5, 2
    s_cselect_b32 s37, 98304, s37
    s_cselect_b32 m0, 124160, m0
    s_cmp_eq_u32 s5, 3
    s_cselect_b32 s37, 99328, s37
    s_cselect_b32 m0, 125184, m0
    s_add_u32 s37, s37, s10
    buffer_load_dwordx4 v1, s[16:19], s37 offen sc1 lds
    s_mov_b32 s37, 100352
    s_mov_b32 m0, 126208
    s_cmp_eq_u32 s5, 1
    s_cselect_b32 s37, 101376, s37
    s_cselect_b32 m0, 127232, m0
    s_cmp_eq_u32 s5, 2
    s_cselect_b32 s37, 102400, s37
    s_cselect_b32 m0, 128256, m0
    s_cmp_eq_u32 s5, 3
    s_cselect_b32 s37, 104448, s37
    s_cselect_b32 m0, 129280, m0
    s_add_u32 s37, s37, s10
    buffer_load_dwordx4 v1, s[16:19], s37 offen sc1 lds
    s_mov_b32 s37, 105472
    s_mov_b32 m0, 130304
    s_cmp_eq_u32 s5, 1
    s_cselect_b32 s37, 106496, s37
    s_cselect_b32 m0, 131328, m0
    s_cmp_eq_u32 s5, 2
    s_cselect_b32 s37, 107520, s37
    s_cselect_b32 m0, 132352, m0
    s_cmp_eq_u32 s5, 3
    s_cselect_b32 s37, 108544, s37
    s_cselect_b32 m0, 133376, m0
    s_add_u32 s37, s37, s10
    buffer_load_dwordx4 v1, s[16:19], s37 offen sc1 lds
    s_mov_b32 s37, 110592
    s_mov_b32 m0, 0
    s_cmp_eq_u32 s5, 1
    s_cselect_b32 s37, 111616, s37
    s_cselect_b32 m0, 1024, m0
    s_cmp_eq_u32 s5, 2
    s_cselect_b32 s37, 112640, s37
    s_cselect_b32 m0, 2048, m0
    s_cmp_eq_u32 s5, 3
    s_cselect_b32 s37, 113664, s37
    s_cselect_b32 m0, 3072, m0
    s_add_u32 s37, s37, s10
    buffer_load_dwordx4 v1, s[16:19], s37 offen sc1 lds
    s_mov_b32 s37, 114688
    s_mov_b32 m0, 4096
    s_cmp_eq_u32 s5, 1
    s_cselect_b32 s37, 116736, s37
    s_cselect_b32 m0, 5120, m0
    s_cmp_eq_u32 s5, 2
    s_cselect_b32 s37, 117760, s37
    s_cselect_b32 m0, 6144, m0
    s_cmp_eq_u32 s5, 3
    s_cselect_b32 s37, 118784, s37
    s_cselect_b32 m0, 7168, m0
    s_add_u32 s37, s37, s10
    buffer_load_dwordx4 v1, s[16:19], s37 offen sc1 lds
    s_mov_b32 s37, 119808
    s_mov_b32 m0, 8192
    s_cmp_eq_u32 s5, 1
    s_cselect_b32 s37, 120832, s37
    s_cselect_b32 m0, 9216, m0
    s_cmp_eq_u32 s5, 2
    s_cselect_b32 s37, 1073741824, s37
    s_cselect_b32 m0, 163840, m0
    s_cmp_eq_u32 s5, 3
    s_cselect_b32 s37, 1073741824, s37
    s_cselect_b32 m0, 163840, m0
    s_add_u32 s37, s37, s10
    buffer_load_dwordx4 v1, s[16:19], s37 offen sc1 lds
    s_waitcnt vmcnt(8)
    s_barrier
    s_waitcnt vmcnt(0)
    s_barrier
    s_cmp_lg_u32 s5, 0
    s_cbranch_scc1 f_p1_ok
    s_sleep 8
    v_mov_b32 v97, 0
    v_mov_b32 v98, 0
    v_mov_b32 v99, 0
    v_mov_b32 v100, 0
    s_mov_b32 s38, 0
    s_mov_b64 s[70:71], 0
f_p1:
    v_cmp_eq_u32 vcc, 0, v97
    s_or_b64 s[70:71], s[70:71], vcc
    s_cmp_eq_u64 vcc, 0
    s_cbranch_scc1 f_p1_s0
    s_mov_b64 exec, vcc
    buffer_load_dword v97, v96, s[28:31], s60 offen sc1
    s_mov_b64 exec, -1
f_p1_s0:
    v_cmp_eq_u32 vcc, 0, v98
    s_or_b64 s[70:71], s[70:71], vcc
    s_cmp_eq_u64 vcc, 0
    s_cbranch_scc1 f_p1_s1
    s_mov_b64 exec, vcc
    buffer_load_dword v98, v96, s[28:31], s61 offen sc1
    s_mov_b64 exec, -1
f_p1_s1:
    v_cmp_eq_u32 vcc, 0, v99
    s_or_b64 s[70:71], s[70:71], vcc
    s_cmp_eq_u64 vcc, 0
    s_cbranch_scc1 f_p1_s2
    s_mov_b64 exec, vcc
    buffer_load_dword v99, v96, s[28:31], s62 offen sc1
    s_mov_b64 exec, -1
f_p1_s2:
    v_cmp_eq_u32 vcc, 0, v100
    s_or_b64 s[70:71], s[70:71], vcc
    s_cmp_eq_u64 vcc, 0
    s_cbranch_scc1 f_p1_s3
    s_mov_b64 exec, vcc
    buffer_load_dword v100, v96, s[28:31], s63 offen sc1
    s_mov_b64 exec, -1
f_p1_s3:
    s_cmp_eq_u64 s[70:71], 0
    s_cbranch_scc1 f_p1_ok
    s_mov_b64 s[70:71], 0
    s_add_u32 s38, s38, 1
    s_sleep 1
    s_waitcnt vmcnt(0)
    s_cmp_lt_u32 s38, 200000
    s_cbranch_scc1 f_p1
f_p1_ok:
k1_done:
    s_add_u32 s16, s8, 0x7000
    s_addc_u32 s17, s9, 0
    s_mov_b32 s18, 0x71000
    s_mov_b32 s19, 0x20000
    v_lshrrev_b32 v1, 6, v0
    s_barrier
    v_readfirstlane_b32 s5, v1
    s_getreg_b32 s43, hwreg(HW_REG_XCC_ID, 0, 4)
    s_add_u32 s42, s43, 1
    v_and_b32 v1, 63, v0
    v_lshlrev_b32 v1, 4, v1
    s_lshl_b32 s10, s5, 10
    s_mov_b32 m0, s10
    s_add_u32 s20, s8, 0x78000
    s_addc_u32 s21, s9, 0
    s_mov_b32 s22, 0x28000
    s_mov_b32 s23, 0x20000
    buffer_load_dwordx4 v1, s[20:23], m0 offen sc1 lds
    s_add_u32 s52, s8, 0xb09000
    s_addc_u32 s53, s9, 0
    s_mov_b32 s54, 0x400
    s_mov_b32 s55, 0x20000
    s_add_u32 s56, s8, 0x7400
    s_addc_u32 s57, s9, 0
    s_mov_b32 s58, 0x400
    s_mov_b32 s59, 0x20000
    buffer_load_dwordx4 v[56:59], v1, s[52:55], 0 offen sc1
    s_add_u32 m0, m0, 0x2000
    buffer_load_dwordx4 v[32:35], v1, s[56:59], 0 offen sc1
    buffer_load_dwordx4 v1, s[20:23], m0 offen sc1 lds
    s_add_u32 m0, m0, 0x2000
    s_nop 0
    buffer_load_dwordx4 v1, s[20:23], m0 offen sc1 lds
    s_add_u32 m0, m0, 0x2000
    s_nop 0
    buffer_load_dwordx4 v1, s[20:23], m0 offen sc1 lds
    s_load_dwordx2 s[44:45], s[0:1], 0
    s_load_dwordx4 s[48:51], s[0:1], 48
    s_load_dwordx2 s[46:47], s[0:1], 72
    s_and_b32 s3, s2, 7
    s_lshl_b32 s24, s3, 2
    s_bfe_u32 s4, s2, 0x20003
    s_add_u32 s24, s24, s4
    s_lshr_b32 s25, s2, 5
    v_and_b32 v2, 31, v0
    v_bfe_u32 v3, v0, 5, 1
    s_lshl_b32 s4, s25, 2
    s_and_b32 s26, s5, 3
    s_add_u32 s4, s4, s26
    s_lshl_b32 s6, s24, 1
    s_lshr_b32 s43, s5, 2
    s_add_u32 s6, s6, s43
    s_mul_i32 s7, s26, 2560
    s_mul_i32 s11, s43, 1280
    s_add_u32 s7, s7, s11
    s_add_u32 s7, s7, 36864
    v_add_u32 v15, s7, v1
    ds_read_b128 v[4:7], v15
    v_lshl_add_u32 v15, v2, 3, s7
    v_mov_b32 v8, 0
    v_mov_b32 v9, 0
    s_mov_b32 exec_hi, 0
    ds_read_b64 v[8:9], v15 offset:1024
    s_mov_b64 exec, -1
    s_setprio 3
    s_bfe_u32 s27, s2, 0x10003
    s_lshr_b32 s28, s24, 1
    s_lshl_b32 s29, s25, 1
    s_add_u32 s29, s29, s27
    v_mov_b32 v12, v1
    v_lshlrev_b32 v13, 3, v2
    v_add_u32 v13, 1024, v13
    v_mul_u32_u24 v14, 20, v3
    v_add_u32 v14, v14, v2
    v_lshlrev_b32 v14, 4, v14
    v_add_u32 v14, 1280, v14
    s_mov_b32 s40, 0x000fffff
    s_mov_b32 s41, 0x000fffff
    v_or_b32 v15, 4, v2
    v_cmp_eq_u32 vcc, 28, v15
    v_mov_b32 v15, 0x3f803f80
    s_add_u32 s43, s43, 1
    v_cndmask_b32 v104, 0, v15, vcc
    v_mov_b32 v64, 0
    v_mov_b32 v65, 0
    v_mov_b32 v66, 0
    v_mov_b32 v67, 0
    v_mov_b32 v68, 0
    v_mov_b32 v69, 0
    v_mov_b32 v70, 0
    v_mov_b32 v71, 0
    v_mov_b32 v72, 0
    v_mov_b32 v73, 0
    v_mov_b32 v74, 0
    v_mov_b32 v75, 0
    v_mov_b32 v76, 0
    v_mov_b32 v77, 0
    v_mov_b32 v78, 0
    v_mov_b32 v79, 0
    v_mov_b32 v105, v104
    v_mov_b32 v106, v104
    v_mov_b32 v107, v104
    v_mov_b32 v108, v104
    v_mov_b32 v109, v104
    v_mov_b32 v110, v104
    v_mov_b32 v111, v104
    v_mov_b32 v112, v104
    v_mov_b32 v113, v104
    v_mov_b32 v114, v104
    v_mov_b32 v115, v104
    v_mov_b32 v116, v104
    v_mov_b32 v117, v104
    v_mov_b32 v118, v104
    v_mov_b32 v119, v104
    v_mov_b32 v84, 0
    v_mov_b32 v85, 0
    v_mov_b32 v86, 0
    v_mov_b32 v87, 0
    v_mov_b32 v10, 0
    v_mov_b32 v11, 0
    v_mov_b32 v98, 0
    v_mov_b32 v99, 0
    v_mov_b32 v102, 0
    v_mov_b32 v103, 0
    s_add_u32 s12, s8, 0xcc0000
    s_addc_u32 s13, s9, 0
    s_mov_b32 s14, 0x280000
    s_mov_b32 s15, 0x20000
    s_mul_i32 s7, s25, 102400
    s_add_u32 s7, s7, 1671168
    s_add_u32 s32, s8, s7
    s_addc_u32 s33, s9, 0
    s_mov_b32 s34, 0x19000
    s_mov_b32 s35, 0x20000
    s_waitcnt vmcnt(3) lgkmcnt(0)
    s_and_b32 s36, s2, 3
    s_cmp_eq_u32 s36, 1
    s_cselect_b64 vcc, -1, 0
    v_cndmask_b32 v56, v56, v57, vcc
    s_cmp_eq_u32 s36, 2
    s_cselect_b64 vcc, -1, 0
    v_cndmask_b32 v56, v56, v58, vcc
    s_cmp_eq_u32 s36, 3
    s_cselect_b64 vcc, -1, 0
    v_cndmask_b32 v56, v56, v59, vcc
    s_lshr_b32 s36, s2, 2
    v_xor_b32 v60, s36, v0
    v_and_b32 v60, 5, v60
    v_cmp_eq_u32 vcc, 0, v60
    v_cmp_ne_u32 s[36:37], s42, v56
    s_nop 0
    s_and_b64 vcc, vcc, s[36:37]
    s_cselect_b32 s30, 0, 1
    v_max3_f32 v48, v32, v33, v34
    v_max_f32 v48, v48, v35
    v_dot2_f32_bf16 v50, v4, v4, 0
    s_nop 1
    v_max_f32_dpp v48, v48, v48 row_ror:1 row_mask:0xf bank_mask:0xf
    s_nop 1
    v_max_f32_dpp v48, v48, v48 row_ror:2 row_mask:0xf bank_mask:0xf
    s_nop 1
    v_max_f32_dpp v48, v48, v48 row_ror:4 row_mask:0xf bank_mask:0xf
    s_nop 1
    v_max_f32_dpp v48, v48, v48 row_ror:8 row_mask:0xf bank_mask:0xf
    v_dot2_f32_bf16 v50, v5, v5, v50
    v_dot2_f32_bf16 v50, v6, v6, v50
    v_dot2_f32_bf16 v50, v7, v7, v50
    v_dot2_f32_bf16 v50, v8, v8, v50
    v_dot2_f32_bf16 v50, v9, v9, v50
    v_mov_b32 v49, v48
    s_nop 2
    v_mov_b32 v51, v50
    v_permlane16_swap_b32 v48, v49
    v_max_f32 v48, v48, v49
    v_permlane32_swap_b32 v50, v51
    v_mov_b32 v49, v48
    v_add_f32 v50, v50, v51
    s_nop 0
    v_permlane32_swap_b32 v48, v49
    v_add_f32 v48, v48, v49
    v_mul_f32 v48, v48, v50
    v_sqrt_f32 v48, v48
    s_nop 0
    v_mov_b32 v49, 0xbf8020c5
    v_fmaak_f32 v16, v48, v49, 0x42700000
    v_mov_b32 v17, v16
    v_mov_b32 v18, v16
    v_mov_b32 v19, v16
    v_mov_b32 v20, v16
    v_mov_b32 v21, v16
    v_mov_b32 v22, v16
    v_mov_b32 v23, v16
    v_mov_b32 v24, v16
    v_mov_b32 v25, v16
    v_mov_b32 v26, v16
    v_mov_b32 v27, v16
    v_mov_b32 v28, v16
    v_mov_b32 v29, v16
    v_mov_b32 v30, v16
    v_mov_b32 v31, v16
    s_waitcnt vmcnt(0) lgkmcnt(0)
    s_barrier
    ds_read_b128 v[88:91], v12 offset:0
    ds_read_b64 v[96:97], v13 offset:0
    ds_read_b128 v[92:95], v12 offset:2560
    ds_read_b64 v[100:101], v13 offset:2560
    s_mov_b64 exec, s[40:41]
    ds_read_b128 v[104:107], v14 offset:0
    ds_read_b128 v[108:111], v14 offset:640
    s_mov_b64 exec, -1
    s_waitcnt lgkmcnt(4)
    v_mfma_f32_32x32x16_bf16 v[32:47], v[88:91], v[4:7], v[16:31]
    v_mfma_f32_32x32x16_bf16 v[32:47], v[96:99], v[8:11], v[32:47]
    s_nop 7
    s_waitcnt lgkmcnt(0)
    ds_read_b128 v[88:91], v12 offset:5120
    ds_read_b64 v[96:97], v13 offset:5120
    v_mfma_f32_32x32x16_bf16 v[64:79], v[116:119], v[84:87], v[64:79]
    v_exp_f32 v32, v32
    s_add_u32 m0, m0, 0x2000
    v_exp_f32 v33, v33
    buffer_load_dwordx4 v1, s[20:23], m0 offen sc1 lds
    v_exp_f32 v34, v34
    v_exp_f32 v35, v35
    v_cvt_pk_bf16_f32 v80, v32, v33
    v_cvt_pk_bf16_f32 v81, v34, v35
    v_mfma_f32_32x32x16_bf16 v[48:63], v[92:95], v[4:7], v[16:31]
    s_mov_b64 exec, s[40:41]
    ds_read_b128 v[112:115], v14 offset:2560
    ds_read_b128 v[116:119], v14 offset:3200
    s_mov_b64 exec, -1
    v_exp_f32 v36, v36
    v_exp_f32 v37, v37
    s_add_u32 m0, m0, 0x2000
    v_exp_f32 v38, v38
    buffer_load_dwordx4 v1, s[20:23], m0 offen sc1 lds
    v_exp_f32 v39, v39
    v_cvt_pk_bf16_f32 v82, v36, v37
    v_cvt_pk_bf16_f32 v83, v38, v39
    v_mfma_f32_32x32x16_bf16 v[48:63], v[100:103], v[8:11], v[48:63]
    v_exp_f32 v40, v40
    v_exp_f32 v41, v41
    v_exp_f32 v42, v42
    s_add_u32 m0, m0, 0x2000
    v_exp_f32 v43, v43
    buffer_load_dwordx4 v1, s[20:23], m0 offen sc1 lds
    v_cvt_pk_bf16_f32 v84, v40, v41
    v_cvt_pk_bf16_f32 v85, v42, v43
    v_mfma_f32_32x32x16_bf16 v[64:79], v[104:107], v[80:83], v[64:79]
    v_exp_f32 v44, v44
    v_exp_f32 v45, v45
    v_exp_f32 v46, v46
    v_exp_f32 v47, v47
    v_cvt_pk_bf16_f32 v86, v44, v45
    v_cvt_pk_bf16_f32 v87, v46, v47
    s_waitcnt lgkmcnt(0)
    ds_read_b128 v[92:95], v12 offset:7680
    ds_read_b64 v[100:101], v13 offset:7680
    v_mfma_f32_32x32x16_bf16 v[64:79], v[108:111], v[84:87], v[64:79]
    s_add_u32 m0, m0, 0x2000
    v_exp_f32 v48, v48
    buffer_load_dwordx4 v1, s[20:23], m0 offen sc1 lds
    v_exp_f32 v49, v49
    v_exp_f32 v50, v50
    v_exp_f32 v51, v51
    v_cvt_pk_bf16_f32 v80, v48, v49
    v_cvt_pk_bf16_f32 v81, v50, v51
    v_mfma_f32_32x32x16_bf16 v[32:47], v[88:91], v[4:7], v[16:31]
    s_mov_b64 exec, s[40:41]
    ds_read_b128 v[104:107], v14 offset:5120
    ds_read_b128 v[108:111], v14 offset:5760
    s_mov_b64 exec, -1
    v_exp_f32 v52, v52
    s_add_u32 m0, m0, 0x2000
    v_exp_f32 v53, v53
    buffer_load_dwordx4 v1, s[20:23], m0 offen sc1 lds
    v_exp_f32 v54, v54
    v_exp_f32 v55, v55
    v_cvt_pk_bf16_f32 v82, v52, v53
    v_cvt_pk_bf16_f32 v83, v54, v55
    v_mfma_f32_32x32x16_bf16 v[32:47], v[96:99], v[8:11], v[32:47]
    v_exp_f32 v56, v56
    v_exp_f32 v57, v57
    s_add_u32 m0, m0, 0x2000
    v_exp_f32 v58, v58
    buffer_load_dwordx4 v1, s[20:23], m0 offen sc1 lds
    v_exp_f32 v59, v59
    v_cvt_pk_bf16_f32 v84, v56, v57
    v_cvt_pk_bf16_f32 v85, v58, v59
    v_mfma_f32_32x32x16_bf16 v[64:79], v[112:115], v[80:83], v[64:79]
    v_exp_f32 v60, v60
    v_exp_f32 v61, v61
    v_exp_f32 v62, v62
    s_add_u32 m0, m0, 0x2000
    v_exp_f32 v63, v63
    buffer_load_dwordx4 v1, s[20:23], m0 offen sc1 lds
    v_cvt_pk_bf16_f32 v86, v60, v61
    v_cvt_pk_bf16_f32 v87, v62, v63
    s_setprio 2
    s_waitcnt lgkmcnt(0)
    ds_read_b128 v[88:91], v12 offset:10240
    ds_read_b64 v[96:97], v13 offset:10240
    v_mfma_f32_32x32x16_bf16 v[64:79], v[116:119], v[84:87], v[64:79]
    v_exp_f32 v32, v32
    v_exp_f32 v33, v33
    v_exp_f32 v34, v34
    v_exp_f32 v35, v35
    v_cvt_pk_bf16_f32 v80, v32, v33
    v_cvt_pk_bf16_f32 v81, v34, v35
    v_mfma_f32_32x32x16_bf16 v[48:63], v[92:95], v[4:7], v[16:31]
    s_mov_b64 exec, s[40:41]
    ds_read_b128 v[112:115], v14 offset:7680
    ds_read_b128 v[116:119], v14 offset:8320
    s_mov_b64 exec, -1
    s_add_u32 m0, m0, 0x2000
    v_exp_f32 v36, v36
    buffer_load_dwordx4 v1, s[20:23], m0 offen sc1 lds
    v_exp_f32 v37, v37
    v_exp_f32 v38, v38
    v_exp_f32 v39, v39
    v_cvt_pk_bf16_f32 v82, v36, v37
    v_cvt_pk_bf16_f32 v83, v38, v39
    v_mfma_f32_32x32x16_bf16 v[48:63], v[100:103], v[8:11], v[48:63]
    v_exp_f32 v40, v40
    s_add_u32 m0, m0, 0x2000
    v_exp_f32 v41, v41
    buffer_load_dwordx4 v1, s[20:23], m0 offen sc1 lds
    v_exp_f32 v42, v42
    v_exp_f32 v43, v43
    v_cvt_pk_bf16_f32 v84, v40, v41
    v_cvt_pk_bf16_f32 v85, v42, v43
    v_mfma_f32_32x32x16_bf16 v[64:79], v[104:107], v[80:83], v[64:79]
    v_exp_f32 v44, v44
    v_exp_f32 v45, v45
    s_add_u32 m0, m0, 0x2000
    v_exp_f32 v46, v46
    buffer_load_dwordx4 v1, s[20:23], m0 offen sc1 lds
    v_exp_f32 v47, v47
    v_cvt_pk_bf16_f32 v86, v44, v45
    v_cvt_pk_bf16_f32 v87, v46, v47
    s_waitcnt lgkmcnt(0)
    ds_read_b128 v[92:95], v12 offset:12800
    ds_read_b64 v[100:101], v13 offset:12800
    v_mfma_f32_32x32x16_bf16 v[64:79], v[108:111], v[84:87], v[64:79]
    v_exp_f32 v48, v48
    v_exp_f32 v49, v49
    v_exp_f32 v50, v50
    s_add_u32 m0, m0, 0x2000
    v_exp_f32 v51, v51
    buffer_load_dwordx4 v1, s[20:23], m0 offen sc1 lds
    v_cvt_pk_bf16_f32 v80, v48, v49
    v_cvt_pk_bf16_f32 v81, v50, v51
    v_mfma_f32_32x32x16_bf16 v[32:47], v[88:91], v[4:7], v[16:31]
    s_mov_b64 exec, s[40:41]
    ds_read_b128 v[104:107], v14 offset:10240
    ds_read_b128 v[108:111], v14 offset:10880
    s_mov_b64 exec, -1
    v_exp_f32 v52, v52
    v_exp_f32 v53, v53
    v_exp_f32 v54, v54
    v_exp_f32 v55, v55
    v_cvt_pk_bf16_f32 v82, v52, v53
    v_cvt_pk_bf16_f32 v83, v54, v55
    v_mfma_f32_32x32x16_bf16 v[32:47], v[96:99], v[8:11], v[32:47]
    s_add_u32 m0, m0, 0x2000
    v_exp_f32 v56, v56
    buffer_load_dwordx4 v1, s[20:23], m0 offen sc1 lds
    v_exp_f32 v57, v57
    v_exp_f32 v58, v58
    v_exp_f32 v59, v59
    v_cvt_pk_bf16_f32 v84, v56, v57
    v_cvt_pk_bf16_f32 v85, v58, v59
    v_mfma_f32_32x32x16_bf16 v[64:79], v[112:115], v[80:83], v[64:79]
    v_exp_f32 v60, v60
    s_add_u32 m0, m0, 0x2000
    v_exp_f32 v61, v61
    buffer_load_dwordx4 v1, s[20:23], m0 offen sc1 lds
    v_exp_f32 v62, v62
    v_exp_f32 v63, v63
    v_cvt_pk_bf16_f32 v86, v60, v61
    v_cvt_pk_bf16_f32 v87, v62, v63
    s_setprio 1
    s_waitcnt lgkmcnt(0)
    ds_read_b128 v[88:91], v12 offset:15360
    ds_read_b64 v[96:97], v13 offset:15360
    v_mfma_f32_32x32x16_bf16 v[64:79], v[116:119], v[84:87], v[64:79]
    v_exp_f32 v32, v32
    v_exp_f32 v33, v33
    s_add_u32 m0, m0, 0x2000
    v_exp_f32 v34, v34
    buffer_load_dwordx4 v1, s[20:23], m0 offen sc1 lds
    v_exp_f32 v35, v35
    v_cvt_pk_bf16_f32 v80, v32, v33
    v_cvt_pk_bf16_f32 v81, v34, v35
    v_mfma_f32_32x32x16_bf16 v[48:63], v[92:95], v[4:7], v[16:31]
    s_mov_b64 exec, s[40:41]
    ds_read_b128 v[112:115], v14 offset:12800
    ds_read_b128 v[116:119], v14 offset:13440
    s_mov_b64 exec, -1
    v_exp_f32 v36, v36
    v_exp_f32 v37, v37
    v_exp_f32 v38, v38
    s_add_u32 m0, m0, 0x2000
    v_exp_f32 v39, v39
    buffer_load_dwordx4 v1, s[20:23], m0 offen sc1 lds
    v_cvt_pk_bf16_f32 v82, v36, v37
    v_cvt_pk_bf16_f32 v83, v38, v39
    v_mfma_f32_32x32x16_bf16 v[48:63], v[100:103], v[8:11], v[48:63]
    v_exp_f32 v40, v40
    v_exp_f32 v41, v41
    v_exp_f32 v42, v42
    v_exp_f32 v43, v43
    v_cvt_pk_bf16_f32 v84, v40, v41
    v_cvt_pk_bf16_f32 v85, v42, v43
    v_mfma_f32_32x32x16_bf16 v[64:79], v[104:107], v[80:83], v[64:79]
    s_add_u32 m0, m0, 0x2000
    v_exp_f32 v44, v44
    buffer_load_dwordx4 v1, s[20:23], m0 offen sc1 lds
    v_exp_f32 v45, v45
    v_exp_f32 v46, v46
    v_exp_f32 v47, v47
    v_cvt_pk_bf16_f32 v86, v44, v45
    v_cvt_pk_bf16_f32 v87, v46, v47
    s_waitcnt lgkmcnt(0)
    ds_read_b128 v[92:95], v12 offset:17920
    ds_read_b64 v[100:101], v13 offset:17920
    v_mfma_f32_32x32x16_bf16 v[64:79], v[108:111], v[84:87], v[64:79]
    v_exp_f32 v48, v48
    v_exp_f32 v49, v49
    v_exp_f32 v50, v50
    v_exp_f32 v51, v51
    v_cvt_pk_bf16_f32 v80, v48, v49
    v_cvt_pk_bf16_f32 v81, v50, v51
    v_mfma_f32_32x32x16_bf16 v[32:47], v[88:91], v[4:7], v[16:31]
    s_mov_b64 exec, s[40:41]
    ds_read_b128 v[104:107], v14 offset:15360
    ds_read_b128 v[108:111], v14 offset:16000
    s_mov_b64 exec, -1
    v_exp_f32 v52, v52
    v_exp_f32 v53, v53
    v_exp_f32 v54, v54
    v_exp_f32 v55, v55
    v_cvt_pk_bf16_f32 v82, v52, v53
    v_cvt_pk_bf16_f32 v83, v54, v55
    v_mfma_f32_32x32x16_bf16 v[32:47], v[96:99], v[8:11], v[32:47]
    v_exp_f32 v56, v56
    v_exp_f32 v57, v57
    v_exp_f32 v58, v58
    v_exp_f32 v59, v59
    v_cvt_pk_bf16_f32 v84, v56, v57
    v_cvt_pk_bf16_f32 v85, v58, v59
    v_mfma_f32_32x32x16_bf16 v[64:79], v[112:115], v[80:83], v[64:79]
    v_exp_f32 v60, v60
    v_exp_f32 v61, v61
    v_exp_f32 v62, v62
    v_exp_f32 v63, v63
    v_cvt_pk_bf16_f32 v86, v60, v61
    v_cvt_pk_bf16_f32 v87, v62, v63
    s_setprio 0
    s_waitcnt lgkmcnt(0)
    ds_read_b128 v[88:91], v12 offset:20480
    ds_read_b64 v[96:97], v13 offset:20480
    v_mfma_f32_32x32x16_bf16 v[64:79], v[116:119], v[84:87], v[64:79]
    v_exp_f32 v32, v32
    v_exp_f32 v33, v33
    v_exp_f32 v34, v34
    v_exp_f32 v35, v35
    v_cvt_pk_bf16_f32 v80, v32, v33
    v_cvt_pk_bf16_f32 v81, v34, v35
    v_mfma_f32_32x32x16_bf16 v[48:63], v[92:95], v[4:7], v[16:31]
    s_mov_b64 exec, s[40:41]
    ds_read_b128 v[112:115], v14 offset:17920
    ds_read_b128 v[116:119], v14 offset:18560
    s_mov_b64 exec, -1
    v_exp_f32 v36, v36
    v_exp_f32 v37, v37
    v_exp_f32 v38, v38
    v_exp_f32 v39, v39
    v_cvt_pk_bf16_f32 v82, v36, v37
    v_cvt_pk_bf16_f32 v83, v38, v39
    v_mfma_f32_32x32x16_bf16 v[48:63], v[100:103], v[8:11], v[48:63]
    v_exp_f32 v40, v40
    v_exp_f32 v41, v41
    v_exp_f32 v42, v42
    v_exp_f32 v43, v43
    v_cvt_pk_bf16_f32 v84, v40, v41
    v_cvt_pk_bf16_f32 v85, v42, v43
    v_mfma_f32_32x32x16_bf16 v[64:79], v[104:107], v[80:83], v[64:79]
    v_exp_f32 v44, v44
    v_exp_f32 v45, v45
    v_exp_f32 v46, v46
    v_exp_f32 v47, v47
    v_cvt_pk_bf16_f32 v86, v44, v45
    v_cvt_pk_bf16_f32 v87, v46, v47
    s_waitcnt lgkmcnt(0)
    ds_read_b128 v[92:95], v12 offset:23040
    ds_read_b64 v[100:101], v13 offset:23040
    v_mfma_f32_32x32x16_bf16 v[64:79], v[108:111], v[84:87], v[64:79]
    v_exp_f32 v48, v48
    v_exp_f32 v49, v49
    v_exp_f32 v50, v50
    v_exp_f32 v51, v51
    v_cvt_pk_bf16_f32 v80, v48, v49
    v_cvt_pk_bf16_f32 v81, v50, v51
    v_mfma_f32_32x32x16_bf16 v[32:47], v[88:91], v[4:7], v[16:31]
    s_mov_b64 exec, s[40:41]
    ds_read_b128 v[104:107], v14 offset:20480
    ds_read_b128 v[108:111], v14 offset:21120
    s_mov_b64 exec, -1
    v_exp_f32 v52, v52
    v_exp_f32 v53, v53
    v_exp_f32 v54, v54
    v_exp_f32 v55, v55
    v_cvt_pk_bf16_f32 v82, v52, v53
    v_cvt_pk_bf16_f32 v83, v54, v55
    v_mfma_f32_32x32x16_bf16 v[32:47], v[96:99], v[8:11], v[32:47]
    v_add_u32 v12, 20480, v12
    v_add_u32 v13, 20480, v13
    v_add_u32 v14, 20480, v14
    v_exp_f32 v56, v56
    v_exp_f32 v57, v57
    v_exp_f32 v58, v58
    v_exp_f32 v59, v59
    v_cvt_pk_bf16_f32 v84, v56, v57
    v_cvt_pk_bf16_f32 v85, v58, v59
    v_mfma_f32_32x32x16_bf16 v[64:79], v[112:115], v[80:83], v[64:79]
    v_exp_f32 v60, v60
    v_exp_f32 v61, v61
    v_exp_f32 v62, v62
    v_exp_f32 v63, v63
    v_cvt_pk_bf16_f32 v86, v60, v61
    v_cvt_pk_bf16_f32 v87, v62, v63
    s_waitcnt vmcnt(0)
    s_barrier
    s_mov_b32 s42, 1
    s_add_u32 s39, s43, 2
    s_branch k2_disp
.p2align 6
k2_loop:
    s_waitcnt lgkmcnt(0)
    ds_read_b128 v[88:91], v12 offset:5120
    ds_read_b64 v[96:97], v13 offset:5120
    v_mfma_f32_32x32x16_bf16 v[64:79], v[116:119], v[84:87], v[64:79]
    v_exp_f32 v32, v32
    v_exp_f32 v33, v33
    v_exp_f32 v34, v34
    v_exp_f32 v35, v35
    v_cvt_pk_bf16_f32 v80, v32, v33
    v_cvt_pk_bf16_f32 v81, v34, v35
    v_mfma_f32_32x32x16_bf16 v[48:63], v[92:95], v[4:7], v[16:31]
    s_mov_b64 exec, s[40:41]
    ds_read_b128 v[112:115], v14 offset:2560
    ds_read_b128 v[116:119], v14 offset:3200
    s_mov_b64 exec, -1
    v_exp_f32 v36, v36
    v_exp_f32 v37, v37
    v_exp_f32 v38, v38
    v_exp_f32 v39, v39
    v_cvt_pk_bf16_f32 v82, v36, v37
    v_cvt_pk_bf16_f32 v83, v38, v39
    v_mfma_f32_32x32x16_bf16 v[48:63], v[100:103], v[8:11], v[48:63]
    v_exp_f32 v40, v40
    v_exp_f32 v41, v41
    v_exp_f32 v42, v42
    v_exp_f32 v43, v43
    v_cvt_pk_bf16_f32 v84, v40, v41
    v_cvt_pk_bf16_f32 v85, v42, v43
    v_mfma_f32_32x32x16_bf16 v[64:79], v[104:107], v[80:83], v[64:79]
    v_exp_f32 v44, v44
    v_exp_f32 v45, v45
    v_exp_f32 v46, v46
    v_exp_f32 v47, v47
    v_cvt_pk_bf16_f32 v86, v44, v45
    v_cvt_pk_bf16_f32 v87, v46, v47
    s_waitcnt lgkmcnt(0)
    ds_read_b128 v[92:95], v12 offset:7680
    ds_read_b64 v[100:101], v13 offset:7680
    v_mfma_f32_32x32x16_bf16 v[64:79], v[108:111], v[84:87], v[64:79]
    v_exp_f32 v48, v48
    v_exp_f32 v49, v49
    v_exp_f32 v50, v50
    v_exp_f32 v51, v51
    v_cvt_pk_bf16_f32 v80, v48, v49
    v_cvt_pk_bf16_f32 v81, v50, v51
    v_mfma_f32_32x32x16_bf16 v[32:47], v[88:91], v[4:7], v[16:31]
    s_mov_b64 exec, s[40:41]
    ds_read_b128 v[104:107], v14 offset:5120
    ds_read_b128 v[108:111], v14 offset:5760
    s_mov_b64 exec, -1
    v_exp_f32 v52, v52
    v_exp_f32 v53, v53
    v_exp_f32 v54, v54
    v_exp_f32 v55, v55
    v_cvt_pk_bf16_f32 v82, v52, v53
    v_cvt_pk_bf16_f32 v83, v54, v55
    v_mfma_f32_32x32x16_bf16 v[32:47], v[96:99], v[8:11], v[32:47]
    v_exp_f32 v56, v56
    v_exp_f32 v57, v57
    v_exp_f32 v58, v58
    v_exp_f32 v59, v59
    v_cvt_pk_bf16_f32 v84, v56, v57
    v_cvt_pk_bf16_f32 v85, v58, v59
    v_mfma_f32_32x32x16_bf16 v[64:79], v[112:115], v[80:83], v[64:79]
    v_exp_f32 v60, v60
    v_exp_f32 v61, v61
    v_exp_f32 v62, v62
    v_exp_f32 v63, v63
    v_cvt_pk_bf16_f32 v86, v60, v61
    v_cvt_pk_bf16_f32 v87, v62, v63
    s_waitcnt lgkmcnt(0)
    ds_read_b128 v[88:91], v12 offset:10240
    ds_read_b64 v[96:97], v13 offset:10240
    v_mfma_f32_32x32x16_bf16 v[64:79], v[116:119], v[84:87], v[64:79]
    v_exp_f32 v32, v32
    v_exp_f32 v33, v33
    v_exp_f32 v34, v34
    v_exp_f32 v35, v35
    v_cvt_pk_bf16_f32 v80, v32, v33
    v_cvt_pk_bf16_f32 v81, v34, v35
    v_mfma_f32_32x32x16_bf16 v[48:63], v[92:95], v[4:7], v[16:31]
    s_mov_b64 exec, s[40:41]
    ds_read_b128 v[112:115], v14 offset:7680
    ds_read_b128 v[116:119], v14 offset:8320
    s_mov_b64 exec, -1
    v_exp_f32 v36, v36
    v_exp_f32 v37, v37
    v_exp_f32 v38, v38
    v_exp_f32 v39, v39
    v_cvt_pk_bf16_f32 v82, v36, v37
    v_cvt_pk_bf16_f32 v83, v38, v39
    v_mfma_f32_32x32x16_bf16 v[48:63], v[100:103], v[8:11], v[48:63]
    v_exp_f32 v40, v40
    v_exp_f32 v41, v41
    v_exp_f32 v42, v42
    v_exp_f32 v43, v43
    v_cvt_pk_bf16_f32 v84, v40, v41
    v_cvt_pk_bf16_f32 v85, v42, v43
    v_mfma_f32_32x32x16_bf16 v[64:79], v[104:107], v[80:83], v[64:79]
    v_exp_f32 v44, v44
    v_exp_f32 v45, v45
    v_exp_f32 v46, v46
    v_exp_f32 v47, v47
    v_cvt_pk_bf16_f32 v86, v44, v45
    v_cvt_pk_bf16_f32 v87, v46, v47
    s_waitcnt lgkmcnt(0)
    ds_read_b128 v[92:95], v12 offset:12800
    ds_read_b64 v[100:101], v13 offset:12800
    v_mfma_f32_32x32x16_bf16 v[64:79], v[108:111], v[84:87], v[64:79]
    v_exp_f32 v48, v48
    v_exp_f32 v49, v49
    v_exp_f32 v50, v50
    v_exp_f32 v51, v51
    v_cvt_pk_bf16_f32 v80, v48, v49
    v_cvt_pk_bf16_f32 v81, v50, v51
    v_mfma_f32_32x32x16_bf16 v[32:47], v[88:91], v[4:7], v[16:31]
    s_mov_b64 exec, s[40:41]
    ds_read_b128 v[104:107], v14 offset:10240
    ds_read_b128 v[108:111], v14 offset:10880
    s_mov_b64 exec, -1
    v_exp_f32 v52, v52
    v_exp_f32 v53, v53
    v_exp_f32 v54, v54
    v_exp_f32 v55, v55
    v_cvt_pk_bf16_f32 v82, v52, v53
    v_cvt_pk_bf16_f32 v83, v54, v55
    v_mfma_f32_32x32x16_bf16 v[32:47], v[96:99], v[8:11], v[32:47]
    v_exp_f32 v56, v56
    v_exp_f32 v57, v57
    v_exp_f32 v58, v58
    v_exp_f32 v59, v59
    v_cvt_pk_bf16_f32 v84, v56, v57
    v_cvt_pk_bf16_f32 v85, v58, v59
    v_mfma_f32_32x32x16_bf16 v[64:79], v[112:115], v[80:83], v[64:79]
    v_exp_f32 v60, v60
    v_exp_f32 v61, v61
    v_exp_f32 v62, v62
    v_exp_f32 v63, v63
    v_cvt_pk_bf16_f32 v86, v60, v61
    v_cvt_pk_bf16_f32 v87, v62, v63
    s_waitcnt lgkmcnt(0)
    ds_read_b128 v[88:91], v12 offset:15360
    ds_read_b64 v[96:97], v13 offset:15360
    v_mfma_f32_32x32x16_bf16 v[64:79], v[116:119], v[84:87], v[64:79]
    v_exp_f32 v32, v32
    v_exp_f32 v33, v33
    v_exp_f32 v34, v34
    v_exp_f32 v35, v35
    v_cvt_pk_bf16_f32 v80, v32, v33
    v_cvt_pk_bf16_f32 v81, v34, v35
    v_mfma_f32_32x32x16_bf16 v[48:63], v[92:95], v[4:7], v[16:31]
    s_mov_b64 exec, s[40:41]
    ds_read_b128 v[112:115], v14 offset:12800
    ds_read_b128 v[116:119], v14 offset:13440
    s_mov_b64 exec, -1
    v_exp_f32 v36, v36
    v_exp_f32 v37, v37
    v_exp_f32 v38, v38
    v_exp_f32 v39, v39
    v_cvt_pk_bf16_f32 v82, v36, v37
    v_cvt_pk_bf16_f32 v83, v38, v39
    v_mfma_f32_32x32x16_bf16 v[48:63], v[100:103], v[8:11], v[48:63]
    v_exp_f32 v40, v40
    v_exp_f32 v41, v41
    v_exp_f32 v42, v42
    v_exp_f32 v43, v43
    v_cvt_pk_bf16_f32 v84, v40, v41
    v_cvt_pk_bf16_f32 v85, v42, v43
    v_mfma_f32_32x32x16_bf16 v[64:79], v[104:107], v[80:83], v[64:79]
    v_exp_f32 v44, v44
    v_exp_f32 v45, v45
    v_exp_f32 v46, v46
    v_exp_f32 v47, v47
    v_cvt_pk_bf16_f32 v86, v44, v45
    v_cvt_pk_bf16_f32 v87, v46, v47
    s_waitcnt lgkmcnt(0)
    ds_read_b128 v[92:95], v12 offset:17920
    ds_read_b64 v[100:101], v13 offset:17920
    v_mfma_f32_32x32x16_bf16 v[64:79], v[108:111], v[84:87], v[64:79]
    v_exp_f32 v48, v48
    v_exp_f32 v49, v49
    v_exp_f32 v50, v50
    v_exp_f32 v51, v51
    v_cvt_pk_bf16_f32 v80, v48, v49
    v_cvt_pk_bf16_f32 v81, v50, v51
    v_mfma_f32_32x32x16_bf16 v[32:47], v[88:91], v[4:7], v[16:31]
    s_mov_b64 exec, s[40:41]
    ds_read_b128 v[104:107], v14 offset:15360
    ds_read_b128 v[108:111], v14 offset:16000
    s_mov_b64 exec, -1
    v_exp_f32 v52, v52
    v_exp_f32 v53, v53
    v_exp_f32 v54, v54
    v_exp_f32 v55, v55
    v_cvt_pk_bf16_f32 v82, v52, v53
    v_cvt_pk_bf16_f32 v83, v54, v55
    v_mfma_f32_32x32x16_bf16 v[32:47], v[96:99], v[8:11], v[32:47]
    v_exp_f32 v56, v56
    v_exp_f32 v57, v57
    v_exp_f32 v58, v58
    v_exp_f32 v59, v59
    v_cvt_pk_bf16_f32 v84, v56, v57
    v_cvt_pk_bf16_f32 v85, v58, v59
    v_mfma_f32_32x32x16_bf16 v[64:79], v[112:115], v[80:83], v[64:79]
    v_exp_f32 v60, v60
    v_exp_f32 v61, v61
    v_exp_f32 v62, v62
    v_exp_f32 v63, v63
    v_cvt_pk_bf16_f32 v86, v60, v61
    v_cvt_pk_bf16_f32 v87, v62, v63
    s_waitcnt lgkmcnt(0)
    ds_read_b128 v[88:91], v12 offset:20480
    ds_read_b64 v[96:97], v13 offset:20480
    v_mfma_f32_32x32x16_bf16 v[64:79], v[116:119], v[84:87], v[64:79]
    v_exp_f32 v32, v32
    v_exp_f32 v33, v33
    v_exp_f32 v34, v34
    v_exp_f32 v35, v35
    v_cvt_pk_bf16_f32 v80, v32, v33
    v_cvt_pk_bf16_f32 v81, v34, v35
    v_mfma_f32_32x32x16_bf16 v[48:63], v[92:95], v[4:7], v[16:31]
    s_mov_b64 exec, s[40:41]
    ds_read_b128 v[112:115], v14 offset:17920
    ds_read_b128 v[116:119], v14 offset:18560
    s_mov_b64 exec, -1
    v_exp_f32 v36, v36
    v_exp_f32 v37, v37
    v_exp_f32 v38, v38
    v_exp_f32 v39, v39
    v_cvt_pk_bf16_f32 v82, v36, v37
    v_cvt_pk_bf16_f32 v83, v38, v39
    v_mfma_f32_32x32x16_bf16 v[48:63], v[100:103], v[8:11], v[48:63]
    v_exp_f32 v40, v40
    v_exp_f32 v41, v41
    v_exp_f32 v42, v42
    v_exp_f32 v43, v43
    v_cvt_pk_bf16_f32 v84, v40, v41
    v_cvt_pk_bf16_f32 v85, v42, v43
    v_mfma_f32_32x32x16_bf16 v[64:79], v[104:107], v[80:83], v[64:79]
    v_exp_f32 v44, v44
    v_exp_f32 v45, v45
    v_exp_f32 v46, v46
    v_exp_f32 v47, v47
    v_cvt_pk_bf16_f32 v86, v44, v45
    v_cvt_pk_bf16_f32 v87, v46, v47
    s_waitcnt lgkmcnt(0)
    ds_read_b128 v[92:95], v12 offset:23040
    ds_read_b64 v[100:101], v13 offset:23040
    v_mfma_f32_32x32x16_bf16 v[64:79], v[108:111], v[84:87], v[64:79]
    v_exp_f32 v48, v48
    v_exp_f32 v49, v49
    v_exp_f32 v50, v50
    v_exp_f32 v51, v51
    v_cvt_pk_bf16_f32 v80, v48, v49
    v_cvt_pk_bf16_f32 v81, v50, v51
    v_mfma_f32_32x32x16_bf16 v[32:47], v[88:91], v[4:7], v[16:31]
    s_mov_b64 exec, s[40:41]
    ds_read_b128 v[104:107], v14 offset:20480
    ds_read_b128 v[108:111], v14 offset:21120
    s_mov_b64 exec, -1
    v_exp_f32 v52, v52
    v_exp_f32 v53, v53
    v_exp_f32 v54, v54
    v_exp_f32 v55, v55
    v_cvt_pk_bf16_f32 v82, v52, v53
    v_cvt_pk_bf16_f32 v83, v54, v55
    v_mfma_f32_32x32x16_bf16 v[32:47], v[96:99], v[8:11], v[32:47]
    v_add_u32 v12, 20480, v12
    v_add_u32 v13, 20480, v13
    v_add_u32 v14, 20480, v14
    v_exp_f32 v56, v56
    v_exp_f32 v57, v57
    v_exp_f32 v58, v58
    v_exp_f32 v59, v59
    v_cvt_pk_bf16_f32 v84, v56, v57
    v_cvt_pk_bf16_f32 v85, v58, v59
    v_mfma_f32_32x32x16_bf16 v[64:79], v[112:115], v[80:83], v[64:79]
    v_exp_f32 v60, v60
    v_exp_f32 v61, v61
    v_exp_f32 v62, v62
    v_exp_f32 v63, v63
    v_cvt_pk_bf16_f32 v86, v60, v61
    v_cvt_pk_bf16_f32 v87, v62, v63
    s_add_u32 s42, s42, 1
k2_disp:
    s_cmp_eq_u32 s42, s43
    s_cbranch_scc1 k2_sideld
    s_cmp_eq_u32 s42, s39
    s_cbranch_scc1 k2_side
k2_cont:
    s_setprio 3
    s_cmp_eq_u32 s42, 1
    s_cbranch_scc1 k2_loop
    s_cmp_eq_u32 s42, 5
    s_cbranch_scc1 k2_blk5
    s_setprio 2
    s_cmp_eq_u32 s42, 2
    s_cbranch_scc1 k2_loop
    s_cmp_eq_u32 s42, 6
    s_cbranch_scc1 k2_blk6
    s_setprio 1
    s_cmp_eq_u32 s42, 3
    s_cbranch_scc1 k2_loop
    s_setprio 0
    s_cmp_eq_u32 s42, 4
    s_cbranch_scc1 k2_loop
    s_setprio 3
    s_sub_u32 m0, s10, 0x2000
    s_mul_i32 s7, s29, 122880
    s_add_u32 s7, s7, 3432448
    s_add_u32 s72, s8, s7
    s_addc_u32 s73, s9, 0
    s_mov_b32 s74, 0x28000
    s_mov_b32 s75, 0x20000
    s_add_u32 s68, s8, 0x350000
    s_addc_u32 s69, s9, 0
    s_mov_b32 s70, 0x1e0000
    s_mov_b32 s71, 0x20000
    s_lshr_b32 s53, s2, 3
    s_lshl_b32 s53, s53, 3
    s_add_u32 s53, s53, s5
    s_mul_i32 s53, s53, 7680
    s_sub_u32 s53, s53, 1024
    s_cmp_lg_u32 s5, 0
    s_cbranch_scc1 k2_fsok
    s_mov_b32 s38, 0
k2_fschk:
    s_waitcnt vmcnt(0)
    v_min3_u32 v168, v168, v169, v170
    v_min_u32 v168, v168, v171
    v_cmp_ne_u32 vcc, 0, v168
    s_cmp_eq_u64 vcc, -1
    s_cbranch_scc1 k2_fsok
    s_sleep 1
    buffer_load_dwordx4 v[168:171], v1, s[16:19], s37 offen sc1
    s_add_u32 s38, s38, 1
    s_cmp_lt_u32 s38, 200000
    s_cbranch_scc1 k2_fschk
k2_fsok:
    s_barrier
    s_waitcnt lgkmcnt(0)
    ds_read_b128 v[88:91], v12 offset:5120
    ds_read_b64 v[96:97], v13 offset:5120
    v_mfma_f32_32x32x16_bf16 v[64:79], v[116:119], v[84:87], v[64:79]
    v_exp_f32 v32, v32
    s_add_u32 m0, s10, 102400
    v_exp_f32 v33, v33
    buffer_load_dwordx4 v1, s[72:75], m0 offen sc1 lds
    v_exp_f32 v34, v34
    v_exp_f32 v35, v35
    v_cvt_pk_bf16_f32 v80, v32, v33
    v_cvt_pk_bf16_f32 v81, v34, v35
    v_mfma_f32_32x32x16_bf16 v[48:63], v[92:95], v[4:7], v[16:31]
    s_mov_b64 exec, s[40:41]
    ds_read_b128 v[112:115], v14 offset:2560
    ds_read_b128 v[116:119], v14 offset:3200
    s_mov_b64 exec, -1
    v_exp_f32 v36, v36
    s_add_u32 m0, m0, 0x2000
    v_exp_f32 v37, v37
    buffer_load_dwordx4 v1, s[72:75], m0 offen sc1 lds
    v_exp_f32 v38, v38
    v_exp_f32 v39, v39
    v_cvt_pk_bf16_f32 v82, v36, v37
    v_cvt_pk_bf16_f32 v83, v38, v39
    v_mfma_f32_32x32x16_bf16 v[48:63], v[100:103], v[8:11], v[48:63]
    v_exp_f32 v40, v40
    s_add_u32 m0, m0, 0x2000
    v_exp_f32 v41, v41
    buffer_load_dwordx4 v1, s[72:75], m0 offen sc1 lds
    v_exp_f32 v42, v42
    v_exp_f32 v43, v43
    v_cvt_pk_bf16_f32 v84, v40, v41
    v_cvt_pk_bf16_f32 v85, v42, v43
    v_mfma_f32_32x32x16_bf16 v[64:79], v[104:107], v[80:83], v[64:79]
    v_exp_f32 v44, v44
    s_add_u32 m0, m0, 0x2000
    v_exp_f32 v45, v45
    buffer_load_dwordx4 v1, s[72:75], m0 offen sc1 lds
    v_exp_f32 v46, v46
    v_exp_f32 v47, v47
    v_cvt_pk_bf16_f32 v86, v44, v45
    v_cvt_pk_bf16_f32 v87, v46, v47
    s_waitcnt lgkmcnt(0)
    ds_read_b128 v[92:95], v12 offset:7680
    ds_read_b64 v[100:101], v13 offset:7680
    v_mfma_f32_32x32x16_bf16 v[64:79], v[108:111], v[84:87], v[64:79]
    v_exp_f32 v48, v48
    s_add_u32 m0, m0, 0x2000
    v_exp_f32 v49, v49
    buffer_load_dwordx4 v1, s[72:75], m0 offen sc1 lds
    v_exp_f32 v50, v50
    v_exp_f32 v51, v51
    v_cvt_pk_bf16_f32 v80, v48, v49
    v_cvt_pk_bf16_f32 v81, v50, v51
    v_mfma_f32_32x32x16_bf16 v[32:47], v[88:91], v[4:7], v[16:31]
    s_mov_b64 exec, s[40:41]
    ds_read_b128 v[104:107], v14 offset:5120
    ds_read_b128 v[108:111], v14 offset:5760
    s_mov_b64 exec, -1
    v_exp_f32 v52, v52
    s_add_u32 s53, s53, 1024
    v_exp_f32 v53, v53
    buffer_load_dwordx4 v[172:175], v1, s[68:71], s53 offen sc1
    v_exp_f32 v54, v54
    v_exp_f32 v55, v55
    v_cvt_pk_bf16_f32 v82, v52, v53
    v_cvt_pk_bf16_f32 v83, v54, v55
    v_mfma_f32_32x32x16_bf16 v[32:47], v[96:99], v[8:11], v[32:47]
    v_exp_f32 v56, v56
    s_add_u32 s53, s53, 1024
    v_exp_f32 v57, v57
    buffer_load_dwordx4 v[172:175], v1, s[68:71], s53 offen sc1
    v_exp_f32 v58, v58
    v_exp_f32 v59, v59
    v_cvt_pk_bf16_f32 v84, v56, v57
    v_cvt_pk_bf16_f32 v85, v58, v59
    v_mfma_f32_32x32x16_bf16 v[64:79], v[112:115], v[80:83], v[64:79]
    v_exp_f32 v60, v60
    s_add_u32 s53, s53, 1024
    v_exp_f32 v61, v61
    buffer_load_dwordx4 v[172:175], v1, s[68:71], s53 offen sc1
    v_exp_f32 v62, v62
    v_exp_f32 v63, v63
    v_cvt_pk_bf16_f32 v86, v60, v61
    v_cvt_pk_bf16_f32 v87, v62, v63
    s_setprio 2
    s_waitcnt lgkmcnt(0)
    ds_read_b128 v[88:91], v12 offset:10240
    ds_read_b64 v[96:97], v13 offset:10240
    v_mfma_f32_32x32x16_bf16 v[64:79], v[116:119], v[84:87], v[64:79]
    v_exp_f32 v32, v32
    s_add_u32 s53, s53, 1024
    v_exp_f32 v33, v33
    buffer_load_dwordx4 v[172:175], v1, s[68:71], s53 offen sc1
    v_exp_f32 v34, v34
    v_exp_f32 v35, v35
    v_cvt_pk_bf16_f32 v80, v32, v33
    v_cvt_pk_bf16_f32 v81, v34, v35
    v_mfma_f32_32x32x16_bf16 v[48:63], v[92:95], v[4:7], v[16:31]
    s_mov_b64 exec, s[40:41]
    ds_read_b128 v[112:115], v14 offset:7680
    ds_read_b128 v[116:119], v14 offset:8320
    s_mov_b64 exec, -1
    v_exp_f32 v36, v36
    s_add_u32 s53, s53, 1024
    v_exp_f32 v37, v37
    buffer_load_dwordx4 v[172:175], v1, s[68:71], s53 offen sc1
    v_exp_f32 v38, v38
    v_exp_f32 v39, v39
    v_cvt_pk_bf16_f32 v82, v36, v37
    v_cvt_pk_bf16_f32 v83, v38, v39
    v_mfma_f32_32x32x16_bf16 v[48:63], v[100:103], v[8:11], v[48:63]
    v_exp_f32 v40, v40
    s_add_u32 s53, s53, 1024
    v_exp_f32 v41, v41
    buffer_load_dwordx4 v[172:175], v1, s[68:71], s53 offen sc1
    v_exp_f32 v42, v42
    v_exp_f32 v43, v43
    v_cvt_pk_bf16_f32 v84, v40, v41
    v_cvt_pk_bf16_f32 v85, v42, v43
    v_mfma_f32_32x32x16_bf16 v[64:79], v[104:107], v[80:83], v[64:79]
    v_exp_f32 v44, v44
    s_add_u32 s53, s53, 1024
    v_exp_f32 v45, v45
    buffer_load_dwordx4 v[172:175], v1, s[68:71], s53 offen sc1
    v_exp_f32 v46, v46
    v_exp_f32 v47, v47
    v_cvt_pk_bf16_f32 v86, v44, v45
    v_cvt_pk_bf16_f32 v87, v46, v47
    s_waitcnt lgkmcnt(0)
    ds_read_b128 v[92:95], v12 offset:12800
    ds_read_b64 v[100:101], v13 offset:12800
    v_mfma_f32_32x32x16_bf16 v[64:79], v[108:111], v[84:87], v[64:79]
    v_exp_f32 v48, v48
    s_add_u32 s53, s53, 1024
    v_exp_f32 v49, v49
    buffer_load_dwordx4 v[172:175], v1, s[68:71], s53 offen sc1
    v_exp_f32 v50, v50
    v_exp_f32 v51, v51
    v_cvt_pk_bf16_f32 v80, v48, v49
    v_cvt_pk_bf16_f32 v81, v50, v51
    v_mfma_f32_32x32x16_bf16 v[32:47], v[88:91], v[4:7], v[16:31]
    s_mov_b64 exec, s[40:41]
    ds_read_b128 v[104:107], v14 offset:10240
    ds_read_b128 v[108:111], v14 offset:10880
    s_mov_b64 exec, -1
    v_exp_f32 v52, v52
    v_exp_f32 v53, v53
    v_exp_f32 v54, v54
    v_exp_f32 v55, v55
    v_cvt_pk_bf16_f32 v82, v52, v53
    v_cvt_pk_bf16_f32 v83, v54, v55
    v_mfma_f32_32x32x16_bf16 v[32:47], v[96:99], v[8:11], v[32:47]
    v_exp_f32 v56, v56
    v_exp_f32 v57, v57
    v_exp_f32 v58, v58
    v_exp_f32 v59, v59
    v_cvt_pk_bf16_f32 v84, v56, v57
    v_cvt_pk_bf16_f32 v85, v58, v59
    v_mfma_f32_32x32x16_bf16 v[64:79], v[112:115], v[80:83], v[64:79]
    v_exp_f32 v60, v60
    v_exp_f32 v61, v61
    v_exp_f32 v62, v62
    v_exp_f32 v63, v63
    v_cvt_pk_bf16_f32 v86, v60, v61
    v_cvt_pk_bf16_f32 v87, v62, v63
    s_setprio 1
    s_waitcnt lgkmcnt(0)
    ds_read_b128 v[88:91], v12 offset:15360
    ds_read_b64 v[96:97], v13 offset:15360
    v_mfma_f32_32x32x16_bf16 v[64:79], v[116:119], v[84:87], v[64:79]
    v_exp_f32 v32, v32
    v_exp_f32 v33, v33
    v_exp_f32 v34, v34
    v_exp_f32 v35, v35
    v_cvt_pk_bf16_f32 v80, v32, v33
    v_cvt_pk_bf16_f32 v81, v34, v35
    v_mfma_f32_32x32x16_bf16 v[48:63], v[92:95], v[4:7], v[16:31]
    s_mov_b64 exec, s[40:41]
    ds_read_b128 v[112:115], v14 offset:12800
    ds_read_b128 v[116:119], v14 offset:13440
    s_mov_b64 exec, -1
    v_exp_f32 v36, v36
    v_exp_f32 v37, v37
    v_exp_f32 v38, v38
    v_exp_f32 v39, v39
    v_cvt_pk_bf16_f32 v82, v36, v37
    v_cvt_pk_bf16_f32 v83, v38, v39
    v_mfma_f32_32x32x16_bf16 v[48:63], v[100:103], v[8:11], v[48:63]
    v_exp_f32 v40, v40
    v_exp_f32 v41, v41
    v_exp_f32 v42, v42
    v_exp_f32 v43, v43
    v_cvt_pk_bf16_f32 v84, v40, v41
    v_cvt_pk_bf16_f32 v85, v42, v43
    v_mfma_f32_32x32x16_bf16 v[64:79], v[104:107], v[80:83], v[64:79]
    v_exp_f32 v44, v44
    v_exp_f32 v45, v45
    v_exp_f32 v46, v46
    v_exp_f32 v47, v47
    v_cvt_pk_bf16_f32 v86, v44, v45
    v_cvt_pk_bf16_f32 v87, v46, v47
    s_waitcnt lgkmcnt(0)
    ds_read_b128 v[92:95], v12 offset:17920
    ds_read_b64 v[100:101], v13 offset:17920
    v_mfma_f32_32x32x16_bf16 v[64:79], v[108:111], v[84:87], v[64:79]
    v_exp_f32 v48, v48
    v_exp_f32 v49, v49
    v_exp_f32 v50, v50
    v_exp_f32 v51, v51
    v_cvt_pk_bf16_f32 v80, v48, v49
    v_cvt_pk_bf16_f32 v81, v50, v51
    v_mfma_f32_32x32x16_bf16 v[32:47], v[88:91], v[4:7], v[16:31]
    s_mov_b64 exec, s[40:41]
    ds_read_b128 v[104:107], v14 offset:15360
    ds_read_b128 v[108:111], v14 offset:16000
    s_mov_b64 exec, -1
    v_exp_f32 v52, v52
    v_exp_f32 v53, v53
    v_exp_f32 v54, v54
    v_exp_f32 v55, v55
    v_cvt_pk_bf16_f32 v82, v52, v53
    v_cvt_pk_bf16_f32 v83, v54, v55
    v_mfma_f32_32x32x16_bf16 v[32:47], v[96:99], v[8:11], v[32:47]
    v_exp_f32 v56, v56
    v_exp_f32 v57, v57
    v_exp_f32 v58, v58
    v_exp_f32 v59, v59
    v_cvt_pk_bf16_f32 v84, v56, v57
    v_cvt_pk_bf16_f32 v85, v58, v59
    v_mfma_f32_32x32x16_bf16 v[64:79], v[112:115], v[80:83], v[64:79]
    v_exp_f32 v60, v60
    v_exp_f32 v61, v61
    v_exp_f32 v62, v62
    v_exp_f32 v63, v63
    v_cvt_pk_bf16_f32 v86, v60, v61
    v_cvt_pk_bf16_f32 v87, v62, v63
    s_setprio 0
    s_waitcnt lgkmcnt(0)
    s_nop 0
    v_mfma_f32_32x32x16_bf16 v[64:79], v[116:119], v[84:87], v[64:79]
    v_exp_f32 v32, v32
    v_exp_f32 v33, v33
    v_exp_f32 v34, v34
    v_exp_f32 v35, v35
    v_cvt_pk_bf16_f32 v80, v32, v33
    v_cvt_pk_bf16_f32 v81, v34, v35
    v_mfma_f32_32x32x16_bf16 v[48:63], v[92:95], v[4:7], v[16:31]
    s_mov_b64 exec, s[40:41]
    ds_read_b128 v[112:115], v14 offset:17920
    ds_read_b128 v[116:119], v14 offset:18560
    s_mov_b64 exec, -1
    v_exp_f32 v36, v36
    v_exp_f32 v37, v37
    v_exp_f32 v38, v38
    v_exp_f32 v39, v39
    v_cvt_pk_bf16_f32 v82, v36, v37
    v_cvt_pk_bf16_f32 v83, v38, v39
    v_mfma_f32_32x32x16_bf16 v[48:63], v[100:103], v[8:11], v[48:63]
    v_exp_f32 v40, v40
    v_exp_f32 v41, v41
    v_exp_f32 v42, v42
    v_exp_f32 v43, v43
    v_cvt_pk_bf16_f32 v84, v40, v41
    v_cvt_pk_bf16_f32 v85, v42, v43
    v_mfma_f32_32x32x16_bf16 v[64:79], v[104:107], v[80:83], v[64:79]
    v_exp_f32 v44, v44
    v_exp_f32 v45, v45
    v_exp_f32 v46, v46
    v_exp_f32 v47, v47
    v_cvt_pk_bf16_f32 v86, v44, v45
    v_cvt_pk_bf16_f32 v87, v46, v47
    s_waitcnt lgkmcnt(0)
    s_nop 0
    v_mfma_f32_32x32x16_bf16 v[64:79], v[108:111], v[84:87], v[64:79]
    v_exp_f32 v48, v48
    v_exp_f32 v49, v49
    v_exp_f32 v50, v50
    v_exp_f32 v51, v51
    v_cvt_pk_bf16_f32 v80, v48, v49
    v_cvt_pk_bf16_f32 v81, v50, v51
    v_exp_f32 v52, v52
    v_exp_f32 v53, v53
    v_exp_f32 v54, v54
    v_exp_f32 v55, v55
    v_cvt_pk_bf16_f32 v82, v52, v53
    v_cvt_pk_bf16_f32 v83, v54, v55
    v_exp_f32 v56, v56
    v_exp_f32 v57, v57
    v_exp_f32 v58, v58
    v_exp_f32 v59, v59
    v_cvt_pk_bf16_f32 v84, v56, v57
    v_cvt_pk_bf16_f32 v85, v58, v59
    v_mfma_f32_32x32x16_bf16 v[64:79], v[112:115], v[80:83], v[64:79]
    v_exp_f32 v60, v60
    v_exp_f32 v61, v61
    v_exp_f32 v62, v62
    v_exp_f32 v63, v63
    v_cvt_pk_bf16_f32 v86, v60, v61
    v_cvt_pk_bf16_f32 v87, v62, v63
    s_nop 1
    v_mfma_f32_32x32x16_bf16 v[64:79], v[116:119], v[84:87], v[64:79]
    v_mov_b32 v15, 0xd800000
    v_mov_b32 v32, 0x7e800000
    s_nop 9
    v_cmp_nge_f32 s[36:37], v76, v15
    v_max3_f32 v33, abs(v64), abs(v65), abs(v66)
    v_max3_f32 v33, v33, abs(v67), abs(v68)
    v_max3_f32 v33, v33, abs(v69), abs(v70)
    v_max3_f32 v33, v33, abs(v71), abs(v72)
    v_max3_f32 v33, v33, abs(v73), abs(v74)
    v_max3_f32 v33, v33, abs(v75), v76
    v_cmp_nlt_f32 vcc, v33, v32
    s_nop 0
    s_or_b64 vcc, vcc, s[36:37]
    s_nop 0
    s_cbranch_vccnz k2_slow
k2_epi:
    v_rcp_f32 v32, v76
    s_mul_i32 s7, s24, 81920
    s_and_b32 s10, s6, 1
    s_lshl_b32 s10, s10, 11
    s_add_u32 s10, s7, s10
    v_lshrrev_b32 v35, 4, v2
    v_lshlrev_b32 v35, 10, v35
    v_and_b32 v34, 15, v2
    v_lshl_add_u32 v35, v34, 4, v35
    s_mul_i32 s11, s4, 20
    v_lshl_add_u32 v36, v3, 2, s11
    v_pk_mul_f32 v[64:65], v[64:65], v[32:33] op_sel_hi:[1,0]
    v_pk_mul_f32 v[66:67], v[66:67], v[32:33] op_sel_hi:[1,0]
    v_pk_mul_f32 v[68:69], v[68:69], v[32:33] op_sel_hi:[1,0]
    v_pk_mul_f32 v[70:71], v[70:71], v[32:33] op_sel_hi:[1,0]
    v_pk_mul_f32 v[72:73], v[72:73], v[32:33] op_sel_hi:[1,0]
    v_pk_mul_f32 v[74:75], v[74:75], v[32:33] op_sel_hi:[1,0]
    v_cvt_pk_bf16_f32 v80, v64, v65
    v_cvt_pk_bf16_f32 v81, v66, v67
    v_cvt_pk_bf16_f32 v82, v68, v69
    v_cvt_pk_bf16_f32 v83, v70, v71
    v_cvt_pk_bf16_f32 v84, v72, v73
    v_cvt_pk_bf16_f32 v85, v74, v75
    v_add_u32 v40, 0, v36
    v_lshrrev_b32 v41, 5, v40
    v_lshl_add_u32 v41, v41, 12, v35
    v_bfe_u32 v42, v40, 3, 2
    v_lshl_add_u32 v41, v42, 8, v41
    v_and_b32 v42, 4, v40
    v_lshl_add_u32 v41, v42, 1, v41
    v_add_u32 v44, 8, v36
    v_lshrrev_b32 v45, 5, v44
    v_lshl_add_u32 v45, v45, 12, v35
    v_bfe_u32 v46, v44, 3, 2
    v_lshl_add_u32 v45, v46, 8, v45
    v_and_b32 v46, 4, v44
    v_lshl_add_u32 v45, v46, 1, v45
    v_add_u32 v48, 16, v36
    v_lshrrev_b32 v49, 5, v48
    v_lshl_add_u32 v49, v49, 12, v35
    v_bfe_u32 v50, v48, 3, 2
    v_lshl_add_u32 v49, v50, 8, v49
    v_and_b32 v50, 4, v48
    v_lshl_add_u32 v49, v50, 1, v49
    v_lshl_add_u32 v49, v3, 30, v49
    s_cmp_eq_u32 s30, 0
    s_cbranch_scc1 adaLN_cond__grouped_kv_mqa__mixer_gmlp__prompt_kernel_sl1
    buffer_store_dwordx2 v[80:81], v41, s[12:15], s10 offen
    buffer_store_dwordx2 v[82:83], v45, s[12:15], s10 offen
    buffer_store_dwordx2 v[84:85], v49, s[12:15], s10 offen
    s_branch adaLN_cond__grouped_kv_mqa__mixer_gmlp__prompt_kernel_sd2
adaLN_cond__grouped_kv_mqa__mixer_gmlp__prompt_kernel_sl1:
    buffer_store_dwordx2 v[80:81], v41, s[12:15], s10 offen sc1
    buffer_store_dwordx2 v[82:83], v45, s[12:15], s10 offen sc1
    buffer_store_dwordx2 v[84:85], v49, s[12:15], s10 offen sc1
adaLN_cond__grouped_kv_mqa__mixer_gmlp__prompt_kernel_sd2:
    s_lshl_b32 s36, s24, 10
    s_add_u32 s36, s36, 299008
    s_lshl_b32 s37, s25, 7
    s_add_u32 s37, s37, s36
    s_load_dwordx2 s[44:45], s[0:1], 64
    s_load_dwordx2 s[46:47], s[0:1], 96
    s_cmp_ge_u32 s5, 4
    s_cbranch_scc1 k2_loader
    s_waitcnt vmcnt(0) lgkmcnt(0)
    s_barrier
    s_cmp_lg_u32 s5, 0
    s_cbranch_scc1 k2_f2done
    v_mov_b32 v10, 1
    s_mov_b64 exec, 1
    s_cmp_eq_u32 s30, 0
    s_cbranch_scc1 adaLN_cond__grouped_kv_mqa__mixer_gmlp__prompt_kernel_sl3
    buffer_store_dword v10, off, s[16:19], s37
    s_branch adaLN_cond__grouped_kv_mqa__mixer_gmlp__prompt_kernel_sd4
adaLN_cond__grouped_kv_mqa__mixer_gmlp__prompt_kernel_sl3:
    buffer_store_dword v10, off, s[16:19], s37 sc1
adaLN_cond__grouped_kv_mqa__mixer_gmlp__prompt_kernel_sd4:
    s_mov_b64 exec, -1
k2_f2done:
    v_bfe_u32 v3, v0, 4, 2
    v_and_b32 v5, 15, v0
    s_lshl_b32 s6, s24, 2
    s_add_u32 s6, s6, s5
    s_lshr_b32 s60, s6, 3
    s_mul_i32 s60, s60, 40
    s_mul_i32 s61, s25, 5
    s_add_u32 s60, s60, s61
    s_lshl_b32 s60, s60, 12
    s_bfe_u32 s61, s6, 0x20001
    s_lshl_b32 s61, s61, 10
    s_add_u32 s60, s60, s61
    s_and_b32 s61, s6, 1
    s_lshl_b32 s61, s61, 8
    s_add_u32 s60, s60, s61
    s_add_u32 s61, s60, 4096
    s_add_u32 s62, s60, 8192
    s_add_u32 s63, s60, 12288
    s_add_u32 s64, s60, 16384
    v_lshrrev_b32 v6, 1, v3
    v_lshlrev_b32 v6, 9, v6
    v_lshl_add_u32 v6, v5, 4, v6
    v_and_b32 v7, 1, v3
    v_lshl_add_u32 v6, v7, 3, v6
    s_lshl_b32 s10, s5, 10
    s_add_u32 s7, s7, s10
    s_add_u32 s52, s8, 0xf40000
    s_addc_u32 s53, s9, 0
    s_mov_b32 s54, 0x280000
    s_mov_b32 s55, 0x20000
    s_add_u32 s56, s8, 0x14c0000
    s_addc_u32 s57, s9, 0
    s_mov_b32 s58, 0x20000
    s_mov_b32 s59, 0x20000
    v_add_u32 v8, 0xf000, v1
    v_add_u32 v9, 0x1e000, v1
    ds_read_b128 v[152:155], v1 offset:40960
    ds_read_b128 v[156:159], v1 offset:41984
    ds_read_b128 v[160:163], v1 offset:43008
    ds_read_b128 v[164:167], v1 offset:44032
    ds_read_b128 v[168:171], v1 offset:45056
    ds_read_b128 v[172:175], v1 offset:46080
    ds_read_b128 v[176:179], v1 offset:47104
    ds_read_b128 v[180:183], v1 offset:48128
    ds_read_b128 v[184:187], v1 offset:49152
    ds_read_b128 v[188:191], v1 offset:50176
    v_and_b32 v10, 7, v0
    v_lshlrev_b32 v10, 7, v10
    s_mov_b32 s38, 0
    buffer_load_dword v11, v10, s[16:19], s36 offen sc1
    s_sleep 1
k2_p2:
    buffer_load_dword v12, v10, s[16:19], s36 offen sc1
    s_waitcnt vmcnt(1)
    v_cmp_ne_u32 vcc, 0, v11
    s_cmp_eq_u64 vcc, -1
    s_cbranch_scc1 k2_p2_ok
    buffer_load_dword v11, v10, s[16:19], s36 offen sc1
    s_waitcnt vmcnt(1)
    v_cmp_ne_u32 vcc, 0, v12
    s_cmp_eq_u64 vcc, -1
    s_cbranch_scc1 k2_p2_ok
    s_add_u32 s38, s38, 1
    s_cmp_lt_u32 s38, 200000
    s_cbranch_scc1 k2_p2
k2_p2_ok:
    s_add_u32 s38, s7, 32768
    buffer_load_dwordx4 v[16:19], v1, s[12:15], s38 offen sc1
    s_add_u32 s38, s7, 36864
    buffer_load_dwordx4 v[20:23], v1, s[12:15], s38 offen sc1
    s_add_u32 s38, s7, 40960
    buffer_load_dwordx4 v[24:27], v1, s[12:15], s38 offen sc1
    s_add_u32 s38, s7, 45056
    buffer_load_dwordx4 v[28:31], v1, s[12:15], s38 offen sc1
    s_add_u32 s38, s7, 49152
    buffer_load_dwordx4 v[32:35], v1, s[12:15], s38 offen sc1
    s_add_u32 s38, s7, 53248
    buffer_load_dwordx4 v[36:39], v1, s[12:15], s38 offen sc1
    s_add_u32 s38, s7, 57344
    buffer_load_dwordx4 v[40:43], v1, s[12:15], s38 offen sc1
    s_add_u32 s38, s7, 61440
    buffer_load_dwordx4 v[44:47], v1, s[12:15], s38 offen sc1
    s_add_u32 s38, s7, 65536
    buffer_load_dwordx4 v[48:51], v1, s[12:15], s38 offen sc1
    s_add_u32 s38, s7, 69632
    buffer_load_dwordx4 v[52:55], v1, s[12:15], s38 offen sc1
    s_add_u32 s38, s7, 73728
    buffer_load_dwordx4 v[56:59], v1, s[12:15], s38 offen sc1
    s_waitcnt vmcnt(10) lgkmcnt(5)
    v_mfma_f32_16x16x32_bf16 v[96:99], v[152:155], v[16:19], 0
    ds_read_b128 v[192:195], v1 offset:51200
    v_mfma_f32_16x16x32_bf16 v[100:103], v[156:159], v[16:19], 0
    ds_read_b128 v[196:199], v1 offset:52224
    v_mfma_f32_16x16x32_bf16 v[104:107], v[160:163], v[16:19], 0
    ds_read_b128 v[200:203], v1 offset:53248
    v_mfma_f32_16x16x32_bf16 v[108:111], v[164:167], v[16:19], 0
    ds_read_b128 v[204:207], v1 offset:54272
    v_mfma_f32_16x16x32_bf16 v[112:115], v[168:171], v[16:19], 0
    ds_read_b128 v[208:211], v1 offset:55296
    s_add_u32 s38, s7, 77824
    buffer_load_dwordx4 v[60:63], v1, s[12:15], s38 offen sc1
    s_waitcnt vmcnt(10) lgkmcnt(5)
    v_mfma_f32_16x16x32_bf16 v[96:99], v[172:175], v[20:23], v[96:99]
    ds_read_b128 v[152:155], v1 offset:56320
    v_mfma_f32_16x16x32_bf16 v[100:103], v[176:179], v[20:23], v[100:103]
    ds_read_b128 v[156:159], v1 offset:57344
    v_mfma_f32_16x16x32_bf16 v[104:107], v[180:183], v[20:23], v[104:107]
    ds_read_b128 v[160:163], v1 offset:58368
    v_mfma_f32_16x16x32_bf16 v[108:111], v[184:187], v[20:23], v[108:111]
    ds_read_b128 v[164:167], v1 offset:59392
    v_mfma_f32_16x16x32_bf16 v[112:115], v[188:191], v[20:23], v[112:115]
    ds_read_b128 v[168:171], v1 offset:60416
    s_add_u32 s38, s7, 0
    buffer_load_dwordx4 v[64:67], v1, s[12:15], s38 offen sc1
    s_waitcnt vmcnt(10) lgkmcnt(5)
    v_mfma_f32_16x16x32_bf16 v[96:99], v[192:195], v[24:27], v[96:99]
    ds_read_b128 v[172:175], v8 offset:0
    v_mfma_f32_16x16x32_bf16 v[100:103], v[196:199], v[24:27], v[100:103]
    ds_read_b128 v[176:179], v8 offset:1024
    v_mfma_f32_16x16x32_bf16 v[104:107], v[200:203], v[24:27], v[104:107]
    ds_read_b128 v[180:183], v8 offset:2048
    v_mfma_f32_16x16x32_bf16 v[108:111], v[204:207], v[24:27], v[108:111]
    ds_read_b128 v[184:187], v8 offset:3072
    v_mfma_f32_16x16x32_bf16 v[112:115], v[208:211], v[24:27], v[112:115]
    ds_read_b128 v[188:191], v8 offset:4096
    s_add_u32 s38, s7, 4096
    buffer_load_dwordx4 v[68:71], v1, s[12:15], s38 offen sc1
    s_waitcnt vmcnt(10) lgkmcnt(5)
    v_mfma_f32_16x16x32_bf16 v[96:99], v[152:155], v[28:31], v[96:99]
    ds_read_b128 v[192:195], v8 offset:5120
    v_mfma_f32_16x16x32_bf16 v[100:103], v[156:159], v[28:31], v[100:103]
    ds_read_b128 v[196:199], v8 offset:6144
    v_mfma_f32_16x16x32_bf16 v[104:107], v[160:163], v[28:31], v[104:107]
    ds_read_b128 v[200:203], v8 offset:7168
    v_mfma_f32_16x16x32_bf16 v[108:111], v[164:167], v[28:31], v[108:111]
    ds_read_b128 v[204:207], v8 offset:8192
    v_mfma_f32_16x16x32_bf16 v[112:115], v[168:171], v[28:31], v[112:115]
    ds_read_b128 v[208:211], v8 offset:9216
    s_add_u32 s38, s7, 8192
    buffer_load_dwordx4 v[72:75], v1, s[12:15], s38 offen sc1
    s_waitcnt vmcnt(10) lgkmcnt(5)
    v_mfma_f32_16x16x32_bf16 v[96:99], v[172:175], v[32:35], v[96:99]
    ds_read_b128 v[152:155], v8 offset:10240
    v_mfma_f32_16x16x32_bf16 v[100:103], v[176:179], v[32:35], v[100:103]
    ds_read_b128 v[156:159], v8 offset:11264
    v_mfma_f32_16x16x32_bf16 v[104:107], v[180:183], v[32:35], v[104:107]
    ds_read_b128 v[160:163], v8 offset:12288
    v_mfma_f32_16x16x32_bf16 v[108:111], v[184:187], v[32:35], v[108:111]
    ds_read_b128 v[164:167], v8 offset:13312
    v_mfma_f32_16x16x32_bf16 v[112:115], v[188:191], v[32:35], v[112:115]
    ds_read_b128 v[168:171], v8 offset:14336
    s_add_u32 s38, s7, 12288
    buffer_load_dwordx4 v[76:79], v1, s[12:15], s38 offen sc1
    s_waitcnt vmcnt(10) lgkmcnt(5)
    v_mfma_f32_16x16x32_bf16 v[96:99], v[192:195], v[36:39], v[96:99]
    ds_read_b128 v[172:175], v8 offset:15360
    v_mfma_f32_16x16x32_bf16 v[100:103], v[196:199], v[36:39], v[100:103]
    ds_read_b128 v[176:179], v8 offset:16384
    v_mfma_f32_16x16x32_bf16 v[104:107], v[200:203], v[36:39], v[104:107]
    ds_read_b128 v[180:183], v8 offset:17408
    v_mfma_f32_16x16x32_bf16 v[108:111], v[204:207], v[36:39], v[108:111]
    ds_read_b128 v[184:187], v8 offset:18432
    v_mfma_f32_16x16x32_bf16 v[112:115], v[208:211], v[36:39], v[112:115]
    ds_read_b128 v[188:191], v8 offset:19456
    s_add_u32 s38, s7, 16384
    buffer_load_dwordx4 v[80:83], v1, s[12:15], s38 offen sc1
    s_waitcnt vmcnt(10) lgkmcnt(5)
    v_mfma_f32_16x16x32_bf16 v[96:99], v[152:155], v[40:43], v[96:99]
    ds_read_b128 v[192:195], v8 offset:20480
    v_mfma_f32_16x16x32_bf16 v[100:103], v[156:159], v[40:43], v[100:103]
    ds_read_b128 v[196:199], v8 offset:21504
    v_mfma_f32_16x16x32_bf16 v[104:107], v[160:163], v[40:43], v[104:107]
    ds_read_b128 v[200:203], v8 offset:22528
    v_mfma_f32_16x16x32_bf16 v[108:111], v[164:167], v[40:43], v[108:111]
    ds_read_b128 v[204:207], v8 offset:23552
    v_mfma_f32_16x16x32_bf16 v[112:115], v[168:171], v[40:43], v[112:115]
    ds_read_b128 v[208:211], v8 offset:24576
    s_add_u32 s38, s7, 20480
    buffer_load_dwordx4 v[84:87], v1, s[12:15], s38 offen sc1
    s_waitcnt vmcnt(10) lgkmcnt(5)
    v_mfma_f32_16x16x32_bf16 v[96:99], v[172:175], v[44:47], v[96:99]
    ds_read_b128 v[152:155], v8 offset:25600
    v_mfma_f32_16x16x32_bf16 v[100:103], v[176:179], v[44:47], v[100:103]
    ds_read_b128 v[156:159], v8 offset:26624
    v_mfma_f32_16x16x32_bf16 v[104:107], v[180:183], v[44:47], v[104:107]
    ds_read_b128 v[160:163], v8 offset:27648
    v_mfma_f32_16x16x32_bf16 v[108:111], v[184:187], v[44:47], v[108:111]
    ds_read_b128 v[164:167], v8 offset:28672
    v_mfma_f32_16x16x32_bf16 v[112:115], v[188:191], v[44:47], v[112:115]
    ds_read_b128 v[168:171], v8 offset:29696
    s_add_u32 s38, s7, 24576
    buffer_load_dwordx4 v[88:91], v1, s[12:15], s38 offen sc1
    s_waitcnt vmcnt(10) lgkmcnt(5)
    v_mfma_f32_16x16x32_bf16 v[96:99], v[192:195], v[48:51], v[96:99]
    ds_read_b128 v[172:175], v8 offset:30720
    v_mfma_f32_16x16x32_bf16 v[100:103], v[196:199], v[48:51], v[100:103]
    ds_read_b128 v[176:179], v8 offset:31744
    v_mfma_f32_16x16x32_bf16 v[104:107], v[200:203], v[48:51], v[104:107]
    ds_read_b128 v[180:183], v8 offset:32768
    v_mfma_f32_16x16x32_bf16 v[108:111], v[204:207], v[48:51], v[108:111]
    ds_read_b128 v[184:187], v8 offset:33792
    v_mfma_f32_16x16x32_bf16 v[112:115], v[208:211], v[48:51], v[112:115]
    ds_read_b128 v[188:191], v8 offset:34816
    s_add_u32 s38, s7, 28672
    buffer_load_dwordx4 v[92:95], v1, s[12:15], s38 offen sc1
    s_barrier
    s_waitcnt vmcnt(10) lgkmcnt(5)
    v_mfma_f32_16x16x32_bf16 v[96:99], v[152:155], v[52:55], v[96:99]
    ds_read_b128 v[192:195], v8 offset:35840
    v_mfma_f32_16x16x32_bf16 v[100:103], v[156:159], v[52:55], v[100:103]
    ds_read_b128 v[196:199], v8 offset:36864
    v_mfma_f32_16x16x32_bf16 v[104:107], v[160:163], v[52:55], v[104:107]
    ds_read_b128 v[200:203], v8 offset:37888
    v_mfma_f32_16x16x32_bf16 v[108:111], v[164:167], v[52:55], v[108:111]
    ds_read_b128 v[204:207], v8 offset:38912
    v_mfma_f32_16x16x32_bf16 v[112:115], v[168:171], v[52:55], v[112:115]
    ds_read_b128 v[208:211], v8 offset:39936
    s_waitcnt vmcnt(9) lgkmcnt(5)
    v_mfma_f32_16x16x32_bf16 v[96:99], v[172:175], v[56:59], v[96:99]
    ds_read_b128 v[152:155], v1 offset:0
    v_mfma_f32_16x16x32_bf16 v[100:103], v[176:179], v[56:59], v[100:103]
    ds_read_b128 v[156:159], v1 offset:1024
    v_mfma_f32_16x16x32_bf16 v[104:107], v[180:183], v[56:59], v[104:107]
    ds_read_b128 v[160:163], v1 offset:2048
    v_mfma_f32_16x16x32_bf16 v[108:111], v[184:187], v[56:59], v[108:111]
    ds_read_b128 v[164:167], v1 offset:3072
    v_mfma_f32_16x16x32_bf16 v[112:115], v[188:191], v[56:59], v[112:115]
    ds_read_b128 v[168:171], v1 offset:4096
    s_waitcnt vmcnt(8) lgkmcnt(5)
    v_mfma_f32_16x16x32_bf16 v[96:99], v[192:195], v[60:63], v[96:99]
    ds_read_b128 v[172:175], v1 offset:5120
    v_mfma_f32_16x16x32_bf16 v[100:103], v[196:199], v[60:63], v[100:103]
    ds_read_b128 v[176:179], v1 offset:6144
    v_mfma_f32_16x16x32_bf16 v[104:107], v[200:203], v[60:63], v[104:107]
    ds_read_b128 v[180:183], v1 offset:7168
    v_mfma_f32_16x16x32_bf16 v[108:111], v[204:207], v[60:63], v[108:111]
    ds_read_b128 v[184:187], v1 offset:8192
    v_mfma_f32_16x16x32_bf16 v[112:115], v[208:211], v[60:63], v[112:115]
    ds_read_b128 v[188:191], v1 offset:9216
    s_barrier
    s_waitcnt vmcnt(7) lgkmcnt(5)
    v_mfma_f32_16x16x32_bf16 v[96:99], v[152:155], v[64:67], v[96:99]
    ds_read_b128 v[192:195], v1 offset:10240
    v_mfma_f32_16x16x32_bf16 v[100:103], v[156:159], v[64:67], v[100:103]
    ds_read_b128 v[196:199], v1 offset:11264
    v_mfma_f32_16x16x32_bf16 v[104:107], v[160:163], v[64:67], v[104:107]
    ds_read_b128 v[200:203], v1 offset:12288
    v_mfma_f32_16x16x32_bf16 v[108:111], v[164:167], v[64:67], v[108:111]
    ds_read_b128 v[204:207], v1 offset:13312
    v_mfma_f32_16x16x32_bf16 v[112:115], v[168:171], v[64:67], v[112:115]
    ds_read_b128 v[208:211], v1 offset:14336
    s_waitcnt vmcnt(6) lgkmcnt(5)
    v_mfma_f32_16x16x32_bf16 v[96:99], v[172:175], v[68:71], v[96:99]
    ds_read_b128 v[152:155], v1 offset:15360
    v_mfma_f32_16x16x32_bf16 v[100:103], v[176:179], v[68:71], v[100:103]
    ds_read_b128 v[156:159], v1 offset:16384
    v_mfma_f32_16x16x32_bf16 v[104:107], v[180:183], v[68:71], v[104:107]
    ds_read_b128 v[160:163], v1 offset:17408
    v_mfma_f32_16x16x32_bf16 v[108:111], v[184:187], v[68:71], v[108:111]
    ds_read_b128 v[164:167], v1 offset:18432
    v_mfma_f32_16x16x32_bf16 v[112:115], v[188:191], v[68:71], v[112:115]
    ds_read_b128 v[168:171], v1 offset:19456
    s_waitcnt vmcnt(5) lgkmcnt(5)
    v_mfma_f32_16x16x32_bf16 v[96:99], v[192:195], v[72:75], v[96:99]
    ds_read_b128 v[172:175], v1 offset:20480
    v_mfma_f32_16x16x32_bf16 v[100:103], v[196:199], v[72:75], v[100:103]
    ds_read_b128 v[176:179], v1 offset:21504
    v_mfma_f32_16x16x32_bf16 v[104:107], v[200:203], v[72:75], v[104:107]
    ds_read_b128 v[180:183], v1 offset:22528
    v_mfma_f32_16x16x32_bf16 v[108:111], v[204:207], v[72:75], v[108:111]
    ds_read_b128 v[184:187], v1 offset:23552
    v_mfma_f32_16x16x32_bf16 v[112:115], v[208:211], v[72:75], v[112:115]
    ds_read_b128 v[188:191], v1 offset:24576
    s_waitcnt vmcnt(4) lgkmcnt(5)
    v_mfma_f32_16x16x32_bf16 v[96:99], v[152:155], v[76:79], v[96:99]
    ds_read_b128 v[192:195], v1 offset:25600
    v_mfma_f32_16x16x32_bf16 v[100:103], v[156:159], v[76:79], v[100:103]
    ds_read_b128 v[196:199], v1 offset:26624
    v_mfma_f32_16x16x32_bf16 v[104:107], v[160:163], v[76:79], v[104:107]
    ds_read_b128 v[200:203], v1 offset:27648
    v_mfma_f32_16x16x32_bf16 v[108:111], v[164:167], v[76:79], v[108:111]
    ds_read_b128 v[204:207], v1 offset:28672
    v_mfma_f32_16x16x32_bf16 v[112:115], v[168:171], v[76:79], v[112:115]
    ds_read_b128 v[208:211], v1 offset:29696
    s_waitcnt vmcnt(3) lgkmcnt(5)
    v_mfma_f32_16x16x32_bf16 v[96:99], v[172:175], v[80:83], v[96:99]
    ds_read_b128 v[152:155], v1 offset:30720
    v_mfma_f32_16x16x32_bf16 v[100:103], v[176:179], v[80:83], v[100:103]
    ds_read_b128 v[156:159], v1 offset:31744
    v_mfma_f32_16x16x32_bf16 v[104:107], v[180:183], v[80:83], v[104:107]
    ds_read_b128 v[160:163], v1 offset:32768
    v_mfma_f32_16x16x32_bf16 v[108:111], v[184:187], v[80:83], v[108:111]
    ds_read_b128 v[164:167], v1 offset:33792
    v_mfma_f32_16x16x32_bf16 v[112:115], v[188:191], v[80:83], v[112:115]
    ds_read_b128 v[168:171], v1 offset:34816
    s_waitcnt vmcnt(2) lgkmcnt(5)
    v_mfma_f32_16x16x32_bf16 v[96:99], v[192:195], v[84:87], v[96:99]
    ds_read_b128 v[172:175], v1 offset:35840
    v_mfma_f32_16x16x32_bf16 v[100:103], v[196:199], v[84:87], v[100:103]
    ds_read_b128 v[176:179], v1 offset:36864
    v_mfma_f32_16x16x32_bf16 v[104:107], v[200:203], v[84:87], v[104:107]
    ds_read_b128 v[180:183], v1 offset:37888
    v_mfma_f32_16x16x32_bf16 v[108:111], v[204:207], v[84:87], v[108:111]
    ds_read_b128 v[184:187], v1 offset:38912
    v_mfma_f32_16x16x32_bf16 v[112:115], v[208:211], v[84:87], v[112:115]
    ds_read_b128 v[188:191], v1 offset:39936
    s_waitcnt vmcnt(1) lgkmcnt(5)
    v_mfma_f32_16x16x32_bf16 v[96:99], v[152:155], v[88:91], v[96:99]
    v_mfma_f32_16x16x32_bf16 v[100:103], v[156:159], v[88:91], v[100:103]
    v_mfma_f32_16x16x32_bf16 v[104:107], v[160:163], v[88:91], v[104:107]
    v_mfma_f32_16x16x32_bf16 v[108:111], v[164:167], v[88:91], v[108:111]
    v_mfma_f32_16x16x32_bf16 v[112:115], v[168:171], v[88:91], v[112:115]
    s_waitcnt vmcnt(0) lgkmcnt(0)
    v_mfma_f32_16x16x32_bf16 v[96:99], v[172:175], v[92:95], v[96:99]
    v_mfma_f32_16x16x32_bf16 v[100:103], v[176:179], v[92:95], v[100:103]
    v_mfma_f32_16x16x32_bf16 v[104:107], v[180:183], v[92:95], v[104:107]
    v_mfma_f32_16x16x32_bf16 v[108:111], v[184:187], v[92:95], v[108:111]
    v_mfma_f32_16x16x32_bf16 v[112:115], v[188:191], v[92:95], v[112:115]
    s_nop 4
    v_lshlrev_b32 v152, 16, v120
    v_and_b32 v153, 0xffff0000, v120
    v_lshlrev_b32 v154, 16, v121
    v_and_b32 v155, 0xffff0000, v121
    v_lshlrev_b32 v156, 16, v122
    v_and_b32 v157, 0xffff0000, v122
    v_lshlrev_b32 v158, 16, v123
    v_and_b32 v159, 0xffff0000, v123
    v_lshlrev_b32 v160, 16, v124
    v_and_b32 v161, 0xffff0000, v124
    v_lshlrev_b32 v162, 16, v125
    v_and_b32 v163, 0xffff0000, v125
    v_lshlrev_b32 v164, 16, v126
    v_and_b32 v165, 0xffff0000, v126
    v_lshlrev_b32 v166, 16, v127
    v_and_b32 v167, 0xffff0000, v127
    v_lshlrev_b32 v168, 16, v128
    v_and_b32 v169, 0xffff0000, v128
    v_lshlrev_b32 v170, 16, v129
    v_and_b32 v171, 0xffff0000, v129
    v_pk_fma_f32 v[96:97], v[96:97], v[132:133], v[152:153]
    v_pk_fma_f32 v[98:99], v[98:99], v[134:135], v[154:155]
    v_pk_fma_f32 v[100:101], v[100:101], v[136:137], v[156:157]
    v_pk_fma_f32 v[102:103], v[102:103], v[138:139], v[158:159]
    v_pk_fma_f32 v[104:105], v[104:105], v[140:141], v[160:161]
    v_pk_fma_f32 v[106:107], v[106:107], v[142:143], v[162:163]
    v_pk_fma_f32 v[108:109], v[108:109], v[144:145], v[164:165]
    v_pk_fma_f32 v[110:111], v[110:111], v[146:147], v[166:167]
    v_pk_fma_f32 v[112:113], v[112:113], v[148:149], v[168:169]
    v_pk_fma_f32 v[114:115], v[114:115], v[150:151], v[170:171]
    v_cvt_pk_bf16_f32 v120, v96, v97
    v_cvt_pk_bf16_f32 v121, v98, v99
    v_cvt_pk_bf16_f32 v122, v100, v101
    v_cvt_pk_bf16_f32 v123, v102, v103
    v_cvt_pk_bf16_f32 v124, v104, v105
    v_cvt_pk_bf16_f32 v125, v106, v107
    v_cvt_pk_bf16_f32 v126, v108, v109
    v_cvt_pk_bf16_f32 v127, v110, v111
    v_cvt_pk_bf16_f32 v128, v112, v113
    v_cvt_pk_bf16_f32 v129, v114, v115
    v_and_b32 v7, 1, v3
    v_mul_u32_u24 v7, 4088, v7
    v_add_u32 v7, v7, v6
    v_mov_b32 v232, v120
    v_mov_b32 v233, v121
    v_mov_b32 v234, v122
    v_mov_b32 v235, v123
    v_mov_b32 v236, v124
    v_mov_b32 v237, v125
    v_mov_b32 v238, v126
    v_mov_b32 v239, v127
    v_mov_b32 v240, v128
    v_mov_b32 v241, v129
    v_permlane16_swap_b32 v120, v122
    v_permlane16_swap_b32 v121, v123
    v_permlane16_swap_b32 v124, v126
    v_permlane16_swap_b32 v125, v127
    s_cmp_eq_u32 s30, 0
    s_cbranch_scc1 adaLN_cond__grouped_kv_mqa__mixer_gmlp__prompt_kernel_sl5
    buffer_store_dwordx4 v[120:123], v7, s[52:55], s60 offen
    buffer_store_dwordx4 v[124:127], v7, s[52:55], s62 offen
    buffer_store_dwordx2 v[128:129], v6, s[52:55], s64 offen
    s_branch adaLN_cond__grouped_kv_mqa__mixer_gmlp__prompt_kernel_sd6
adaLN_cond__grouped_kv_mqa__mixer_gmlp__prompt_kernel_sl5:
    buffer_store_dwordx4 v[120:123], v7, s[52:55], s60 offen sc1
    buffer_store_dwordx4 v[124:127], v7, s[52:55], s62 offen sc1
    buffer_store_dwordx2 v[128:129], v6, s[52:55], s64 offen sc1
adaLN_cond__grouped_kv_mqa__mixer_gmlp__prompt_kernel_sd6:
    v_mov_b32 v8, 0x3f803f80
    v_dot2_f32_bf16 v10, v232, v8, 0
    v_dot2_f32_bf16 v12, v232, v232, 0
    v_dot2_f32_bf16 v11, v233, v8, 0
    v_dot2_f32_bf16 v13, v233, v233, 0
    v_dot2_f32_bf16 v10, v234, v8, v10
    v_dot2_f32_bf16 v12, v234, v234, v12
    v_dot2_f32_bf16 v11, v235, v8, v11
    v_dot2_f32_bf16 v13, v235, v235, v13
    v_dot2_f32_bf16 v10, v236, v8, v10
    v_dot2_f32_bf16 v12, v236, v236, v12
    v_dot2_f32_bf16 v11, v237, v8, v11
    v_dot2_f32_bf16 v13, v237, v237, v13
    v_dot2_f32_bf16 v10, v238, v8, v10
    v_dot2_f32_bf16 v12, v238, v238, v12
    v_dot2_f32_bf16 v11, v239, v8, v11
    v_dot2_f32_bf16 v13, v239, v239, v13
    v_dot2_f32_bf16 v10, v240, v8, v10
    v_dot2_f32_bf16 v12, v240, v240, v12
    v_dot2_f32_bf16 v11, v241, v8, v11
    v_dot2_f32_bf16 v13, v241, v241, v13
    s_nop 2
    v_add_f32 v10, v10, v11
    v_add_f32 v12, v12, v13
    s_lshl_b32 s36, s24, 3
    s_add_u32 s36, s36, s25
    v_lshlrev_b32 v7, 3, v5
    v_permlane16_swap_b32 v10, v12
    v_add_f32 v10, v10, v12
    v_mov_b32 v12, v10
    v_and_b32 v8, 1, v3
    v_lshl_add_u32 v7, v8, 2, v7
    v_permlane32_swap_b32 v10, v12
    v_add_f32 v10, v10, v12
    v_lshrrev_b32 v8, 1, v3
    v_lshl_add_u32 v7, v8, 30, v7
    s_lshl_b32 s36, s36, 9
    s_lshl_b32 s37, s5, 7
    s_add_u32 s36, s36, s37
    s_cmp_eq_u32 s30, 0
    s_cbranch_scc1 adaLN_cond__grouped_kv_mqa__mixer_gmlp__prompt_kernel_sl7
    buffer_store_dword v10, v7, s[56:59], s36 offen
    s_branch adaLN_cond__grouped_kv_mqa__mixer_gmlp__prompt_kernel_sd8
adaLN_cond__grouped_kv_mqa__mixer_gmlp__prompt_kernel_sl7:
    buffer_store_dword v10, v7, s[56:59], s36 offen sc1
adaLN_cond__grouped_kv_mqa__mixer_gmlp__prompt_kernel_sd8:
    s_lshl_b32 s36, s28, 11
    s_add_u32 s36, s36, 331776
    s_lshl_b32 s37, s29, 7
    s_add_u32 s37, s37, s36
    s_waitcnt vmcnt(0)
    s_barrier
    s_cmp_lg_u32 s5, 0
    s_cbranch_scc1 k2_f3done
    v_mov_b32 v11, 1
    s_mov_b64 exec, 1
    s_cmp_eq_u32 s30, 0
    s_cbranch_scc1 adaLN_cond__grouped_kv_mqa__mixer_gmlp__prompt_kernel_sl9
    buffer_store_dword v11, off, s[16:19], s37
    s_branch adaLN_cond__grouped_kv_mqa__mixer_gmlp__prompt_kernel_sd10
adaLN_cond__grouped_kv_mqa__mixer_gmlp__prompt_kernel_sl9:
    buffer_store_dword v11, off, s[16:19], s37 sc1
adaLN_cond__grouped_kv_mqa__mixer_gmlp__prompt_kernel_sd10:
    s_mov_b64 exec, -1
k2_f3done:
    v_bfe_u32 v3, v0, 5, 1
    s_lshl_b32 s6, s28, 2
    s_add_u32 s6, s6, s5
    s_mul_i32 s7, s28, 163840
    s_add_u32 s7, s7, s10
    s_lshl_b32 s11, s6, 11
    s_and_b32 s37, s5, 1
    s_mul_i32 s37, s37, 1792
    s_sub_u32 s11, s11, s37
    v_lshlrev_b32 v4, 3, v2
    v_lshl_add_u32 v6, v3, 11, v4
    v_add_u32 v7, 40960, v1
    v_add_u32 v14, 102400, v1
    v_mov_b32 v12, 0xc0135761
    v_mov_b32 v13, 0xbdd2d3e8
    ds_read_b128 v[128:131], v14 offset:0
    ds_read_b128 v[132:135], v14 offset:1024
    ds_read_b128 v[136:139], v14 offset:2048
    ds_read_b128 v[140:143], v14 offset:3072
    ds_read_b128 v[144:147], v14 offset:4096
    ds_read_b128 v[148:151], v14 offset:5120
    s_mul_i32 s37, s28, 163840
    s_mul_i32 s39, s29, 10240
    s_add_u32 s37, s37, s39
    s_mul_i32 s39, s5, 2560
    s_add_u32 s37, s37, s39
    v_and_b32 v10, 15, v0
    v_lshlrev_b32 v10, 7, v10
    s_mov_b32 s38, 0
    buffer_load_dword v172, v10, s[16:19], s36 offen sc1
    s_sleep 1
k2_p3:
    buffer_load_dword v173, v10, s[16:19], s36 offen sc1
    s_waitcnt vmcnt(1)
    v_cmp_ne_u32 vcc, 0, v172
    s_cmp_eq_u64 vcc, -1
    s_cbranch_scc1 k2_p3_ok
    buffer_load_dword v172, v10, s[16:19], s36 offen sc1
    s_waitcnt vmcnt(1)
    v_cmp_ne_u32 vcc, 0, v173
    s_cmp_eq_u64 vcc, -1
    s_cbranch_scc1 k2_p3_ok
    s_add_u32 s38, s38, 1
    s_cmp_lt_u32 s38, 200000
    s_cbranch_scc1 k2_p3
k2_p3_ok:
    buffer_load_dwordx2 v[164:165], v6, s[56:59], s11 offen offset:0 sc1
    buffer_load_dwordx2 v[166:167], v6, s[56:59], s11 offen offset:512 sc1
    buffer_load_dwordx2 v[168:169], v6, s[56:59], s11 offen offset:1024 sc1
    buffer_load_dwordx2 v[170:171], v6, s[56:59], s11 offen offset:1536 sc1
    s_add_u32 s38, s7, 81920
    buffer_load_dwordx4 v[16:19], v1, s[52:55], s38 offen sc1
    s_add_u32 s38, s7, 86016
    buffer_load_dwordx4 v[20:23], v1, s[52:55], s38 offen sc1
    s_add_u32 s38, s7, 90112
    buffer_load_dwordx4 v[24:27], v1, s[52:55], s38 offen sc1
    s_add_u32 s38, s7, 94208
    buffer_load_dwordx4 v[28:31], v1, s[52:55], s38 offen sc1
    s_add_u32 s38, s7, 98304
    buffer_load_dwordx4 v[32:35], v1, s[52:55], s38 offen sc1
    s_add_u32 s38, s7, 102400
    buffer_load_dwordx4 v[36:39], v1, s[52:55], s38 offen sc1
    s_add_u32 s38, s7, 106496
    buffer_load_dwordx4 v[40:43], v1, s[52:55], s38 offen sc1
    s_add_u32 s38, s7, 110592
    buffer_load_dwordx4 v[44:47], v1, s[52:55], s38 offen sc1
    s_add_u32 s38, s7, 114688
    buffer_load_dwordx4 v[48:51], v1, s[52:55], s38 offen sc1
    s_add_u32 s38, s7, 118784
    buffer_load_dwordx4 v[52:55], v1, s[52:55], s38 offen sc1
    s_add_u32 s38, s7, 122880
    buffer_load_dwordx4 v[56:59], v1, s[52:55], s38 offen sc1
    s_add_u32 s38, s7, 126976
    buffer_load_dwordx4 v[60:63], v1, s[52:55], s38 offen sc1
    s_cmp_eq_u32 s27, 0
    s_cbranch_scc0 k2_p4B
    s_waitcnt vmcnt(11) lgkmcnt(3)
    v_mfma_f32_32x32x16_bf16 v[80:95], v[16:19], v[128:131], 0
    ds_read_b128 v[152:155], v14 offset:6144
    ds_read_b128 v[156:159], v14 offset:7168
    ds_read_b128 v[160:163], v14 offset:8192
    v_mfma_f32_32x32x16_bf16 v[96:111], v[16:19], v[132:135], 0
    s_add_u32 s38, s7, 131072
    buffer_load_dwordx4 v[64:67], v1, s[52:55], s38 offen sc1
    v_mfma_f32_32x32x16_bf16 v[112:127], v[136:139], v[16:19], 0
    s_waitcnt vmcnt(11) lgkmcnt(3)
    v_mfma_f32_32x32x16_bf16 v[80:95], v[20:23], v[140:143], v[80:95]
    ds_read_b128 v[128:131], v14 offset:9216
    ds_read_b128 v[132:135], v14 offset:10240
    ds_read_b128 v[136:139], v14 offset:11264
    v_mfma_f32_32x32x16_bf16 v[96:111], v[20:23], v[144:147], v[96:111]
    s_add_u32 s38, s7, 135168
    buffer_load_dwordx4 v[68:71], v1, s[52:55], s38 offen sc1
    v_mfma_f32_32x32x16_bf16 v[112:127], v[148:151], v[20:23], v[112:127]
    s_waitcnt vmcnt(11) lgkmcnt(3)
    v_mfma_f32_32x32x16_bf16 v[80:95], v[24:27], v[152:155], v[80:95]
    ds_read_b128 v[140:143], v14 offset:12288
    ds_read_b128 v[144:147], v14 offset:13312
    ds_read_b128 v[148:151], v14 offset:14336
    v_mfma_f32_32x32x16_bf16 v[96:111], v[24:27], v[156:159], v[96:111]
    s_add_u32 s38, s7, 139264
    buffer_load_dwordx4 v[72:75], v1, s[52:55], s38 offen sc1
    v_mfma_f32_32x32x16_bf16 v[112:127], v[160:163], v[24:27], v[112:127]
    s_waitcnt vmcnt(11) lgkmcnt(3)
    v_mfma_f32_32x32x16_bf16 v[80:95], v[28:31], v[128:131], v[80:95]
    ds_read_b128 v[152:155], v14 offset:15360
    ds_read_b128 v[156:159], v14 offset:16384
    ds_read_b128 v[160:163], v14 offset:17408
    v_mfma_f32_32x32x16_bf16 v[96:111], v[28:31], v[132:135], v[96:111]
    s_add_u32 s38, s7, 143360
    buffer_load_dwordx4 v[76:79], v1, s[52:55], s38 offen sc1
    v_mfma_f32_32x32x16_bf16 v[112:127], v[136:139], v[28:31], v[112:127]
    s_waitcnt vmcnt(11) lgkmcnt(3)
    v_mfma_f32_32x32x16_bf16 v[80:95], v[32:35], v[140:143], v[80:95]
    ds_read_b128 v[128:131], v14 offset:18432
    ds_read_b128 v[132:135], v14 offset:19456
    ds_read_b128 v[136:139], v14 offset:20480
    v_mfma_f32_32x32x16_bf16 v[96:111], v[32:35], v[144:147], v[96:111]
    s_add_u32 s38, s7, 147456
    buffer_load_dwordx4 v[16:19], v1, s[52:55], s38 offen sc1
    v_mfma_f32_32x32x16_bf16 v[112:127], v[148:151], v[32:35], v[112:127]
    s_waitcnt vmcnt(11) lgkmcnt(3)
    v_mfma_f32_32x32x16_bf16 v[80:95], v[36:39], v[152:155], v[80:95]
    ds_read_b128 v[140:143], v14 offset:21504
    ds_read_b128 v[144:147], v14 offset:22528
    ds_read_b128 v[148:151], v14 offset:23552
    v_mfma_f32_32x32x16_bf16 v[96:111], v[36:39], v[156:159], v[96:111]
    s_add_u32 s38, s7, 151552
    buffer_load_dwordx4 v[20:23], v1, s[52:55], s38 offen sc1
    v_mfma_f32_32x32x16_bf16 v[112:127], v[160:163], v[36:39], v[112:127]
    s_waitcnt vmcnt(11) lgkmcnt(3)
    v_mfma_f32_32x32x16_bf16 v[80:95], v[40:43], v[128:131], v[80:95]
    ds_read_b128 v[152:155], v14 offset:24576
    ds_read_b128 v[156:159], v14 offset:25600
    ds_read_b128 v[160:163], v14 offset:26624
    v_mfma_f32_32x32x16_bf16 v[96:111], v[40:43], v[132:135], v[96:111]
    s_add_u32 s38, s7, 155648
    buffer_load_dwordx4 v[24:27], v1, s[52:55], s38 offen sc1
    v_mfma_f32_32x32x16_bf16 v[112:127], v[136:139], v[40:43], v[112:127]
    s_waitcnt vmcnt(11) lgkmcnt(3)
    v_mfma_f32_32x32x16_bf16 v[80:95], v[44:47], v[140:143], v[80:95]
    ds_read_b128 v[128:131], v14 offset:27648
    ds_read_b128 v[132:135], v14 offset:28672
    ds_read_b128 v[136:139], v14 offset:29696
    v_mfma_f32_32x32x16_bf16 v[96:111], v[44:47], v[144:147], v[96:111]
    s_add_u32 s38, s7, 159744
    buffer_load_dwordx4 v[28:31], v1, s[52:55], s38 offen sc1
    v_mfma_f32_32x32x16_bf16 v[112:127], v[148:151], v[44:47], v[112:127]
    s_waitcnt vmcnt(11) lgkmcnt(3)
    v_mfma_f32_32x32x16_bf16 v[80:95], v[48:51], v[152:155], v[80:95]
    ds_read_b128 v[140:143], v14 offset:30720
    ds_read_b128 v[144:147], v14 offset:31744
    ds_read_b128 v[148:151], v14 offset:32768
    v_mfma_f32_32x32x16_bf16 v[96:111], v[48:51], v[156:159], v[96:111]
    s_add_u32 s38, s7, 0
    buffer_load_dwordx4 v[32:35], v1, s[52:55], s38 offen sc1
    v_mfma_f32_32x32x16_bf16 v[112:127], v[160:163], v[48:51], v[112:127]
    s_waitcnt vmcnt(11) lgkmcnt(3)
    v_mfma_f32_32x32x16_bf16 v[80:95], v[52:55], v[128:131], v[80:95]
    ds_read_b128 v[152:155], v14 offset:33792
    ds_read_b128 v[156:159], v14 offset:34816
    ds_read_b128 v[160:163], v14 offset:35840
    v_mfma_f32_32x32x16_bf16 v[96:111], v[52:55], v[132:135], v[96:111]
    s_add_u32 s38, s7, 4096
    buffer_load_dwordx4 v[36:39], v1, s[52:55], s38 offen sc1
    v_mfma_f32_32x32x16_bf16 v[112:127], v[136:139], v[52:55], v[112:127]
    s_waitcnt vmcnt(11) lgkmcnt(3)
    v_mfma_f32_32x32x16_bf16 v[80:95], v[56:59], v[140:143], v[80:95]
    ds_read_b128 v[128:131], v14 offset:36864
    ds_read_b128 v[132:135], v14 offset:37888
    ds_read_b128 v[136:139], v14 offset:38912
    v_mfma_f32_32x32x16_bf16 v[96:111], v[56:59], v[144:147], v[96:111]
    s_add_u32 s38, s7, 8192
    buffer_load_dwordx4 v[40:43], v1, s[52:55], s38 offen sc1
    v_mfma_f32_32x32x16_bf16 v[112:127], v[148:151], v[56:59], v[112:127]
    s_barrier
    s_waitcnt vmcnt(11) lgkmcnt(3)
    v_mfma_f32_32x32x16_bf16 v[80:95], v[60:63], v[152:155], v[80:95]
    ds_read_b128 v[140:143], v14 offset:39936
    ds_read_b128 v[144:147], v14 offset:40960
    ds_read_b128 v[148:151], v14 offset:41984
    v_mfma_f32_32x32x16_bf16 v[96:111], v[60:63], v[156:159], v[96:111]
    s_add_u32 s38, s7, 12288
    buffer_load_dwordx4 v[44:47], v1, s[52:55], s38 offen sc1
    v_mfma_f32_32x32x16_bf16 v[112:127], v[160:163], v[60:63], v[112:127]
    s_waitcnt vmcnt(11) lgkmcnt(3)
    v_mfma_f32_32x32x16_bf16 v[80:95], v[64:67], v[128:131], v[80:95]
    ds_read_b128 v[152:155], v14 offset:43008
    ds_read_b128 v[156:159], v14 offset:44032
    ds_read_b128 v[160:163], v14 offset:45056
    v_mfma_f32_32x32x16_bf16 v[96:111], v[64:67], v[132:135], v[96:111]
    s_add_u32 s38, s7, 16384
    buffer_load_dwordx4 v[48:51], v1, s[52:55], s38 offen sc1
    v_mfma_f32_32x32x16_bf16 v[112:127], v[136:139], v[64:67], v[112:127]
    s_waitcnt vmcnt(11) lgkmcnt(3)
    v_mfma_f32_32x32x16_bf16 v[80:95], v[68:71], v[140:143], v[80:95]
    ds_read_b128 v[128:131], v14 offset:46080
    ds_read_b128 v[132:135], v14 offset:47104
    ds_read_b128 v[136:139], v14 offset:48128
    v_mfma_f32_32x32x16_bf16 v[96:111], v[68:71], v[144:147], v[96:111]
    s_add_u32 s38, s7, 20480
    buffer_load_dwordx4 v[52:55], v1, s[52:55], s38 offen sc1
    v_mfma_f32_32x32x16_bf16 v[112:127], v[148:151], v[68:71], v[112:127]
    s_waitcnt vmcnt(11) lgkmcnt(3)
    v_mfma_f32_32x32x16_bf16 v[80:95], v[72:75], v[152:155], v[80:95]
    ds_read_b128 v[140:143], v14 offset:49152
    ds_read_b128 v[144:147], v14 offset:50176
    ds_read_b128 v[148:151], v14 offset:51200
    v_mfma_f32_32x32x16_bf16 v[96:111], v[72:75], v[156:159], v[96:111]
    s_add_u32 s38, s7, 24576
    buffer_load_dwordx4 v[56:59], v1, s[52:55], s38 offen sc1
    v_mfma_f32_32x32x16_bf16 v[112:127], v[160:163], v[72:75], v[112:127]
    s_waitcnt vmcnt(11) lgkmcnt(3)
    v_mfma_f32_32x32x16_bf16 v[80:95], v[76:79], v[128:131], v[80:95]
    ds_read_b128 v[152:155], v14 offset:52224
    ds_read_b128 v[156:159], v14 offset:53248
    ds_read_b128 v[160:163], v14 offset:54272
    v_mfma_f32_32x32x16_bf16 v[96:111], v[76:79], v[132:135], v[96:111]
    s_add_u32 s38, s7, 28672
    buffer_load_dwordx4 v[60:63], v1, s[52:55], s38 offen sc1
    v_mfma_f32_32x32x16_bf16 v[112:127], v[136:139], v[76:79], v[112:127]
    s_waitcnt vmcnt(11) lgkmcnt(3)
    v_mfma_f32_32x32x16_bf16 v[80:95], v[16:19], v[140:143], v[80:95]
    ds_read_b128 v[128:131], v14 offset:55296
    ds_read_b128 v[132:135], v14 offset:56320
    ds_read_b128 v[136:139], v14 offset:57344
    v_mfma_f32_32x32x16_bf16 v[96:111], v[16:19], v[144:147], v[96:111]
    s_add_u32 s38, s7, 32768
    buffer_load_dwordx4 v[64:67], v1, s[52:55], s38 offen sc1
    v_mfma_f32_32x32x16_bf16 v[112:127], v[148:151], v[16:19], v[112:127]
    s_waitcnt vmcnt(11) lgkmcnt(3)
    v_mfma_f32_32x32x16_bf16 v[80:95], v[20:23], v[152:155], v[80:95]
    ds_read_b128 v[140:143], v14 offset:58368
    ds_read_b128 v[144:147], v14 offset:59392
    ds_read_b128 v[148:151], v14 offset:60416
    v_mfma_f32_32x32x16_bf16 v[96:111], v[20:23], v[156:159], v[96:111]
    s_add_u32 s38, s7, 36864
    buffer_load_dwordx4 v[68:71], v1, s[52:55], s38 offen sc1
    v_mfma_f32_32x32x16_bf16 v[112:127], v[160:163], v[20:23], v[112:127]
    s_waitcnt vmcnt(11) lgkmcnt(3)
    v_mfma_f32_32x32x16_bf16 v[80:95], v[24:27], v[128:131], v[80:95]
    ds_read_b128 v[152:155], v7 offset:0
    ds_read_b128 v[156:159], v7 offset:1024
    ds_read_b128 v[160:163], v7 offset:2048
    v_mfma_f32_32x32x16_bf16 v[96:111], v[24:27], v[132:135], v[96:111]
    s_add_u32 s38, s7, 40960
    buffer_load_dwordx4 v[72:75], v1, s[52:55], s38 offen sc1
    v_mfma_f32_32x32x16_bf16 v[112:127], v[136:139], v[24:27], v[112:127]
    s_waitcnt vmcnt(11) lgkmcnt(3)
    v_mfma_f32_32x32x16_bf16 v[80:95], v[28:31], v[140:143], v[80:95]
    ds_read_b128 v[128:131], v7 offset:3072
    ds_read_b128 v[132:135], v7 offset:4096
    ds_read_b128 v[136:139], v7 offset:5120
    v_mfma_f32_32x32x16_bf16 v[96:111], v[28:31], v[144:147], v[96:111]
    s_add_u32 s38, s7, 45056
    buffer_load_dwordx4 v[76:79], v1, s[52:55], s38 offen sc1
    v_mfma_f32_32x32x16_bf16 v[112:127], v[148:151], v[28:31], v[112:127]
    s_waitcnt vmcnt(11) lgkmcnt(3)
    v_mfma_f32_32x32x16_bf16 v[80:95], v[32:35], v[152:155], v[80:95]
    ds_read_b128 v[140:143], v7 offset:6144
    ds_read_b128 v[144:147], v7 offset:7168
    ds_read_b128 v[148:151], v7 offset:8192
    v_mfma_f32_32x32x16_bf16 v[96:111], v[32:35], v[156:159], v[96:111]
    s_add_u32 s38, s7, 49152
    buffer_load_dwordx4 v[16:19], v1, s[52:55], s38 offen sc1
    v_mfma_f32_32x32x16_bf16 v[112:127], v[160:163], v[32:35], v[112:127]
    s_waitcnt vmcnt(11) lgkmcnt(3)
    v_mfma_f32_32x32x16_bf16 v[80:95], v[36:39], v[128:131], v[80:95]
    ds_read_b128 v[152:155], v7 offset:9216
    ds_read_b128 v[156:159], v7 offset:10240
    ds_read_b128 v[160:163], v7 offset:11264
    v_mfma_f32_32x32x16_bf16 v[96:111], v[36:39], v[132:135], v[96:111]
    s_add_u32 s38, s7, 53248
    buffer_load_dwordx4 v[20:23], v1, s[52:55], s38 offen sc1
    v_mfma_f32_32x32x16_bf16 v[112:127], v[136:139], v[36:39], v[112:127]
    v_pk_add_f32 v[164:165], v[164:165], v[166:167]
    v_pk_add_f32 v[168:169], v[168:169], v[170:171]
    v_pk_add_f32 v[164:165], v[164:165], v[168:169]
    v_mov_b32 v166, v164
    v_mov_b32 v167, v165
    s_lshl_b32 s36, s5, 8
    s_add_u32 s36, s36, 2048
    v_permlane32_swap_b32 v164, v166
    v_permlane32_swap_b32 v165, v167
    v_pk_add_f32 v[164:165], v[164:165], v[166:167]
    v_lshl_add_u32 v10, v2, 2, s36
    v_mov_b32 v166, 0x3acccccd
    v_fmaak_f32 v8, v164, v166, 0x80000000
    v_fmaak_f32 v9, v165, v166, 0x3727c5ac
    v_fma_f32 v9, -v8, v8, v9
    v_max_f32 v9, 0x3727c5ac, v9
    v_rsq_f32 v11, v9
    s_nop 0
    v_mul_f32 v9, v8, v11
    v_sub_f32 v9, 0, v9
    v_mov_b32 v8, v11
    ds_write_b32 v10, v8
    ds_write_b32 v10, v9 offset:128
    s_waitcnt vmcnt(11) lgkmcnt(3)
    v_mfma_f32_32x32x16_bf16 v[80:95], v[40:43], v[140:143], v[80:95]
    ds_read_b128 v[128:131], v7 offset:12288
    ds_read_b128 v[132:135], v7 offset:13312
    ds_read_b128 v[136:139], v7 offset:14336
    v_mfma_f32_32x32x16_bf16 v[96:111], v[40:43], v[144:147], v[96:111]
    s_add_u32 s38, s7, 57344
    buffer_load_dwordx4 v[24:27], v1, s[52:55], s38 offen sc1
    v_mfma_f32_32x32x16_bf16 v[112:127], v[148:151], v[40:43], v[112:127]
    s_waitcnt vmcnt(11) lgkmcnt(3)
    v_mfma_f32_32x32x16_bf16 v[80:95], v[44:47], v[152:155], v[80:95]
    ds_read_b128 v[140:143], v7 offset:15360
    ds_read_b128 v[144:147], v7 offset:16384
    ds_read_b128 v[148:151], v7 offset:17408
    v_mfma_f32_32x32x16_bf16 v[96:111], v[44:47], v[156:159], v[96:111]
    s_add_u32 s38, s7, 61440
    buffer_load_dwordx4 v[28:31], v1, s[52:55], s38 offen sc1
    v_mfma_f32_32x32x16_bf16 v[112:127], v[160:163], v[44:47], v[112:127]
    s_waitcnt vmcnt(11) lgkmcnt(3)
    v_mfma_f32_32x32x16_bf16 v[80:95], v[48:51], v[128:131], v[80:95]
    ds_read_b128 v[152:155], v7 offset:18432
    ds_read_b128 v[156:159], v7 offset:19456
    ds_read_b128 v[160:163], v7 offset:20480
    v_mfma_f32_32x32x16_bf16 v[96:111], v[48:51], v[132:135], v[96:111]
    s_add_u32 s38, s7, 65536
    buffer_load_dwordx4 v[32:35], v1, s[52:55], s38 offen sc1
    v_mfma_f32_32x32x16_bf16 v[112:127], v[136:139], v[48:51], v[112:127]
    s_waitcnt vmcnt(11) lgkmcnt(3)
    v_mfma_f32_32x32x16_bf16 v[80:95], v[52:55], v[140:143], v[80:95]
    ds_read_b128 v[128:131], v7 offset:21504
    ds_read_b128 v[132:135], v7 offset:22528
    ds_read_b128 v[136:139], v7 offset:23552
    v_mfma_f32_32x32x16_bf16 v[96:111], v[52:55], v[144:147], v[96:111]
    s_add_u32 s38, s7, 69632
    buffer_load_dwordx4 v[36:39], v1, s[52:55], s38 offen sc1
    v_mfma_f32_32x32x16_bf16 v[112:127], v[148:151], v[52:55], v[112:127]
    s_waitcnt vmcnt(11) lgkmcnt(3)
    v_mfma_f32_32x32x16_bf16 v[80:95], v[56:59], v[152:155], v[80:95]
    ds_read_b128 v[140:143], v7 offset:24576
    ds_read_b128 v[144:147], v7 offset:25600
    ds_read_b128 v[148:151], v7 offset:26624
    v_mfma_f32_32x32x16_bf16 v[96:111], v[56:59], v[156:159], v[96:111]
    s_add_u32 s38, s7, 73728
    buffer_load_dwordx4 v[40:43], v1, s[52:55], s38 offen sc1
    v_mfma_f32_32x32x16_bf16 v[112:127], v[160:163], v[56:59], v[112:127]
    s_waitcnt vmcnt(11) lgkmcnt(3)
    v_mfma_f32_32x32x16_bf16 v[80:95], v[60:63], v[128:131], v[80:95]
    ds_read_b128 v[152:155], v7 offset:27648
    ds_read_b128 v[156:159], v7 offset:28672
    ds_read_b128 v[160:163], v7 offset:29696
    v_mfma_f32_32x32x16_bf16 v[96:111], v[60:63], v[132:135], v[96:111]
    s_add_u32 s38, s7, 77824
    buffer_load_dwordx4 v[44:47], v1, s[52:55], s38 offen sc1
    v_mfma_f32_32x32x16_bf16 v[112:127], v[136:139], v[60:63], v[112:127]
    s_waitcnt vmcnt(11) lgkmcnt(3)
    v_mfma_f32_32x32x16_bf16 v[80:95], v[64:67], v[140:143], v[80:95]
    ds_read_b128 v[128:131], v7 offset:30720
    ds_read_b128 v[132:135], v7 offset:31744
    ds_read_b128 v[136:139], v7 offset:32768
    v_mfma_f32_32x32x16_bf16 v[96:111], v[64:67], v[144:147], v[96:111]
    v_mfma_f32_32x32x16_bf16 v[112:127], v[148:151], v[64:67], v[112:127]
    s_waitcnt vmcnt(10) lgkmcnt(3)
    v_mfma_f32_32x32x16_bf16 v[80:95], v[68:71], v[152:155], v[80:95]
    ds_read_b128 v[140:143], v7 offset:33792
    ds_read_b128 v[144:147], v7 offset:34816
    ds_read_b128 v[148:151], v7 offset:35840
    v_mfma_f32_32x32x16_bf16 v[96:111], v[68:71], v[156:159], v[96:111]
    v_mfma_f32_32x32x16_bf16 v[112:127], v[160:163], v[68:71], v[112:127]
    s_waitcnt vmcnt(9) lgkmcnt(3)
    v_mfma_f32_32x32x16_bf16 v[80:95], v[72:75], v[128:131], v[80:95]
    ds_read_b128 v[152:155], v7 offset:36864
    ds_read_b128 v[156:159], v7 offset:37888
    ds_read_b128 v[160:163], v7 offset:38912
    v_mfma_f32_32x32x16_bf16 v[96:111], v[72:75], v[132:135], v[96:111]
    v_mfma_f32_32x32x16_bf16 v[112:127], v[136:139], v[72:75], v[112:127]
    s_waitcnt vmcnt(8) lgkmcnt(3)
    v_mfma_f32_32x32x16_bf16 v[80:95], v[76:79], v[140:143], v[80:95]
    ds_read_b128 v[128:131], v7 offset:39936
    ds_read_b128 v[132:135], v7 offset:40960
    ds_read_b128 v[136:139], v7 offset:41984
    v_mfma_f32_32x32x16_bf16 v[96:111], v[76:79], v[144:147], v[96:111]
    v_mfma_f32_32x32x16_bf16 v[112:127], v[148:151], v[76:79], v[112:127]
    s_waitcnt vmcnt(7) lgkmcnt(3)
    v_mfma_f32_32x32x16_bf16 v[80:95], v[16:19], v[152:155], v[80:95]
    ds_read_b128 v[140:143], v7 offset:43008
    ds_read_b128 v[144:147], v7 offset:44032
    ds_read_b128 v[148:151], v7 offset:45056
    v_mfma_f32_32x32x16_bf16 v[96:111], v[16:19], v[156:159], v[96:111]
    v_mfma_f32_32x32x16_bf16 v[112:127], v[160:163], v[16:19], v[112:127]
    s_waitcnt vmcnt(6) lgkmcnt(3)
    v_mfma_f32_32x32x16_bf16 v[80:95], v[20:23], v[128:131], v[80:95]
    ds_read_b128 v[152:155], v7 offset:46080
    ds_read_b128 v[156:159], v7 offset:47104
    ds_read_b128 v[160:163], v7 offset:48128
    v_mfma_f32_32x32x16_bf16 v[96:111], v[20:23], v[132:135], v[96:111]
    v_mfma_f32_32x32x16_bf16 v[112:127], v[136:139], v[20:23], v[112:127]
    s_waitcnt vmcnt(5) lgkmcnt(3)
    v_mfma_f32_32x32x16_bf16 v[80:95], v[24:27], v[140:143], v[80:95]
    ds_read_b128 v[128:131], v7 offset:49152
    ds_read_b128 v[132:135], v7 offset:50176
    ds_read_b128 v[136:139], v7 offset:51200
    v_mfma_f32_32x32x16_bf16 v[96:111], v[24:27], v[144:147], v[96:111]
    v_mfma_f32_32x32x16_bf16 v[112:127], v[148:151], v[24:27], v[112:127]
    s_waitcnt vmcnt(4) lgkmcnt(3)
    v_mfma_f32_32x32x16_bf16 v[80:95], v[28:31], v[152:155], v[80:95]
    ds_read_b128 v[140:143], v7 offset:52224
    ds_read_b128 v[144:147], v7 offset:53248
    ds_read_b128 v[148:151], v7 offset:54272
    v_mfma_f32_32x32x16_bf16 v[96:111], v[28:31], v[156:159], v[96:111]
    v_mfma_f32_32x32x16_bf16 v[112:127], v[160:163], v[28:31], v[112:127]
    s_waitcnt vmcnt(3) lgkmcnt(3)
    v_mfma_f32_32x32x16_bf16 v[80:95], v[32:35], v[128:131], v[80:95]
    ds_read_b128 v[152:155], v7 offset:55296
    ds_read_b128 v[156:159], v7 offset:56320
    ds_read_b128 v[160:163], v7 offset:57344
    v_mfma_f32_32x32x16_bf16 v[96:111], v[32:35], v[132:135], v[96:111]
    v_mfma_f32_32x32x16_bf16 v[112:127], v[136:139], v[32:35], v[112:127]
    s_waitcnt vmcnt(2) lgkmcnt(3)
    v_mfma_f32_32x32x16_bf16 v[80:95], v[36:39], v[140:143], v[80:95]
    ds_read_b128 v[128:131], v7 offset:58368
    ds_read_b128 v[132:135], v7 offset:59392
    ds_read_b128 v[136:139], v7 offset:60416
    v_mfma_f32_32x32x16_bf16 v[96:111], v[36:39], v[144:147], v[96:111]
    v_mfma_f32_32x32x16_bf16 v[112:127], v[148:151], v[36:39], v[112:127]
    s_waitcnt vmcnt(1) lgkmcnt(3)
    v_mfma_f32_32x32x16_bf16 v[80:95], v[40:43], v[152:155], v[80:95]
    v_mfma_f32_32x32x16_bf16 v[96:111], v[40:43], v[156:159], v[96:111]
    v_mfma_f32_32x32x16_bf16 v[112:127], v[160:163], v[40:43], v[112:127]
    s_waitcnt vmcnt(0) lgkmcnt(0)
    v_mfma_f32_32x32x16_bf16 v[80:95], v[44:47], v[128:131], v[80:95]
    v_mfma_f32_32x32x16_bf16 v[96:111], v[44:47], v[132:135], v[96:111]
    v_mfma_f32_32x32x16_bf16 v[112:127], v[136:139], v[44:47], v[112:127]
    s_barrier
    v_lshl_add_u32 v10, v3, 4, s36
    v_lshlrev_b32 v11, 2, v2
    ds_read_b128 v[16:19], v10 offset:0
    ds_read_b128 v[32:35], v10 offset:128
    ds_read_b128 v[20:23], v10 offset:32
    ds_read_b128 v[36:39], v10 offset:160
    ds_read_b128 v[24:27], v10 offset:64
    ds_read_b128 v[40:43], v10 offset:192
    ds_read_b128 v[28:31], v10 offset:96
    ds_read_b128 v[44:47], v10 offset:224
    ds_read_b32 v48, v11 offset:0
    ds_read_b32 v49, v11 offset:1024
    ds_read_b32 v50, v11 offset:128
    ds_read_b32 v51, v11 offset:1152
    s_add_u32 s60, s8, 0x10000
    s_addc_u32 s61, s9, 0
    s_mov_b32 s62, 0x40000
    s_mov_b32 s63, 0x20000
    s_add_u32 s64, s8, 0x1500000
    s_addc_u32 s65, s9, 0
    s_mov_b32 s66, 0x300000
    s_mov_b32 s67, 0x20000
    s_add_u32 s68, s8, 0x1800000
    s_addc_u32 s69, s9, 0
    s_mov_b32 s70, 0x300000
    s_mov_b32 s71, 0x20000
    v_lshlrev_b32 v15, 4, v3
    s_waitcnt lgkmcnt(0)
    ds_read_b128 v[160:163], v15 offset:256
    ds_read_b128 v[176:179], v15 offset:1280
    ds_read_b128 v[164:167], v15 offset:288
    ds_read_b128 v[180:183], v15 offset:1312
    ds_read_b128 v[168:171], v15 offset:320
    ds_read_b128 v[184:187], v15 offset:1344
    ds_read_b128 v[172:175], v15 offset:352
    ds_read_b128 v[188:191], v15 offset:1376
    v_pk_fma_f32 v[56:57], v[32:33], v[48:49], v[48:49] op_sel:[0,0,1] op_sel_hi:[1,0,1]
    v_pk_fma_f32 v[58:59], v[34:35], v[48:49], v[48:49] op_sel:[0,0,1] op_sel_hi:[1,0,1]
    v_pk_fma_f32 v[60:61], v[36:37], v[48:49], v[48:49] op_sel:[0,0,1] op_sel_hi:[1,0,1]
    v_pk_fma_f32 v[62:63], v[38:39], v[48:49], v[48:49] op_sel:[0,0,1] op_sel_hi:[1,0,1]
    v_pk_fma_f32 v[64:65], v[40:41], v[48:49], v[48:49] op_sel:[0,0,1] op_sel_hi:[1,0,1]
    v_pk_fma_f32 v[66:67], v[42:43], v[48:49], v[48:49] op_sel:[0,0,1] op_sel_hi:[1,0,1]
    v_pk_fma_f32 v[68:69], v[44:45], v[48:49], v[48:49] op_sel:[0,0,1] op_sel_hi:[1,0,1]
    v_pk_fma_f32 v[70:71], v[46:47], v[48:49], v[48:49] op_sel:[0,0,1] op_sel_hi:[1,0,1]
    v_pk_fma_f32 v[80:81], v[80:81], v[16:17], v[56:57]
    v_pk_fma_f32 v[82:83], v[82:83], v[18:19], v[58:59]
    v_pk_fma_f32 v[84:85], v[84:85], v[20:21], v[60:61]
    v_pk_fma_f32 v[86:87], v[86:87], v[22:23], v[62:63]
    v_pk_fma_f32 v[88:89], v[88:89], v[24:25], v[64:65]
    v_pk_fma_f32 v[90:91], v[90:91], v[26:27], v[66:67]
    v_pk_fma_f32 v[92:93], v[92:93], v[28:29], v[68:69]
    v_pk_fma_f32 v[94:95], v[94:95], v[30:31], v[70:71]
    v_pk_mul_f32 v[56:57], v[80:81], v[80:81]
    v_pk_mul_f32 v[58:59], v[82:83], v[82:83]
    v_pk_mul_f32 v[60:61], v[84:85], v[84:85]
    v_pk_mul_f32 v[62:63], v[86:87], v[86:87]
    v_pk_mul_f32 v[64:65], v[88:89], v[88:89]
    v_pk_mul_f32 v[66:67], v[90:91], v[90:91]
    v_pk_mul_f32 v[68:69], v[92:93], v[92:93]
    v_pk_mul_f32 v[70:71], v[94:95], v[94:95]
    v_pk_fma_f32 v[56:57], v[56:57], v[12:13], v[12:13] op_sel:[0,1,0] op_sel_hi:[1,1,0]
    v_pk_fma_f32 v[58:59], v[58:59], v[12:13], v[12:13] op_sel:[0,1,0] op_sel_hi:[1,1,0]
    v_pk_fma_f32 v[60:61], v[60:61], v[12:13], v[12:13] op_sel:[0,1,0] op_sel_hi:[1,1,0]
    v_pk_fma_f32 v[62:63], v[62:63], v[12:13], v[12:13] op_sel:[0,1,0] op_sel_hi:[1,1,0]
    v_pk_fma_f32 v[64:65], v[64:65], v[12:13], v[12:13] op_sel:[0,1,0] op_sel_hi:[1,1,0]
    v_pk_fma_f32 v[66:67], v[66:67], v[12:13], v[12:13] op_sel:[0,1,0] op_sel_hi:[1,1,0]
    v_pk_fma_f32 v[68:69], v[68:69], v[12:13], v[12:13] op_sel:[0,1,0] op_sel_hi:[1,1,0]
    v_pk_fma_f32 v[70:71], v[70:71], v[12:13], v[12:13] op_sel:[0,1,0] op_sel_hi:[1,1,0]
    v_pk_mul_f32 v[56:57], v[56:57], v[80:81]
    v_pk_mul_f32 v[58:59], v[58:59], v[82:83]
    v_pk_mul_f32 v[60:61], v[60:61], v[84:85]
    v_pk_mul_f32 v[62:63], v[62:63], v[86:87]
    v_pk_mul_f32 v[64:65], v[64:65], v[88:89]
    v_pk_mul_f32 v[66:67], v[66:67], v[90:91]
    v_pk_mul_f32 v[68:69], v[68:69], v[92:93]
    v_pk_mul_f32 v[70:71], v[70:71], v[94:95]
    v_exp_f32 v56, v56
    v_exp_f32 v57, v57
    v_exp_f32 v58, v58
    v_exp_f32 v59, v59
    v_exp_f32 v60, v60
    v_exp_f32 v61, v61
    v_exp_f32 v62, v62
    v_exp_f32 v63, v63
    v_exp_f32 v64, v64
    v_exp_f32 v65, v65
    v_exp_f32 v66, v66
    v_exp_f32 v67, v67
    v_exp_f32 v68, v68
    v_exp_f32 v69, v69
    v_exp_f32 v70, v70
    v_exp_f32 v71, v71
    v_pk_add_f32 v[56:57], v[56:57], 1.0 op_sel_hi:[1,0]
    v_pk_add_f32 v[58:59], v[58:59], 1.0 op_sel_hi:[1,0]
    v_pk_add_f32 v[60:61], v[60:61], 1.0 op_sel_hi:[1,0]
    v_pk_add_f32 v[62:63], v[62:63], 1.0 op_sel_hi:[1,0]
    v_pk_add_f32 v[64:65], v[64:65], 1.0 op_sel_hi:[1,0]
    v_pk_add_f32 v[66:67], v[66:67], 1.0 op_sel_hi:[1,0]
    v_pk_add_f32 v[68:69], v[68:69], 1.0 op_sel_hi:[1,0]
    v_pk_add_f32 v[70:71], v[70:71], 1.0 op_sel_hi:[1,0]
    v_rcp_f32 v56, v56
    v_rcp_f32 v57, v57
    v_rcp_f32 v58, v58
    v_rcp_f32 v59, v59
    v_rcp_f32 v60, v60
    v_rcp_f32 v61, v61
    v_rcp_f32 v62, v62
    v_rcp_f32 v63, v63
    v_rcp_f32 v64, v64
    v_rcp_f32 v65, v65
    v_rcp_f32 v66, v66
    v_rcp_f32 v67, v67
    v_rcp_f32 v68, v68
    v_rcp_f32 v69, v69
    v_rcp_f32 v70, v70
    v_rcp_f32 v71, v71
    v_pk_mul_f32 v[80:81], v[80:81], v[56:57]
    v_pk_mul_f32 v[82:83], v[82:83], v[58:59]
    v_pk_mul_f32 v[84:85], v[84:85], v[60:61]
    v_pk_mul_f32 v[86:87], v[86:87], v[62:63]
    v_pk_mul_f32 v[88:89], v[88:89], v[64:65]
    v_pk_mul_f32 v[90:91], v[90:91], v[66:67]
    v_pk_mul_f32 v[92:93], v[92:93], v[68:69]
    v_pk_mul_f32 v[94:95], v[94:95], v[70:71]
    v_pk_mul_f32 v[144:145], v[80:81], v[80:81]
    v_pk_mul_f32 v[146:147], v[82:83], v[82:83]
    v_pk_mul_f32 v[148:149], v[84:85], v[84:85]
    v_pk_mul_f32 v[150:151], v[86:87], v[86:87]
    v_pk_mul_f32 v[152:153], v[88:89], v[88:89]
    v_pk_mul_f32 v[154:155], v[90:91], v[90:91]
    v_pk_mul_f32 v[156:157], v[92:93], v[92:93]
    v_pk_mul_f32 v[158:159], v[94:95], v[94:95]
    v_pk_fma_f32 v[56:57], v[32:33], v[50:51], v[50:51] op_sel:[0,0,1] op_sel_hi:[1,0,1]
    v_pk_fma_f32 v[58:59], v[34:35], v[50:51], v[50:51] op_sel:[0,0,1] op_sel_hi:[1,0,1]
    v_pk_fma_f32 v[60:61], v[36:37], v[50:51], v[50:51] op_sel:[0,0,1] op_sel_hi:[1,0,1]
    v_pk_fma_f32 v[62:63], v[38:39], v[50:51], v[50:51] op_sel:[0,0,1] op_sel_hi:[1,0,1]
    v_pk_fma_f32 v[64:65], v[40:41], v[50:51], v[50:51] op_sel:[0,0,1] op_sel_hi:[1,0,1]
    v_pk_fma_f32 v[66:67], v[42:43], v[50:51], v[50:51] op_sel:[0,0,1] op_sel_hi:[1,0,1]
    v_pk_fma_f32 v[68:69], v[44:45], v[50:51], v[50:51] op_sel:[0,0,1] op_sel_hi:[1,0,1]
    v_pk_fma_f32 v[70:71], v[46:47], v[50:51], v[50:51] op_sel:[0,0,1] op_sel_hi:[1,0,1]
    v_pk_fma_f32 v[96:97], v[96:97], v[16:17], v[56:57]
    v_pk_fma_f32 v[98:99], v[98:99], v[18:19], v[58:59]
    v_pk_fma_f32 v[100:101], v[100:101], v[20:21], v[60:61]
    v_pk_fma_f32 v[102:103], v[102:103], v[22:23], v[62:63]
    v_pk_fma_f32 v[104:105], v[104:105], v[24:25], v[64:65]
    v_pk_fma_f32 v[106:107], v[106:107], v[26:27], v[66:67]
    v_pk_fma_f32 v[108:109], v[108:109], v[28:29], v[68:69]
    v_pk_fma_f32 v[110:111], v[110:111], v[30:31], v[70:71]
    v_pk_mul_f32 v[56:57], v[96:97], v[96:97]
    v_pk_mul_f32 v[58:59], v[98:99], v[98:99]
    v_pk_mul_f32 v[60:61], v[100:101], v[100:101]
    v_pk_mul_f32 v[62:63], v[102:103], v[102:103]
    v_pk_mul_f32 v[64:65], v[104:105], v[104:105]
    v_pk_mul_f32 v[66:67], v[106:107], v[106:107]
    v_pk_mul_f32 v[68:69], v[108:109], v[108:109]
    v_pk_mul_f32 v[70:71], v[110:111], v[110:111]
    v_pk_fma_f32 v[56:57], v[56:57], v[12:13], v[12:13] op_sel:[0,1,0] op_sel_hi:[1,1,0]
    v_pk_fma_f32 v[58:59], v[58:59], v[12:13], v[12:13] op_sel:[0,1,0] op_sel_hi:[1,1,0]
    v_pk_fma_f32 v[60:61], v[60:61], v[12:13], v[12:13] op_sel:[0,1,0] op_sel_hi:[1,1,0]
    v_pk_fma_f32 v[62:63], v[62:63], v[12:13], v[12:13] op_sel:[0,1,0] op_sel_hi:[1,1,0]
    v_pk_fma_f32 v[64:65], v[64:65], v[12:13], v[12:13] op_sel:[0,1,0] op_sel_hi:[1,1,0]
    v_pk_fma_f32 v[66:67], v[66:67], v[12:13], v[12:13] op_sel:[0,1,0] op_sel_hi:[1,1,0]
    v_pk_fma_f32 v[68:69], v[68:69], v[12:13], v[12:13] op_sel:[0,1,0] op_sel_hi:[1,1,0]
    v_pk_fma_f32 v[70:71], v[70:71], v[12:13], v[12:13] op_sel:[0,1,0] op_sel_hi:[1,1,0]
    v_pk_mul_f32 v[56:57], v[56:57], v[96:97]
    v_pk_mul_f32 v[58:59], v[58:59], v[98:99]
    v_pk_mul_f32 v[60:61], v[60:61], v[100:101]
    v_pk_mul_f32 v[62:63], v[62:63], v[102:103]
    v_pk_mul_f32 v[64:65], v[64:65], v[104:105]
    v_pk_mul_f32 v[66:67], v[66:67], v[106:107]
    v_pk_mul_f32 v[68:69], v[68:69], v[108:109]
    v_pk_mul_f32 v[70:71], v[70:71], v[110:111]
    v_exp_f32 v56, v56
    v_exp_f32 v57, v57
    v_exp_f32 v58, v58
    v_exp_f32 v59, v59
    v_exp_f32 v60, v60
    v_exp_f32 v61, v61
    v_exp_f32 v62, v62
    v_exp_f32 v63, v63
    v_exp_f32 v64, v64
    v_exp_f32 v65, v65
    v_exp_f32 v66, v66
    v_exp_f32 v67, v67
    v_exp_f32 v68, v68
    v_exp_f32 v69, v69
    v_exp_f32 v70, v70
    v_exp_f32 v71, v71
    v_pk_add_f32 v[56:57], v[56:57], 1.0 op_sel_hi:[1,0]
    v_pk_add_f32 v[58:59], v[58:59], 1.0 op_sel_hi:[1,0]
    v_pk_add_f32 v[60:61], v[60:61], 1.0 op_sel_hi:[1,0]
    v_pk_add_f32 v[62:63], v[62:63], 1.0 op_sel_hi:[1,0]
    v_pk_add_f32 v[64:65], v[64:65], 1.0 op_sel_hi:[1,0]
    v_pk_add_f32 v[66:67], v[66:67], 1.0 op_sel_hi:[1,0]
    v_pk_add_f32 v[68:69], v[68:69], 1.0 op_sel_hi:[1,0]
    v_pk_add_f32 v[70:71], v[70:71], 1.0 op_sel_hi:[1,0]
    v_rcp_f32 v56, v56
    v_rcp_f32 v57, v57
    v_rcp_f32 v58, v58
    v_rcp_f32 v59, v59
    v_rcp_f32 v60, v60
    v_rcp_f32 v61, v61
    v_rcp_f32 v62, v62
    v_rcp_f32 v63, v63
    v_rcp_f32 v64, v64
    v_rcp_f32 v65, v65
    v_rcp_f32 v66, v66
    v_rcp_f32 v67, v67
    v_rcp_f32 v68, v68
    v_rcp_f32 v69, v69
    v_rcp_f32 v70, v70
    v_rcp_f32 v71, v71
    v_pk_mul_f32 v[96:97], v[96:97], v[56:57]
    v_pk_mul_f32 v[98:99], v[98:99], v[58:59]
    v_pk_mul_f32 v[100:101], v[100:101], v[60:61]
    v_pk_mul_f32 v[102:103], v[102:103], v[62:63]
    v_pk_mul_f32 v[104:105], v[104:105], v[64:65]
    v_pk_mul_f32 v[106:107], v[106:107], v[66:67]
    v_pk_mul_f32 v[108:109], v[108:109], v[68:69]
    v_pk_mul_f32 v[110:111], v[110:111], v[70:71]
    v_pk_fma_f32 v[144:145], v[96:97], v[96:97], v[144:145]
    v_pk_fma_f32 v[146:147], v[98:99], v[98:99], v[146:147]
    v_pk_fma_f32 v[148:149], v[100:101], v[100:101], v[148:149]
    v_pk_fma_f32 v[150:151], v[102:103], v[102:103], v[150:151]
    v_pk_fma_f32 v[152:153], v[104:105], v[104:105], v[152:153]
    v_pk_fma_f32 v[154:155], v[106:107], v[106:107], v[154:155]
    v_pk_fma_f32 v[156:157], v[108:109], v[108:109], v[156:157]
    v_pk_fma_f32 v[158:159], v[110:111], v[110:111], v[158:159]
    v_pk_add_f32 v[128:129], v[80:81], v[96:97]
    v_pk_add_f32 v[130:131], v[82:83], v[98:99]
    v_pk_add_f32 v[132:133], v[84:85], v[100:101]
    v_pk_add_f32 v[134:135], v[86:87], v[102:103]
    v_pk_add_f32 v[136:137], v[88:89], v[104:105]
    v_pk_add_f32 v[138:139], v[90:91], v[106:107]
    v_pk_add_f32 v[140:141], v[92:93], v[108:109]
    v_pk_add_f32 v[142:143], v[94:95], v[110:111]
    v_and_b32 v4, 3, v0
    v_bfe_u32 v5, v0, 2, 2
    v_permlane16_swap_b32 v128, v144
    v_permlane16_swap_b32 v129, v145
    v_permlane16_swap_b32 v130, v146
    v_permlane16_swap_b32 v131, v147
    v_permlane16_swap_b32 v132, v148
    v_permlane16_swap_b32 v133, v149
    v_permlane16_swap_b32 v134, v150
    v_permlane16_swap_b32 v135, v151
    v_permlane16_swap_b32 v136, v152
    v_permlane16_swap_b32 v137, v153
    v_permlane16_swap_b32 v138, v154
    v_permlane16_swap_b32 v139, v155
    v_permlane16_swap_b32 v140, v156
    v_permlane16_swap_b32 v141, v157
    v_permlane16_swap_b32 v142, v158
    v_permlane16_swap_b32 v143, v159
    v_add_f32 v128, v128, v144
    v_add_f32 v129, v129, v145
    v_add_f32 v130, v130, v146
    v_add_f32 v131, v131, v147
    v_add_f32 v132, v132, v148
    v_add_f32 v133, v133, v149
    v_add_f32 v134, v134, v150
    v_add_f32 v135, v135, v151
    v_add_f32 v136, v136, v152
    v_add_f32 v137, v137, v153
    v_add_f32 v138, v138, v154
    v_add_f32 v139, v139, v155
    v_add_f32 v140, v140, v156
    v_add_f32 v141, v141, v157
    v_add_f32 v142, v142, v158
    v_add_f32 v143, v143, v159
    v_add_f32_dpp v128, v128, v128 row_ror:8 row_mask:0xf bank_mask:0x3
    v_add_f32_dpp v129, v129, v129 row_ror:8 row_mask:0xf bank_mask:0x3
    v_add_f32_dpp v130, v130, v130 row_ror:8 row_mask:0xf bank_mask:0x3
    v_add_f32_dpp v131, v131, v131 row_ror:8 row_mask:0xf bank_mask:0x3
    v_add_f32_dpp v132, v132, v132 row_ror:8 row_mask:0xf bank_mask:0x3
    v_add_f32_dpp v133, v133, v133 row_ror:8 row_mask:0xf bank_mask:0x3
    v_add_f32_dpp v134, v134, v134 row_ror:8 row_mask:0xf bank_mask:0x3
    v_add_f32_dpp v135, v135, v135 row_ror:8 row_mask:0xf bank_mask:0x3
    v_add_f32_dpp v128, v136, v136 row_ror:8 row_mask:0xf bank_mask:0xc
    v_add_f32_dpp v129, v137, v137 row_ror:8 row_mask:0xf bank_mask:0xc
    v_add_f32_dpp v130, v138, v138 row_ror:8 row_mask:0xf bank_mask:0xc
    v_add_f32_dpp v131, v139, v139 row_ror:8 row_mask:0xf bank_mask:0xc
    v_add_f32_dpp v132, v140, v140 row_ror:8 row_mask:0xf bank_mask:0xc
    v_add_f32_dpp v133, v141, v141 row_ror:8 row_mask:0xf bank_mask:0xc
    v_add_f32_dpp v134, v142, v142 row_ror:8 row_mask:0xf bank_mask:0xc
    v_add_f32_dpp v135, v143, v143 row_ror:8 row_mask:0xf bank_mask:0xc
    v_add_f32_dpp v128, v128, v128 row_half_mirror row_mask:0xf bank_mask:0x5
    v_add_f32_dpp v129, v129, v129 row_half_mirror row_mask:0xf bank_mask:0x5
    v_add_f32_dpp v130, v130, v130 row_half_mirror row_mask:0xf bank_mask:0x5
    v_add_f32_dpp v131, v131, v131 row_half_mirror row_mask:0xf bank_mask:0x5
    v_add_f32_dpp v128, v132, v132 row_half_mirror row_mask:0xf bank_mask:0xa
    v_add_f32_dpp v129, v133, v133 row_half_mirror row_mask:0xf bank_mask:0xa
    v_add_f32_dpp v130, v134, v134 row_half_mirror row_mask:0xf bank_mask:0xa
    v_add_f32_dpp v131, v135, v135 row_half_mirror row_mask:0xf bank_mask:0xa
    v_add_f32_dpp v128, v128, v128 quad_perm:[2,3,0,1] row_mask:0xf bank_mask:0xf
    v_add_f32_dpp v129, v129, v129 quad_perm:[2,3,0,1] row_mask:0xf bank_mask:0xf
    v_add_f32_dpp v130, v130, v130 quad_perm:[2,3,0,1] row_mask:0xf bank_mask:0xf
    v_add_f32_dpp v131, v131, v131 quad_perm:[2,3,0,1] row_mask:0xf bank_mask:0xf
    v_add_f32_dpp v128, v128, v128 quad_perm:[1,0,3,2] row_mask:0xf bank_mask:0xf
    v_add_f32_dpp v129, v129, v129 quad_perm:[1,0,3,2] row_mask:0xf bank_mask:0xf
    v_add_f32_dpp v130, v130, v130 quad_perm:[1,0,3,2] row_mask:0xf bank_mask:0xf
    v_add_f32_dpp v131, v131, v131 quad_perm:[1,0,3,2] row_mask:0xf bank_mask:0xf
    v_lshl_add_u32 v4, v5, 3, v4
    v_lshl_add_u32 v4, v3, 2, v4
    v_lshlrev_b32 v4, 3, v4
    v_bfe_u32 v5, v0, 4, 1
    v_lshl_add_u32 v4, v5, 2, v4
    v_cvt_f32_u32 v5, v5
    v_mul_f32 v5, 0xc1700000, v5
    v_add_f32 v5, 0x41800000, v5
    s_mov_b32 s40, 0x22222222
    s_mov_b32 s41, 0x22222222
    v_cndmask_b32 v128, v128, v129, s[40:41]
    s_mov_b32 s40, 0x44444444
    s_mov_b32 s41, 0x44444444
    v_cndmask_b32 v128, v128, v130, s[40:41]
    s_mov_b32 s40, 0x88888888
    s_mov_b32 s41, 0x88888888
    v_cndmask_b32 v128, v128, v131, s[40:41]
    s_lshl_b32 s37, s28, 14
    s_lshl_b32 s38, s5, 8
    s_add_u32 s37, s37, s38
    s_lshl_b32 s38, s29, 10
    s_add_u32 s38, s38, s37
    v_add_f32 v128, v128, v5
    s_cmp_eq_u32 s30, 0
    s_cbranch_scc1 adaLN_cond__grouped_kv_mqa__mixer_gmlp__prompt_kernel_sl11
    buffer_store_dword v128, v4, s[60:63], s38 offen
    s_branch adaLN_cond__grouped_kv_mqa__mixer_gmlp__prompt_kernel_sd12
adaLN_cond__grouped_kv_mqa__mixer_gmlp__prompt_kernel_sl11:
    buffer_store_dword v128, v4, s[60:63], s38 offen sc1
adaLN_cond__grouped_kv_mqa__mixer_gmlp__prompt_kernel_sd12:
    s_mul_i32 s39, s6, 24
    s_mul_i32 s38, s25, 3
    s_add_u32 s39, s39, s38
    s_add_u32 s39, s39, 0
    s_lshl_b32 s39, s39, 11
    v_lshlrev_b32 v4, 3, v2
    v_lshl_add_u32 v4, v3, 13, v4
    s_add_u32 s38, s37, 4096
    s_waitcnt lgkmcnt(0)
    v_pk_fma_f32 v[56:57], v[8:9], v[160:161], v[176:177] op_sel:[1,0,0] op_sel_hi:[1,1,1]
    v_pk_fma_f32 v[58:59], v[8:9], v[162:163], v[178:179] op_sel:[1,0,0] op_sel_hi:[1,1,1]
    v_pk_fma_f32 v[60:61], v[8:9], v[164:165], v[180:181] op_sel:[1,0,0] op_sel_hi:[1,1,1]
    v_pk_fma_f32 v[62:63], v[8:9], v[166:167], v[182:183] op_sel:[1,0,0] op_sel_hi:[1,1,1]
    v_pk_fma_f32 v[64:65], v[8:9], v[168:169], v[184:185] op_sel:[1,0,0] op_sel_hi:[1,1,1]
    v_pk_fma_f32 v[66:67], v[8:9], v[170:171], v[186:187] op_sel:[1,0,0] op_sel_hi:[1,1,1]
    v_pk_fma_f32 v[68:69], v[8:9], v[172:173], v[188:189] op_sel:[1,0,0] op_sel_hi:[1,1,1]
    v_pk_fma_f32 v[70:71], v[8:9], v[174:175], v[190:191] op_sel:[1,0,0] op_sel_hi:[1,1,1]
    v_pk_fma_f32 v[112:113], v[112:113], v[8:9], v[56:57] op_sel_hi:[1,0,1]
    v_pk_fma_f32 v[114:115], v[114:115], v[8:9], v[58:59] op_sel_hi:[1,0,1]
    v_pk_fma_f32 v[116:117], v[116:117], v[8:9], v[60:61] op_sel_hi:[1,0,1]
    v_pk_fma_f32 v[118:119], v[118:119], v[8:9], v[62:63] op_sel_hi:[1,0,1]
    v_pk_fma_f32 v[120:121], v[120:121], v[8:9], v[64:65] op_sel_hi:[1,0,1]
    v_pk_fma_f32 v[122:123], v[122:123], v[8:9], v[66:67] op_sel_hi:[1,0,1]
    v_pk_fma_f32 v[124:125], v[124:125], v[8:9], v[68:69] op_sel_hi:[1,0,1]
    v_pk_fma_f32 v[126:127], v[126:127], v[8:9], v[70:71] op_sel_hi:[1,0,1]
    v_pk_mul_f32 v[56:57], v[112:113], v[112:113]
    v_pk_mul_f32 v[58:59], v[114:115], v[114:115]
    v_pk_mul_f32 v[60:61], v[116:117], v[116:117]
    v_pk_mul_f32 v[62:63], v[118:119], v[118:119]
    v_pk_mul_f32 v[64:65], v[120:121], v[120:121]
    v_pk_mul_f32 v[66:67], v[122:123], v[122:123]
    v_pk_mul_f32 v[68:69], v[124:125], v[124:125]
    v_pk_mul_f32 v[70:71], v[126:127], v[126:127]
    v_pk_fma_f32 v[56:57], v[56:57], v[12:13], v[12:13] op_sel:[0,1,0] op_sel_hi:[1,1,0]
    v_pk_fma_f32 v[58:59], v[58:59], v[12:13], v[12:13] op_sel:[0,1,0] op_sel_hi:[1,1,0]
    v_pk_fma_f32 v[60:61], v[60:61], v[12:13], v[12:13] op_sel:[0,1,0] op_sel_hi:[1,1,0]
    v_pk_fma_f32 v[62:63], v[62:63], v[12:13], v[12:13] op_sel:[0,1,0] op_sel_hi:[1,1,0]
    v_pk_fma_f32 v[64:65], v[64:65], v[12:13], v[12:13] op_sel:[0,1,0] op_sel_hi:[1,1,0]
    v_pk_fma_f32 v[66:67], v[66:67], v[12:13], v[12:13] op_sel:[0,1,0] op_sel_hi:[1,1,0]
    v_pk_fma_f32 v[68:69], v[68:69], v[12:13], v[12:13] op_sel:[0,1,0] op_sel_hi:[1,1,0]
    v_pk_fma_f32 v[70:71], v[70:71], v[12:13], v[12:13] op_sel:[0,1,0] op_sel_hi:[1,1,0]
    v_pk_mul_f32 v[56:57], v[56:57], v[112:113]
    v_pk_mul_f32 v[58:59], v[58:59], v[114:115]
    v_pk_mul_f32 v[60:61], v[60:61], v[116:117]
    v_pk_mul_f32 v[62:63], v[62:63], v[118:119]
    v_pk_mul_f32 v[64:65], v[64:65], v[120:121]
    v_pk_mul_f32 v[66:67], v[66:67], v[122:123]
    v_pk_mul_f32 v[68:69], v[68:69], v[124:125]
    v_pk_mul_f32 v[70:71], v[70:71], v[126:127]
    v_exp_f32 v56, v56
    v_exp_f32 v57, v57
    v_exp_f32 v58, v58
    v_exp_f32 v59, v59
    v_exp_f32 v60, v60
    v_exp_f32 v61, v61
    v_exp_f32 v62, v62
    v_exp_f32 v63, v63
    v_exp_f32 v64, v64
    v_exp_f32 v65, v65
    v_exp_f32 v66, v66
    v_exp_f32 v67, v67
    v_exp_f32 v68, v68
    v_exp_f32 v69, v69
    v_exp_f32 v70, v70
    v_exp_f32 v71, v71
    buffer_load_dwordx2 v[160:161], v4, s[60:63], s37 offen offset:0 sc1
    buffer_load_dwordx2 v[162:163], v4, s[60:63], s37 offen offset:1024 sc1
    buffer_load_dwordx2 v[164:165], v4, s[60:63], s37 offen offset:2048 sc1
    buffer_load_dwordx2 v[166:167], v4, s[60:63], s37 offen offset:3072 sc1
    buffer_load_dwordx2 v[168:169], v4, s[60:63], s38 offen offset:0 sc1
    buffer_load_dwordx2 v[170:171], v4, s[60:63], s38 offen offset:1024 sc1
    buffer_load_dwordx2 v[172:173], v4, s[60:63], s38 offen offset:2048 sc1
    buffer_load_dwordx2 v[174:175], v4, s[60:63], s38 offen offset:3072 sc1
    v_pk_add_f32 v[56:57], v[56:57], 1.0 op_sel_hi:[1,0]
    v_pk_add_f32 v[58:59], v[58:59], 1.0 op_sel_hi:[1,0]
    v_pk_add_f32 v[60:61], v[60:61], 1.0 op_sel_hi:[1,0]
    v_pk_add_f32 v[62:63], v[62:63], 1.0 op_sel_hi:[1,0]
    v_pk_add_f32 v[64:65], v[64:65], 1.0 op_sel_hi:[1,0]
    v_pk_add_f32 v[66:67], v[66:67], 1.0 op_sel_hi:[1,0]
    v_pk_add_f32 v[68:69], v[68:69], 1.0 op_sel_hi:[1,0]
    v_pk_add_f32 v[70:71], v[70:71], 1.0 op_sel_hi:[1,0]
    v_rcp_f32 v56, v56
    v_rcp_f32 v57, v57
    v_rcp_f32 v58, v58
    v_rcp_f32 v59, v59
    v_rcp_f32 v60, v60
    v_rcp_f32 v61, v61
    v_rcp_f32 v62, v62
    v_rcp_f32 v63, v63
    v_rcp_f32 v64, v64
    v_rcp_f32 v65, v65
    v_rcp_f32 v66, v66
    v_rcp_f32 v67, v67
    v_rcp_f32 v68, v68
    v_rcp_f32 v69, v69
    v_rcp_f32 v70, v70
    v_rcp_f32 v71, v71
    v_pk_mul_f32 v[112:113], v[112:113], v[56:57]
    v_pk_mul_f32 v[114:115], v[114:115], v[58:59]
    v_pk_mul_f32 v[116:117], v[116:117], v[60:61]
    v_pk_mul_f32 v[118:119], v[118:119], v[62:63]
    v_pk_mul_f32 v[120:121], v[120:121], v[64:65]
    v_pk_mul_f32 v[122:123], v[122:123], v[66:67]
    v_pk_mul_f32 v[124:125], v[124:125], v[68:69]
    v_pk_mul_f32 v[126:127], v[126:127], v[70:71]
    v_cvt_pk_bf16_f32 v128, v112, v113
    v_cvt_pk_bf16_f32 v129, v114, v115
    v_cvt_pk_bf16_f32 v130, v116, v117
    v_cvt_pk_bf16_f32 v131, v118, v119
    v_cvt_pk_bf16_f32 v132, v120, v121
    v_cvt_pk_bf16_f32 v133, v122, v123
    v_cvt_pk_bf16_f32 v134, v124, v125
    v_cvt_pk_bf16_f32 v135, v126, v127
    s_mov_b32 s42, 0
    s_branch k2_st0_in
k2_st0:
    buffer_load_dwordx2 v[160:161], v4, s[60:63], s37 offen offset:0 sc1
    buffer_load_dwordx2 v[162:163], v4, s[60:63], s37 offen offset:1024 sc1
    buffer_load_dwordx2 v[164:165], v4, s[60:63], s37 offen offset:2048 sc1
    buffer_load_dwordx2 v[166:167], v4, s[60:63], s37 offen offset:3072 sc1
    buffer_load_dwordx2 v[168:169], v4, s[60:63], s38 offen offset:0 sc1
    buffer_load_dwordx2 v[170:171], v4, s[60:63], s38 offen offset:1024 sc1
    buffer_load_dwordx2 v[172:173], v4, s[60:63], s38 offen offset:2048 sc1
    buffer_load_dwordx2 v[174:175], v4, s[60:63], s38 offen offset:3072 sc1
k2_st0_in:
    s_waitcnt vmcnt(0)
    s_add_u32 s42, s42, 1
    v_min3_u32 v5, v160, v161, v162
    v_min3_u32 v5, v5, v163, v164
    v_min3_u32 v5, v5, v165, v166
    v_min3_u32 v5, v5, v167, v168
    v_min3_u32 v5, v5, v169, v170
    v_min3_u32 v5, v5, v171, v172
    v_min3_u32 v5, v5, v173, v174
    v_min_u32 v5, v5, v175
    v_cmp_ne_u32 vcc, 0, v5
    s_cmp_eq_u64 vcc, -1
    s_cbranch_scc1 k2_st0_ok
    s_sleep 1
    s_cmp_lt_u32 s42, 200000
    s_cbranch_scc1 k2_st0
k2_st0_ok:
    buffer_store_dwordx4 v[128:131], v1, s[64:67], s39 offen offset:0 sc1
    buffer_store_dwordx4 v[132:135], v1, s[64:67], s39 offen offset:1024 sc1
    v_pk_add_f32 v[160:161], v[160:161], v[162:163]
    v_pk_add_f32 v[164:165], v[164:165], v[166:167]
    v_pk_add_f32 v[168:169], v[168:169], v[170:171]
    v_pk_add_f32 v[172:173], v[172:173], v[174:175]
    v_pk_add_f32 v[160:161], v[160:161], v[164:165]
    v_pk_add_f32 v[168:169], v[168:169], v[172:173]
    v_pk_add_f32 v[160:161], v[160:161], v[168:169]
    v_mov_b32 v162, v160
    v_mov_b32 v163, v161
    s_lshl_b32 s36, s5, 8
    s_add_u32 s36, s36, 2048
    v_permlane32_swap_b32 v160, v162
    v_permlane32_swap_b32 v161, v163
    v_pk_add_f32 v[160:161], v[160:161], v[162:163]
    v_lshl_add_u32 v10, v2, 2, s36
    v_mov_b32 v162, 0x3aaaaaab
    v_fmaak_f32 v8, v160, v162, 0xbeaaaaab
    v_fmaak_f32 v9, v161, v162, 0xbcaa95b2
    v_fma_f32 v9, -v8, v8, v9
    v_max_f32 v9, 0x3727c5ac, v9
    v_rsq_f32 v11, v9
    s_nop 0
    v_mul_f32 v9, v8, v11
    v_sub_f32 v9, 0, v9
    v_mov_b32 v8, v11
    ds_write_b32 v10, v8
    ds_write_b32 v10, v9 offset:128
    v_lshl_add_u32 v10, v3, 4, s36
    s_lshl_b32 s37, s25, 7
    s_lshl_b32 s38, s6, 1
    s_add_u32 s37, s37, s38
    s_mul_i32 s37, s37, 3072
    s_add_u32 s37, s37, 0
    s_add_u32 s38, s37, 3072
    s_waitcnt lgkmcnt(0)
    ds_read_b128 v[16:19], v10 offset:0
    ds_read_b128 v[32:35], v10 offset:128
    ds_read_b128 v[20:23], v10 offset:32
    ds_read_b128 v[36:39], v10 offset:160
    ds_read_b128 v[24:27], v10 offset:64
    ds_read_b128 v[40:43], v10 offset:192
    ds_read_b128 v[28:31], v10 offset:96
    ds_read_b128 v[44:47], v10 offset:224
    s_waitcnt lgkmcnt(0)
    v_pk_fma_f32 v[80:81], v[80:81], v[16:17], v[32:33]
    v_pk_fma_f32 v[82:83], v[82:83], v[18:19], v[34:35]
    v_pk_fma_f32 v[84:85], v[84:85], v[20:21], v[36:37]
    v_pk_fma_f32 v[86:87], v[86:87], v[22:23], v[38:39]
    v_pk_fma_f32 v[88:89], v[88:89], v[24:25], v[40:41]
    v_pk_fma_f32 v[90:91], v[90:91], v[26:27], v[42:43]
    v_pk_fma_f32 v[92:93], v[92:93], v[28:29], v[44:45]
    v_pk_fma_f32 v[94:95], v[94:95], v[30:31], v[46:47]
    v_cvt_pk_bf16_f32 v56, v80, v81
    v_cvt_pk_bf16_f32 v57, v82, v83
    v_cvt_pk_bf16_f32 v58, v84, v85
    v_cvt_pk_bf16_f32 v59, v86, v87
    v_cvt_pk_bf16_f32 v60, v88, v89
    v_cvt_pk_bf16_f32 v61, v90, v91
    v_cvt_pk_bf16_f32 v62, v92, v93
    v_cvt_pk_bf16_f32 v63, v94, v95
    s_nop 0
    v_permlane32_swap_b32 v56, v58
    v_permlane32_swap_b32 v57, v59
    buffer_store_dwordx4 v[56:59], v1, s[68:71], s37 offen offset:0 sc1
    v_permlane32_swap_b32 v60, v62
    v_permlane32_swap_b32 v61, v63
    buffer_store_dwordx4 v[60:63], v1, s[68:71], s38 offen offset:0 sc1
    v_pk_fma_f32 v[96:97], v[96:97], v[16:17], v[32:33]
    v_pk_fma_f32 v[98:99], v[98:99], v[18:19], v[34:35]
    v_pk_fma_f32 v[100:101], v[100:101], v[20:21], v[36:37]
    v_pk_fma_f32 v[102:103], v[102:103], v[22:23], v[38:39]
    v_pk_fma_f32 v[104:105], v[104:105], v[24:25], v[40:41]
    v_pk_fma_f32 v[106:107], v[106:107], v[26:27], v[42:43]
    v_pk_fma_f32 v[108:109], v[108:109], v[28:29], v[44:45]
    v_pk_fma_f32 v[110:111], v[110:111], v[30:31], v[46:47]
    v_cvt_pk_bf16_f32 v64, v96, v97
    v_cvt_pk_bf16_f32 v65, v98, v99
    v_cvt_pk_bf16_f32 v66, v100, v101
    v_cvt_pk_bf16_f32 v67, v102, v103
    v_cvt_pk_bf16_f32 v68, v104, v105
    v_cvt_pk_bf16_f32 v69, v106, v107
    v_cvt_pk_bf16_f32 v70, v108, v109
    v_cvt_pk_bf16_f32 v71, v110, v111
    s_nop 0
    v_permlane32_swap_b32 v64, v66
    v_permlane32_swap_b32 v65, v67
    buffer_store_dwordx4 v[64:67], v1, s[68:71], s37 offen offset:1024 sc1
    v_permlane32_swap_b32 v68, v70
    v_permlane32_swap_b32 v69, v71
    buffer_store_dwordx4 v[68:71], v1, s[68:71], s38 offen offset:1024 sc1
    s_branch k2_zdone
k2_p4B:
    s_waitcnt vmcnt(11) lgkmcnt(3)
    v_mfma_f32_32x32x16_bf16 v[80:95], v[16:19], v[128:131], 0
    ds_read_b128 v[152:155], v14 offset:6144
    ds_read_b128 v[156:159], v14 offset:7168
    ds_read_b128 v[160:163], v14 offset:8192
    v_mfma_f32_32x32x16_bf16 v[96:111], v[132:135], v[16:19], 0
    s_add_u32 s38, s7, 131072
    buffer_load_dwordx4 v[64:67], v1, s[52:55], s38 offen sc1
    v_mfma_f32_32x32x16_bf16 v[112:127], v[136:139], v[16:19], 0
    s_waitcnt vmcnt(11) lgkmcnt(3)
    v_mfma_f32_32x32x16_bf16 v[80:95], v[20:23], v[140:143], v[80:95]
    ds_read_b128 v[128:131], v14 offset:9216
    ds_read_b128 v[132:135], v14 offset:10240
    ds_read_b128 v[136:139], v14 offset:11264
    v_mfma_f32_32x32x16_bf16 v[96:111], v[144:147], v[20:23], v[96:111]
    s_add_u32 s38, s7, 135168
    buffer_load_dwordx4 v[68:71], v1, s[52:55], s38 offen sc1
    v_mfma_f32_32x32x16_bf16 v[112:127], v[148:151], v[20:23], v[112:127]
    s_waitcnt vmcnt(11) lgkmcnt(3)
    v_mfma_f32_32x32x16_bf16 v[80:95], v[24:27], v[152:155], v[80:95]
    ds_read_b128 v[140:143], v14 offset:12288
    ds_read_b128 v[144:147], v14 offset:13312
    ds_read_b128 v[148:151], v14 offset:14336
    v_mfma_f32_32x32x16_bf16 v[96:111], v[156:159], v[24:27], v[96:111]
    s_add_u32 s38, s7, 139264
    buffer_load_dwordx4 v[72:75], v1, s[52:55], s38 offen sc1
    v_mfma_f32_32x32x16_bf16 v[112:127], v[160:163], v[24:27], v[112:127]
    s_waitcnt vmcnt(11) lgkmcnt(3)
    v_mfma_f32_32x32x16_bf16 v[80:95], v[28:31], v[128:131], v[80:95]
    ds_read_b128 v[152:155], v14 offset:15360
    ds_read_b128 v[156:159], v14 offset:16384
    ds_read_b128 v[160:163], v14 offset:17408
    v_mfma_f32_32x32x16_bf16 v[96:111], v[132:135], v[28:31], v[96:111]
    s_add_u32 s38, s7, 143360
    buffer_load_dwordx4 v[76:79], v1, s[52:55], s38 offen sc1
    v_mfma_f32_32x32x16_bf16 v[112:127], v[136:139], v[28:31], v[112:127]
    s_waitcnt vmcnt(11) lgkmcnt(3)
    v_mfma_f32_32x32x16_bf16 v[80:95], v[32:35], v[140:143], v[80:95]
    ds_read_b128 v[128:131], v14 offset:18432
    ds_read_b128 v[132:135], v14 offset:19456
    ds_read_b128 v[136:139], v14 offset:20480
    v_mfma_f32_32x32x16_bf16 v[96:111], v[144:147], v[32:35], v[96:111]
    s_add_u32 s38, s7, 147456
    buffer_load_dwordx4 v[16:19], v1, s[52:55], s38 offen sc1
    v_mfma_f32_32x32x16_bf16 v[112:127], v[148:151], v[32:35], v[112:127]
    s_waitcnt vmcnt(11) lgkmcnt(3)
    v_mfma_f32_32x32x16_bf16 v[80:95], v[36:39], v[152:155], v[80:95]
    ds_read_b128 v[140:143], v14 offset:21504
    ds_read_b128 v[144:147], v14 offset:22528
    ds_read_b128 v[148:151], v14 offset:23552
    v_mfma_f32_32x32x16_bf16 v[96:111], v[156:159], v[36:39], v[96:111]
    s_add_u32 s38, s7, 151552
    buffer_load_dwordx4 v[20:23], v1, s[52:55], s38 offen sc1
    v_mfma_f32_32x32x16_bf16 v[112:127], v[160:163], v[36:39], v[112:127]
    s_waitcnt vmcnt(11) lgkmcnt(3)
    v_mfma_f32_32x32x16_bf16 v[80:95], v[40:43], v[128:131], v[80:95]
    ds_read_b128 v[152:155], v14 offset:24576
    ds_read_b128 v[156:159], v14 offset:25600
    ds_read_b128 v[160:163], v14 offset:26624
    v_mfma_f32_32x32x16_bf16 v[96:111], v[132:135], v[40:43], v[96:111]
    s_add_u32 s38, s7, 155648
    buffer_load_dwordx4 v[24:27], v1, s[52:55], s38 offen sc1
    v_mfma_f32_32x32x16_bf16 v[112:127], v[136:139], v[40:43], v[112:127]
    s_waitcnt vmcnt(11) lgkmcnt(3)
    v_mfma_f32_32x32x16_bf16 v[80:95], v[44:47], v[140:143], v[80:95]
    ds_read_b128 v[128:131], v14 offset:27648
    ds_read_b128 v[132:135], v14 offset:28672
    ds_read_b128 v[136:139], v14 offset:29696
    v_mfma_f32_32x32x16_bf16 v[96:111], v[144:147], v[44:47], v[96:111]
    s_add_u32 s38, s7, 159744
    buffer_load_dwordx4 v[28:31], v1, s[52:55], s38 offen sc1
    v_mfma_f32_32x32x16_bf16 v[112:127], v[148:151], v[44:47], v[112:127]
    s_waitcnt vmcnt(11) lgkmcnt(3)
    v_mfma_f32_32x32x16_bf16 v[80:95], v[48:51], v[152:155], v[80:95]
    ds_read_b128 v[140:143], v14 offset:30720
    ds_read_b128 v[144:147], v14 offset:31744
    ds_read_b128 v[148:151], v14 offset:32768
    v_mfma_f32_32x32x16_bf16 v[96:111], v[156:159], v[48:51], v[96:111]
    s_add_u32 s38, s7, 0
    buffer_load_dwordx4 v[32:35], v1, s[52:55], s38 offen sc1
    v_mfma_f32_32x32x16_bf16 v[112:127], v[160:163], v[48:51], v[112:127]
    s_waitcnt vmcnt(11) lgkmcnt(3)
    v_mfma_f32_32x32x16_bf16 v[80:95], v[52:55], v[128:131], v[80:95]
    ds_read_b128 v[152:155], v14 offset:33792
    ds_read_b128 v[156:159], v14 offset:34816
    ds_read_b128 v[160:163], v14 offset:35840
    v_mfma_f32_32x32x16_bf16 v[96:111], v[132:135], v[52:55], v[96:111]
    s_add_u32 s38, s7, 4096
    buffer_load_dwordx4 v[36:39], v1, s[52:55], s38 offen sc1
    v_mfma_f32_32x32x16_bf16 v[112:127], v[136:139], v[52:55], v[112:127]
    s_waitcnt vmcnt(11) lgkmcnt(3)
    v_mfma_f32_32x32x16_bf16 v[80:95], v[56:59], v[140:143], v[80:95]
    ds_read_b128 v[128:131], v14 offset:36864
    ds_read_b128 v[132:135], v14 offset:37888
    ds_read_b128 v[136:139], v14 offset:38912
    v_mfma_f32_32x32x16_bf16 v[96:111], v[144:147], v[56:59], v[96:111]
    s_add_u32 s38, s7, 8192
    buffer_load_dwordx4 v[40:43], v1, s[52:55], s38 offen sc1
    v_mfma_f32_32x32x16_bf16 v[112:127], v[148:151], v[56:59], v[112:127]
    s_barrier
    s_waitcnt vmcnt(11) lgkmcnt(3)
    v_mfma_f32_32x32x16_bf16 v[80:95], v[60:63], v[152:155], v[80:95]
    ds_read_b128 v[140:143], v14 offset:39936
    ds_read_b128 v[144:147], v14 offset:40960
    ds_read_b128 v[148:151], v14 offset:41984
    v_mfma_f32_32x32x16_bf16 v[96:111], v[156:159], v[60:63], v[96:111]
    s_add_u32 s38, s7, 12288
    buffer_load_dwordx4 v[44:47], v1, s[52:55], s38 offen sc1
    v_mfma_f32_32x32x16_bf16 v[112:127], v[160:163], v[60:63], v[112:127]
    s_waitcnt vmcnt(11) lgkmcnt(3)
    v_mfma_f32_32x32x16_bf16 v[80:95], v[64:67], v[128:131], v[80:95]
    ds_read_b128 v[152:155], v14 offset:43008
    ds_read_b128 v[156:159], v14 offset:44032
    ds_read_b128 v[160:163], v14 offset:45056
    v_mfma_f32_32x32x16_bf16 v[96:111], v[132:135], v[64:67], v[96:111]
    s_add_u32 s38, s7, 16384
    buffer_load_dwordx4 v[48:51], v1, s[52:55], s38 offen sc1
    v_mfma_f32_32x32x16_bf16 v[112:127], v[136:139], v[64:67], v[112:127]
    s_waitcnt vmcnt(11) lgkmcnt(3)
    v_mfma_f32_32x32x16_bf16 v[80:95], v[68:71], v[140:143], v[80:95]
    ds_read_b128 v[128:131], v14 offset:46080
    ds_read_b128 v[132:135], v14 offset:47104
    ds_read_b128 v[136:139], v14 offset:48128
    v_mfma_f32_32x32x16_bf16 v[96:111], v[144:147], v[68:71], v[96:111]
    s_add_u32 s38, s7, 20480
    buffer_load_dwordx4 v[52:55], v1, s[52:55], s38 offen sc1
    v_mfma_f32_32x32x16_bf16 v[112:127], v[148:151], v[68:71], v[112:127]
    s_waitcnt vmcnt(11) lgkmcnt(3)
    v_mfma_f32_32x32x16_bf16 v[80:95], v[72:75], v[152:155], v[80:95]
    ds_read_b128 v[140:143], v14 offset:49152
    ds_read_b128 v[144:147], v14 offset:50176
    ds_read_b128 v[148:151], v14 offset:51200
    v_mfma_f32_32x32x16_bf16 v[96:111], v[156:159], v[72:75], v[96:111]
    s_add_u32 s38, s7, 24576
    buffer_load_dwordx4 v[56:59], v1, s[52:55], s38 offen sc1
    v_mfma_f32_32x32x16_bf16 v[112:127], v[160:163], v[72:75], v[112:127]
    s_waitcnt vmcnt(11) lgkmcnt(3)
    v_mfma_f32_32x32x16_bf16 v[80:95], v[76:79], v[128:131], v[80:95]
    ds_read_b128 v[152:155], v14 offset:52224
    ds_read_b128 v[156:159], v14 offset:53248
    ds_read_b128 v[160:163], v14 offset:54272
    v_mfma_f32_32x32x16_bf16 v[96:111], v[132:135], v[76:79], v[96:111]
    s_add_u32 s38, s7, 28672
    buffer_load_dwordx4 v[60:63], v1, s[52:55], s38 offen sc1
    v_mfma_f32_32x32x16_bf16 v[112:127], v[136:139], v[76:79], v[112:127]
    s_waitcnt vmcnt(11) lgkmcnt(3)
    v_mfma_f32_32x32x16_bf16 v[80:95], v[16:19], v[140:143], v[80:95]
    ds_read_b128 v[128:131], v14 offset:55296
    ds_read_b128 v[132:135], v14 offset:56320
    ds_read_b128 v[136:139], v14 offset:57344
    v_mfma_f32_32x32x16_bf16 v[96:111], v[144:147], v[16:19], v[96:111]
    s_add_u32 s38, s7, 32768
    buffer_load_dwordx4 v[64:67], v1, s[52:55], s38 offen sc1
    v_mfma_f32_32x32x16_bf16 v[112:127], v[148:151], v[16:19], v[112:127]
    s_waitcnt vmcnt(11) lgkmcnt(3)
    v_mfma_f32_32x32x16_bf16 v[80:95], v[20:23], v[152:155], v[80:95]
    ds_read_b128 v[140:143], v14 offset:58368
    ds_read_b128 v[144:147], v14 offset:59392
    ds_read_b128 v[148:151], v14 offset:60416
    v_mfma_f32_32x32x16_bf16 v[96:111], v[156:159], v[20:23], v[96:111]
    s_add_u32 s38, s7, 36864
    buffer_load_dwordx4 v[68:71], v1, s[52:55], s38 offen sc1
    v_mfma_f32_32x32x16_bf16 v[112:127], v[160:163], v[20:23], v[112:127]
    s_waitcnt vmcnt(11) lgkmcnt(3)
    v_mfma_f32_32x32x16_bf16 v[80:95], v[24:27], v[128:131], v[80:95]
    ds_read_b128 v[152:155], v7 offset:0
    ds_read_b128 v[156:159], v7 offset:1024
    ds_read_b128 v[160:163], v7 offset:2048
    v_mfma_f32_32x32x16_bf16 v[96:111], v[132:135], v[24:27], v[96:111]
    s_add_u32 s38, s7, 40960
    buffer_load_dwordx4 v[72:75], v1, s[52:55], s38 offen sc1
    v_mfma_f32_32x32x16_bf16 v[112:127], v[136:139], v[24:27], v[112:127]
    s_waitcnt vmcnt(11) lgkmcnt(3)
    v_mfma_f32_32x32x16_bf16 v[80:95], v[28:31], v[140:143], v[80:95]
    ds_read_b128 v[128:131], v7 offset:3072
    ds_read_b128 v[132:135], v7 offset:4096
    ds_read_b128 v[136:139], v7 offset:5120
    v_mfma_f32_32x32x16_bf16 v[96:111], v[144:147], v[28:31], v[96:111]
    s_add_u32 s38, s7, 45056
    buffer_load_dwordx4 v[76:79], v1, s[52:55], s38 offen sc1
    v_mfma_f32_32x32x16_bf16 v[112:127], v[148:151], v[28:31], v[112:127]
    s_waitcnt vmcnt(11) lgkmcnt(3)
    v_mfma_f32_32x32x16_bf16 v[80:95], v[32:35], v[152:155], v[80:95]
    ds_read_b128 v[140:143], v7 offset:6144
    ds_read_b128 v[144:147], v7 offset:7168
    ds_read_b128 v[148:151], v7 offset:8192
    v_mfma_f32_32x32x16_bf16 v[96:111], v[156:159], v[32:35], v[96:111]
    s_add_u32 s38, s7, 49152
    buffer_load_dwordx4 v[16:19], v1, s[52:55], s38 offen sc1
    v_mfma_f32_32x32x16_bf16 v[112:127], v[160:163], v[32:35], v[112:127]
    s_waitcnt vmcnt(11) lgkmcnt(3)
    v_mfma_f32_32x32x16_bf16 v[80:95], v[36:39], v[128:131], v[80:95]
    ds_read_b128 v[152:155], v7 offset:9216
    ds_read_b128 v[156:159], v7 offset:10240
    ds_read_b128 v[160:163], v7 offset:11264
    v_mfma_f32_32x32x16_bf16 v[96:111], v[132:135], v[36:39], v[96:111]
    s_add_u32 s38, s7, 53248
    buffer_load_dwordx4 v[20:23], v1, s[52:55], s38 offen sc1
    v_mfma_f32_32x32x16_bf16 v[112:127], v[136:139], v[36:39], v[112:127]
    v_pk_add_f32 v[164:165], v[164:165], v[166:167]
    v_pk_add_f32 v[168:169], v[168:169], v[170:171]
    v_pk_add_f32 v[164:165], v[164:165], v[168:169]
    v_mov_b32 v166, v164
    v_mov_b32 v167, v165
    s_lshl_b32 s36, s5, 8
    s_add_u32 s36, s36, 2048
    v_permlane32_swap_b32 v164, v166
    v_permlane32_swap_b32 v165, v167
    v_pk_add_f32 v[164:165], v[164:165], v[166:167]
    v_lshl_add_u32 v10, v2, 2, s36
    v_mov_b32 v166, 0x3acccccd
    v_fmaak_f32 v8, v164, v166, 0x80000000
    v_fmaak_f32 v9, v165, v166, 0x3727c5ac
    v_fma_f32 v9, -v8, v8, v9
    v_max_f32 v9, 0x3727c5ac, v9
    v_rsq_f32 v11, v9
    s_nop 0
    v_mul_f32 v9, v8, v11
    v_sub_f32 v9, 0, v9
    v_mov_b32 v8, v11
    ds_write_b32 v10, v8
    ds_write_b32 v10, v9 offset:128
    s_waitcnt vmcnt(11) lgkmcnt(3)
    v_mfma_f32_32x32x16_bf16 v[80:95], v[40:43], v[140:143], v[80:95]
    ds_read_b128 v[128:131], v7 offset:12288
    ds_read_b128 v[132:135], v7 offset:13312
    ds_read_b128 v[136:139], v7 offset:14336
    v_mfma_f32_32x32x16_bf16 v[96:111], v[144:147], v[40:43], v[96:111]
    s_add_u32 s38, s7, 57344
    buffer_load_dwordx4 v[24:27], v1, s[52:55], s38 offen sc1
    v_mfma_f32_32x32x16_bf16 v[112:127], v[148:151], v[40:43], v[112:127]
    s_waitcnt vmcnt(11) lgkmcnt(3)
    v_mfma_f32_32x32x16_bf16 v[80:95], v[44:47], v[152:155], v[80:95]
    ds_read_b128 v[140:143], v7 offset:15360
    ds_read_b128 v[144:147], v7 offset:16384
    ds_read_b128 v[148:151], v7 offset:17408
    v_mfma_f32_32x32x16_bf16 v[96:111], v[156:159], v[44:47], v[96:111]
    s_add_u32 s38, s7, 61440
    buffer_load_dwordx4 v[28:31], v1, s[52:55], s38 offen sc1
    v_mfma_f32_32x32x16_bf16 v[112:127], v[160:163], v[44:47], v[112:127]
    s_waitcnt vmcnt(11) lgkmcnt(3)
    v_mfma_f32_32x32x16_bf16 v[80:95], v[48:51], v[128:131], v[80:95]
    ds_read_b128 v[152:155], v7 offset:18432
    ds_read_b128 v[156:159], v7 offset:19456
    ds_read_b128 v[160:163], v7 offset:20480
    v_mfma_f32_32x32x16_bf16 v[96:111], v[132:135], v[48:51], v[96:111]
    s_add_u32 s38, s7, 65536
    buffer_load_dwordx4 v[32:35], v1, s[52:55], s38 offen sc1
    v_mfma_f32_32x32x16_bf16 v[112:127], v[136:139], v[48:51], v[112:127]
    s_waitcnt vmcnt(11) lgkmcnt(3)
    v_mfma_f32_32x32x16_bf16 v[80:95], v[52:55], v[140:143], v[80:95]
    ds_read_b128 v[128:131], v7 offset:21504
    ds_read_b128 v[132:135], v7 offset:22528
    ds_read_b128 v[136:139], v7 offset:23552
    v_mfma_f32_32x32x16_bf16 v[96:111], v[144:147], v[52:55], v[96:111]
    s_add_u32 s38, s7, 69632
    buffer_load_dwordx4 v[36:39], v1, s[52:55], s38 offen sc1
    v_mfma_f32_32x32x16_bf16 v[112:127], v[148:151], v[52:55], v[112:127]
    s_waitcnt vmcnt(11) lgkmcnt(3)
    v_mfma_f32_32x32x16_bf16 v[80:95], v[56:59], v[152:155], v[80:95]
    ds_read_b128 v[140:143], v7 offset:24576
    ds_read_b128 v[144:147], v7 offset:25600
    ds_read_b128 v[148:151], v7 offset:26624
    v_mfma_f32_32x32x16_bf16 v[96:111], v[156:159], v[56:59], v[96:111]
    s_add_u32 s38, s7, 73728
    buffer_load_dwordx4 v[40:43], v1, s[52:55], s38 offen sc1
    v_mfma_f32_32x32x16_bf16 v[112:127], v[160:163], v[56:59], v[112:127]
    s_waitcnt vmcnt(11) lgkmcnt(3)
    v_mfma_f32_32x32x16_bf16 v[80:95], v[60:63], v[128:131], v[80:95]
    ds_read_b128 v[152:155], v7 offset:27648
    ds_read_b128 v[156:159], v7 offset:28672
    ds_read_b128 v[160:163], v7 offset:29696
    v_mfma_f32_32x32x16_bf16 v[96:111], v[132:135], v[60:63], v[96:111]
    s_add_u32 s38, s7, 77824
    buffer_load_dwordx4 v[44:47], v1, s[52:55], s38 offen sc1
    v_mfma_f32_32x32x16_bf16 v[112:127], v[136:139], v[60:63], v[112:127]
    s_waitcnt vmcnt(11) lgkmcnt(3)
    v_mfma_f32_32x32x16_bf16 v[80:95], v[64:67], v[140:143], v[80:95]
    ds_read_b128 v[128:131], v7 offset:30720
    ds_read_b128 v[132:135], v7 offset:31744
    ds_read_b128 v[136:139], v7 offset:32768
    v_mfma_f32_32x32x16_bf16 v[96:111], v[144:147], v[64:67], v[96:111]
    v_mfma_f32_32x32x16_bf16 v[112:127], v[148:151], v[64:67], v[112:127]
    s_waitcnt vmcnt(10) lgkmcnt(3)
    v_mfma_f32_32x32x16_bf16 v[80:95], v[68:71], v[152:155], v[80:95]
    ds_read_b128 v[140:143], v7 offset:33792
    ds_read_b128 v[144:147], v7 offset:34816
    ds_read_b128 v[148:151], v7 offset:35840
    v_mfma_f32_32x32x16_bf16 v[96:111], v[156:159], v[68:71], v[96:111]
    v_mfma_f32_32x32x16_bf16 v[112:127], v[160:163], v[68:71], v[112:127]
    s_waitcnt vmcnt(9) lgkmcnt(3)
    v_mfma_f32_32x32x16_bf16 v[80:95], v[72:75], v[128:131], v[80:95]
    ds_read_b128 v[152:155], v7 offset:36864
    ds_read_b128 v[156:159], v7 offset:37888
    ds_read_b128 v[160:163], v7 offset:38912
    v_mfma_f32_32x32x16_bf16 v[96:111], v[132:135], v[72:75], v[96:111]
    v_mfma_f32_32x32x16_bf16 v[112:127], v[136:139], v[72:75], v[112:127]
    s_waitcnt vmcnt(8) lgkmcnt(3)
    v_mfma_f32_32x32x16_bf16 v[80:95], v[76:79], v[140:143], v[80:95]
    ds_read_b128 v[128:131], v7 offset:39936
    ds_read_b128 v[132:135], v7 offset:40960
    ds_read_b128 v[136:139], v7 offset:41984
    v_mfma_f32_32x32x16_bf16 v[96:111], v[144:147], v[76:79], v[96:111]
    v_mfma_f32_32x32x16_bf16 v[112:127], v[148:151], v[76:79], v[112:127]
    s_waitcnt vmcnt(7) lgkmcnt(3)
    v_mfma_f32_32x32x16_bf16 v[80:95], v[16:19], v[152:155], v[80:95]
    ds_read_b128 v[140:143], v7 offset:43008
    ds_read_b128 v[144:147], v7 offset:44032
    ds_read_b128 v[148:151], v7 offset:45056
    v_mfma_f32_32x32x16_bf16 v[96:111], v[156:159], v[16:19], v[96:111]
    v_mfma_f32_32x32x16_bf16 v[112:127], v[160:163], v[16:19], v[112:127]
    s_waitcnt vmcnt(6) lgkmcnt(3)
    v_mfma_f32_32x32x16_bf16 v[80:95], v[20:23], v[128:131], v[80:95]
    ds_read_b128 v[152:155], v7 offset:46080
    ds_read_b128 v[156:159], v7 offset:47104
    ds_read_b128 v[160:163], v7 offset:48128
    v_mfma_f32_32x32x16_bf16 v[96:111], v[132:135], v[20:23], v[96:111]
    v_mfma_f32_32x32x16_bf16 v[112:127], v[136:139], v[20:23], v[112:127]
    s_waitcnt vmcnt(5) lgkmcnt(3)
    v_mfma_f32_32x32x16_bf16 v[80:95], v[24:27], v[140:143], v[80:95]
    ds_read_b128 v[128:131], v7 offset:49152
    ds_read_b128 v[132:135], v7 offset:50176
    ds_read_b128 v[136:139], v7 offset:51200
    v_mfma_f32_32x32x16_bf16 v[96:111], v[144:147], v[24:27], v[96:111]
    v_mfma_f32_32x32x16_bf16 v[112:127], v[148:151], v[24:27], v[112:127]
    s_waitcnt vmcnt(4) lgkmcnt(3)
    v_mfma_f32_32x32x16_bf16 v[80:95], v[28:31], v[152:155], v[80:95]
    ds_read_b128 v[140:143], v7 offset:52224
    ds_read_b128 v[144:147], v7 offset:53248
    ds_read_b128 v[148:151], v7 offset:54272
    v_mfma_f32_32x32x16_bf16 v[96:111], v[156:159], v[28:31], v[96:111]
    v_mfma_f32_32x32x16_bf16 v[112:127], v[160:163], v[28:31], v[112:127]
    s_waitcnt vmcnt(3) lgkmcnt(3)
    v_mfma_f32_32x32x16_bf16 v[80:95], v[32:35], v[128:131], v[80:95]
    ds_read_b128 v[152:155], v7 offset:55296
    ds_read_b128 v[156:159], v7 offset:56320
    ds_read_b128 v[160:163], v7 offset:57344
    v_mfma_f32_32x32x16_bf16 v[96:111], v[132:135], v[32:35], v[96:111]
    v_mfma_f32_32x32x16_bf16 v[112:127], v[136:139], v[32:35], v[112:127]
    s_waitcnt vmcnt(2) lgkmcnt(3)
    v_mfma_f32_32x32x16_bf16 v[80:95], v[36:39], v[140:143], v[80:95]
    ds_read_b128 v[128:131], v7 offset:58368
    ds_read_b128 v[132:135], v7 offset:59392
    ds_read_b128 v[136:139], v7 offset:60416
    v_mfma_f32_32x32x16_bf16 v[96:111], v[144:147], v[36:39], v[96:111]
    v_mfma_f32_32x32x16_bf16 v[112:127], v[148:151], v[36:39], v[112:127]
    s_waitcnt vmcnt(1) lgkmcnt(3)
    v_mfma_f32_32x32x16_bf16 v[80:95], v[40:43], v[152:155], v[80:95]
    v_mfma_f32_32x32x16_bf16 v[96:111], v[156:159], v[40:43], v[96:111]
    v_mfma_f32_32x32x16_bf16 v[112:127], v[160:163], v[40:43], v[112:127]
    s_waitcnt vmcnt(0) lgkmcnt(0)
    v_mfma_f32_32x32x16_bf16 v[80:95], v[44:47], v[128:131], v[80:95]
    v_mfma_f32_32x32x16_bf16 v[96:111], v[132:135], v[44:47], v[96:111]
    v_mfma_f32_32x32x16_bf16 v[112:127], v[136:139], v[44:47], v[112:127]
    s_barrier
    v_lshl_add_u32 v10, v3, 4, s36
    v_lshlrev_b32 v11, 2, v2
    ds_read_b128 v[16:19], v10 offset:0
    ds_read_b128 v[32:35], v10 offset:128
    ds_read_b128 v[20:23], v10 offset:32
    ds_read_b128 v[36:39], v10 offset:160
    ds_read_b128 v[24:27], v10 offset:64
    ds_read_b128 v[40:43], v10 offset:192
    ds_read_b128 v[28:31], v10 offset:96
    ds_read_b128 v[44:47], v10 offset:224
    ds_read_b32 v48, v11 offset:0
    ds_read_b32 v49, v11 offset:1024
    s_add_u32 s60, s8, 0x10000
    s_addc_u32 s61, s9, 0
    s_mov_b32 s62, 0x40000
    s_mov_b32 s63, 0x20000
    s_add_u32 s64, s8, 0x1500000
    s_addc_u32 s65, s9, 0
    s_mov_b32 s66, 0x300000
    s_mov_b32 s67, 0x20000
    s_add_u32 s68, s8, 0x1800000
    s_addc_u32 s69, s9, 0
    s_mov_b32 s70, 0x300000
    s_mov_b32 s71, 0x20000
    v_lshlrev_b32 v15, 4, v3
    s_waitcnt lgkmcnt(0)
    ds_read_b128 v[160:163], v15 offset:128
    ds_read_b128 v[176:179], v15 offset:1152
    ds_read_b128 v[164:167], v15 offset:160
    ds_read_b128 v[180:183], v15 offset:1184
    ds_read_b128 v[168:171], v15 offset:192
    ds_read_b128 v[184:187], v15 offset:1216
    ds_read_b128 v[172:175], v15 offset:224
    ds_read_b128 v[188:191], v15 offset:1248
    v_pk_fma_f32 v[56:57], v[32:33], v[48:49], v[48:49] op_sel:[0,0,1] op_sel_hi:[1,0,1]
    v_pk_fma_f32 v[58:59], v[34:35], v[48:49], v[48:49] op_sel:[0,0,1] op_sel_hi:[1,0,1]
    v_pk_fma_f32 v[60:61], v[36:37], v[48:49], v[48:49] op_sel:[0,0,1] op_sel_hi:[1,0,1]
    v_pk_fma_f32 v[62:63], v[38:39], v[48:49], v[48:49] op_sel:[0,0,1] op_sel_hi:[1,0,1]
    v_pk_fma_f32 v[64:65], v[40:41], v[48:49], v[48:49] op_sel:[0,0,1] op_sel_hi:[1,0,1]
    v_pk_fma_f32 v[66:67], v[42:43], v[48:49], v[48:49] op_sel:[0,0,1] op_sel_hi:[1,0,1]
    v_pk_fma_f32 v[68:69], v[44:45], v[48:49], v[48:49] op_sel:[0,0,1] op_sel_hi:[1,0,1]
    v_pk_fma_f32 v[70:71], v[46:47], v[48:49], v[48:49] op_sel:[0,0,1] op_sel_hi:[1,0,1]
    v_pk_fma_f32 v[80:81], v[80:81], v[16:17], v[56:57]
    v_pk_fma_f32 v[82:83], v[82:83], v[18:19], v[58:59]
    v_pk_fma_f32 v[84:85], v[84:85], v[20:21], v[60:61]
    v_pk_fma_f32 v[86:87], v[86:87], v[22:23], v[62:63]
    v_pk_fma_f32 v[88:89], v[88:89], v[24:25], v[64:65]
    v_pk_fma_f32 v[90:91], v[90:91], v[26:27], v[66:67]
    v_pk_fma_f32 v[92:93], v[92:93], v[28:29], v[68:69]
    v_pk_fma_f32 v[94:95], v[94:95], v[30:31], v[70:71]
    v_pk_mul_f32 v[56:57], v[80:81], v[80:81]
    v_pk_mul_f32 v[58:59], v[82:83], v[82:83]
    v_pk_mul_f32 v[60:61], v[84:85], v[84:85]
    v_pk_mul_f32 v[62:63], v[86:87], v[86:87]
    v_pk_mul_f32 v[64:65], v[88:89], v[88:89]
    v_pk_mul_f32 v[66:67], v[90:91], v[90:91]
    v_pk_mul_f32 v[68:69], v[92:93], v[92:93]
    v_pk_mul_f32 v[70:71], v[94:95], v[94:95]
    v_pk_fma_f32 v[56:57], v[56:57], v[12:13], v[12:13] op_sel:[0,1,0] op_sel_hi:[1,1,0]
    v_pk_fma_f32 v[58:59], v[58:59], v[12:13], v[12:13] op_sel:[0,1,0] op_sel_hi:[1,1,0]
    v_pk_fma_f32 v[60:61], v[60:61], v[12:13], v[12:13] op_sel:[0,1,0] op_sel_hi:[1,1,0]
    v_pk_fma_f32 v[62:63], v[62:63], v[12:13], v[12:13] op_sel:[0,1,0] op_sel_hi:[1,1,0]
    v_pk_fma_f32 v[64:65], v[64:65], v[12:13], v[12:13] op_sel:[0,1,0] op_sel_hi:[1,1,0]
    v_pk_fma_f32 v[66:67], v[66:67], v[12:13], v[12:13] op_sel:[0,1,0] op_sel_hi:[1,1,0]
    v_pk_fma_f32 v[68:69], v[68:69], v[12:13], v[12:13] op_sel:[0,1,0] op_sel_hi:[1,1,0]
    v_pk_fma_f32 v[70:71], v[70:71], v[12:13], v[12:13] op_sel:[0,1,0] op_sel_hi:[1,1,0]
    v_pk_mul_f32 v[56:57], v[56:57], v[80:81]
    v_pk_mul_f32 v[58:59], v[58:59], v[82:83]
    v_pk_mul_f32 v[60:61], v[60:61], v[84:85]
    v_pk_mul_f32 v[62:63], v[62:63], v[86:87]
    v_pk_mul_f32 v[64:65], v[64:65], v[88:89]
    v_pk_mul_f32 v[66:67], v[66:67], v[90:91]
    v_pk_mul_f32 v[68:69], v[68:69], v[92:93]
    v_pk_mul_f32 v[70:71], v[70:71], v[94:95]
    v_exp_f32 v56, v56
    v_exp_f32 v57, v57
    v_exp_f32 v58, v58
    v_exp_f32 v59, v59
    v_exp_f32 v60, v60
    v_exp_f32 v61, v61
    v_exp_f32 v62, v62
    v_exp_f32 v63, v63
    v_exp_f32 v64, v64
    v_exp_f32 v65, v65
    v_exp_f32 v66, v66
    v_exp_f32 v67, v67
    v_exp_f32 v68, v68
    v_exp_f32 v69, v69
    v_exp_f32 v70, v70
    v_exp_f32 v71, v71
    v_pk_add_f32 v[56:57], v[56:57], 1.0 op_sel_hi:[1,0]
    v_pk_add_f32 v[58:59], v[58:59], 1.0 op_sel_hi:[1,0]
    v_pk_add_f32 v[60:61], v[60:61], 1.0 op_sel_hi:[1,0]
    v_pk_add_f32 v[62:63], v[62:63], 1.0 op_sel_hi:[1,0]
    v_pk_add_f32 v[64:65], v[64:65], 1.0 op_sel_hi:[1,0]
    v_pk_add_f32 v[66:67], v[66:67], 1.0 op_sel_hi:[1,0]
    v_pk_add_f32 v[68:69], v[68:69], 1.0 op_sel_hi:[1,0]
    v_pk_add_f32 v[70:71], v[70:71], 1.0 op_sel_hi:[1,0]
    v_rcp_f32 v56, v56
    v_rcp_f32 v57, v57
    v_rcp_f32 v58, v58
    v_rcp_f32 v59, v59
    v_rcp_f32 v60, v60
    v_rcp_f32 v61, v61
    v_rcp_f32 v62, v62
    v_rcp_f32 v63, v63
    v_rcp_f32 v64, v64
    v_rcp_f32 v65, v65
    v_rcp_f32 v66, v66
    v_rcp_f32 v67, v67
    v_rcp_f32 v68, v68
    v_rcp_f32 v69, v69
    v_rcp_f32 v70, v70
    v_rcp_f32 v71, v71
    v_pk_mul_f32 v[80:81], v[80:81], v[56:57]
    v_pk_mul_f32 v[82:83], v[82:83], v[58:59]
    v_pk_mul_f32 v[84:85], v[84:85], v[60:61]
    v_pk_mul_f32 v[86:87], v[86:87], v[62:63]
    v_pk_mul_f32 v[88:89], v[88:89], v[64:65]
    v_pk_mul_f32 v[90:91], v[90:91], v[66:67]
    v_pk_mul_f32 v[92:93], v[92:93], v[68:69]
    v_pk_mul_f32 v[94:95], v[94:95], v[70:71]
    v_pk_mul_f32 v[144:145], v[80:81], v[80:81]
    v_pk_mul_f32 v[146:147], v[82:83], v[82:83]
    v_pk_mul_f32 v[148:149], v[84:85], v[84:85]
    v_pk_mul_f32 v[150:151], v[86:87], v[86:87]
    v_pk_mul_f32 v[152:153], v[88:89], v[88:89]
    v_pk_mul_f32 v[154:155], v[90:91], v[90:91]
    v_pk_mul_f32 v[156:157], v[92:93], v[92:93]
    v_pk_mul_f32 v[158:159], v[94:95], v[94:95]
    v_pk_mul_f32 v[128:129], v[80:81], 1.0 op_sel_hi:[1,0]
    v_pk_mul_f32 v[130:131], v[82:83], 1.0 op_sel_hi:[1,0]
    v_pk_mul_f32 v[132:133], v[84:85], 1.0 op_sel_hi:[1,0]
    v_pk_mul_f32 v[134:135], v[86:87], 1.0 op_sel_hi:[1,0]
    v_pk_mul_f32 v[136:137], v[88:89], 1.0 op_sel_hi:[1,0]
    v_pk_mul_f32 v[138:139], v[90:91], 1.0 op_sel_hi:[1,0]
    v_pk_mul_f32 v[140:141], v[92:93], 1.0 op_sel_hi:[1,0]
    v_pk_mul_f32 v[142:143], v[94:95], 1.0 op_sel_hi:[1,0]
    v_and_b32 v4, 3, v0
    v_bfe_u32 v5, v0, 2, 2
    v_permlane16_swap_b32 v128, v144
    v_permlane16_swap_b32 v129, v145
    v_permlane16_swap_b32 v130, v146
    v_permlane16_swap_b32 v131, v147
    v_permlane16_swap_b32 v132, v148
    v_permlane16_swap_b32 v133, v149
    v_permlane16_swap_b32 v134, v150
    v_permlane16_swap_b32 v135, v151
    v_permlane16_swap_b32 v136, v152
    v_permlane16_swap_b32 v137, v153
    v_permlane16_swap_b32 v138, v154
    v_permlane16_swap_b32 v139, v155
    v_permlane16_swap_b32 v140, v156
    v_permlane16_swap_b32 v141, v157
    v_permlane16_swap_b32 v142, v158
    v_permlane16_swap_b32 v143, v159
    v_add_f32 v128, v128, v144
    v_add_f32 v129, v129, v145
    v_add_f32 v130, v130, v146
    v_add_f32 v131, v131, v147
    v_add_f32 v132, v132, v148
    v_add_f32 v133, v133, v149
    v_add_f32 v134, v134, v150
    v_add_f32 v135, v135, v151
    v_add_f32 v136, v136, v152
    v_add_f32 v137, v137, v153
    v_add_f32 v138, v138, v154
    v_add_f32 v139, v139, v155
    v_add_f32 v140, v140, v156
    v_add_f32 v141, v141, v157
    v_add_f32 v142, v142, v158
    v_add_f32 v143, v143, v159
    v_add_f32_dpp v128, v128, v128 row_ror:8 row_mask:0xf bank_mask:0x3
    v_add_f32_dpp v129, v129, v129 row_ror:8 row_mask:0xf bank_mask:0x3
    v_add_f32_dpp v130, v130, v130 row_ror:8 row_mask:0xf bank_mask:0x3
    v_add_f32_dpp v131, v131, v131 row_ror:8 row_mask:0xf bank_mask:0x3
    v_add_f32_dpp v132, v132, v132 row_ror:8 row_mask:0xf bank_mask:0x3
    v_add_f32_dpp v133, v133, v133 row_ror:8 row_mask:0xf bank_mask:0x3
    v_add_f32_dpp v134, v134, v134 row_ror:8 row_mask:0xf bank_mask:0x3
    v_add_f32_dpp v135, v135, v135 row_ror:8 row_mask:0xf bank_mask:0x3
    v_add_f32_dpp v128, v136, v136 row_ror:8 row_mask:0xf bank_mask:0xc
    v_add_f32_dpp v129, v137, v137 row_ror:8 row_mask:0xf bank_mask:0xc
    v_add_f32_dpp v130, v138, v138 row_ror:8 row_mask:0xf bank_mask:0xc
    v_add_f32_dpp v131, v139, v139 row_ror:8 row_mask:0xf bank_mask:0xc
    v_add_f32_dpp v132, v140, v140 row_ror:8 row_mask:0xf bank_mask:0xc
    v_add_f32_dpp v133, v141, v141 row_ror:8 row_mask:0xf bank_mask:0xc
    v_add_f32_dpp v134, v142, v142 row_ror:8 row_mask:0xf bank_mask:0xc
    v_add_f32_dpp v135, v143, v143 row_ror:8 row_mask:0xf bank_mask:0xc
    v_add_f32_dpp v128, v128, v128 row_half_mirror row_mask:0xf bank_mask:0x5
    v_add_f32_dpp v129, v129, v129 row_half_mirror row_mask:0xf bank_mask:0x5
    v_add_f32_dpp v130, v130, v130 row_half_mirror row_mask:0xf bank_mask:0x5
    v_add_f32_dpp v131, v131, v131 row_half_mirror row_mask:0xf bank_mask:0x5
    v_add_f32_dpp v128, v132, v132 row_half_mirror row_mask:0xf bank_mask:0xa
    v_add_f32_dpp v129, v133, v133 row_half_mirror row_mask:0xf bank_mask:0xa
    v_add_f32_dpp v130, v134, v134 row_half_mirror row_mask:0xf bank_mask:0xa
    v_add_f32_dpp v131, v135, v135 row_half_mirror row_mask:0xf bank_mask:0xa
    v_add_f32_dpp v128, v128, v128 quad_perm:[2,3,0,1] row_mask:0xf bank_mask:0xf
    v_add_f32_dpp v129, v129, v129 quad_perm:[2,3,0,1] row_mask:0xf bank_mask:0xf
    v_add_f32_dpp v130, v130, v130 quad_perm:[2,3,0,1] row_mask:0xf bank_mask:0xf
    v_add_f32_dpp v131, v131, v131 quad_perm:[2,3,0,1] row_mask:0xf bank_mask:0xf
    v_add_f32_dpp v128, v128, v128 quad_perm:[1,0,3,2] row_mask:0xf bank_mask:0xf
    v_add_f32_dpp v129, v129, v129 quad_perm:[1,0,3,2] row_mask:0xf bank_mask:0xf
    v_add_f32_dpp v130, v130, v130 quad_perm:[1,0,3,2] row_mask:0xf bank_mask:0xf
    v_add_f32_dpp v131, v131, v131 quad_perm:[1,0,3,2] row_mask:0xf bank_mask:0xf
    v_lshl_add_u32 v4, v5, 3, v4
    v_lshl_add_u32 v4, v3, 2, v4
    v_lshlrev_b32 v4, 3, v4
    v_bfe_u32 v5, v0, 4, 1
    v_lshl_add_u32 v4, v5, 2, v4
    v_cvt_f32_u32 v5, v5
    v_mul_f32 v5, 0xc1700000, v5
    v_add_f32 v5, 0x41800000, v5
    s_mov_b32 s40, 0x22222222
    s_mov_b32 s41, 0x22222222
    v_cndmask_b32 v128, v128, v129, s[40:41]
    s_mov_b32 s40, 0x44444444
    s_mov_b32 s41, 0x44444444
    v_cndmask_b32 v128, v128, v130, s[40:41]
    s_mov_b32 s40, 0x88888888
    s_mov_b32 s41, 0x88888888
    v_cndmask_b32 v128, v128, v131, s[40:41]
    s_lshl_b32 s37, s28, 14
    s_lshl_b32 s38, s5, 8
    s_add_u32 s37, s37, s38
    s_lshl_b32 s38, s29, 10
    s_add_u32 s38, s38, s37
    v_add_f32 v128, v128, v5
    s_cmp_eq_u32 s30, 0
    s_cbranch_scc1 adaLN_cond__grouped_kv_mqa__mixer_gmlp__prompt_kernel_sl13
    buffer_store_dword v128, v4, s[60:63], s38 offen
    s_branch adaLN_cond__grouped_kv_mqa__mixer_gmlp__prompt_kernel_sd14
adaLN_cond__grouped_kv_mqa__mixer_gmlp__prompt_kernel_sl13:
    buffer_store_dword v128, v4, s[60:63], s38 offen sc1
adaLN_cond__grouped_kv_mqa__mixer_gmlp__prompt_kernel_sd14:
    s_mul_i32 s39, s6, 24
    s_mul_i32 s38, s25, 3
    s_add_u32 s39, s39, s38
    s_add_u32 s39, s39, 1
    s_lshl_b32 s39, s39, 11
    v_lshlrev_b32 v4, 3, v2
    v_lshl_add_u32 v4, v3, 13, v4
    s_add_u32 s38, s37, 4096
    s_waitcnt lgkmcnt(0)
    v_pk_fma_f32 v[56:57], v[8:9], v[160:161], v[176:177] op_sel:[1,0,0] op_sel_hi:[1,1,1]
    v_pk_fma_f32 v[58:59], v[8:9], v[162:163], v[178:179] op_sel:[1,0,0] op_sel_hi:[1,1,1]
    v_pk_fma_f32 v[60:61], v[8:9], v[164:165], v[180:181] op_sel:[1,0,0] op_sel_hi:[1,1,1]
    v_pk_fma_f32 v[62:63], v[8:9], v[166:167], v[182:183] op_sel:[1,0,0] op_sel_hi:[1,1,1]
    v_pk_fma_f32 v[64:65], v[8:9], v[168:169], v[184:185] op_sel:[1,0,0] op_sel_hi:[1,1,1]
    v_pk_fma_f32 v[66:67], v[8:9], v[170:171], v[186:187] op_sel:[1,0,0] op_sel_hi:[1,1,1]
    v_pk_fma_f32 v[68:69], v[8:9], v[172:173], v[188:189] op_sel:[1,0,0] op_sel_hi:[1,1,1]
    v_pk_fma_f32 v[70:71], v[8:9], v[174:175], v[190:191] op_sel:[1,0,0] op_sel_hi:[1,1,1]
    ds_read_b128 v[160:163], v15 offset:256
    ds_read_b128 v[176:179], v15 offset:1280
    ds_read_b128 v[164:167], v15 offset:288
    ds_read_b128 v[180:183], v15 offset:1312
    ds_read_b128 v[168:171], v15 offset:320
    ds_read_b128 v[184:187], v15 offset:1344
    ds_read_b128 v[172:175], v15 offset:352
    ds_read_b128 v[188:191], v15 offset:1376
    v_pk_fma_f32 v[96:97], v[96:97], v[8:9], v[56:57] op_sel_hi:[1,0,1]
    v_pk_fma_f32 v[98:99], v[98:99], v[8:9], v[58:59] op_sel_hi:[1,0,1]
    v_pk_fma_f32 v[100:101], v[100:101], v[8:9], v[60:61] op_sel_hi:[1,0,1]
    v_pk_fma_f32 v[102:103], v[102:103], v[8:9], v[62:63] op_sel_hi:[1,0,1]
    v_pk_fma_f32 v[104:105], v[104:105], v[8:9], v[64:65] op_sel_hi:[1,0,1]
    v_pk_fma_f32 v[106:107], v[106:107], v[8:9], v[66:67] op_sel_hi:[1,0,1]
    v_pk_fma_f32 v[108:109], v[108:109], v[8:9], v[68:69] op_sel_hi:[1,0,1]
    v_pk_fma_f32 v[110:111], v[110:111], v[8:9], v[70:71] op_sel_hi:[1,0,1]
    v_pk_mul_f32 v[56:57], v[96:97], v[96:97]
    v_pk_mul_f32 v[58:59], v[98:99], v[98:99]
    v_pk_mul_f32 v[60:61], v[100:101], v[100:101]
    v_pk_mul_f32 v[62:63], v[102:103], v[102:103]
    v_pk_mul_f32 v[64:65], v[104:105], v[104:105]
    v_pk_mul_f32 v[66:67], v[106:107], v[106:107]
    v_pk_mul_f32 v[68:69], v[108:109], v[108:109]
    v_pk_mul_f32 v[70:71], v[110:111], v[110:111]
    v_pk_fma_f32 v[56:57], v[56:57], v[12:13], v[12:13] op_sel:[0,1,0] op_sel_hi:[1,1,0]
    v_pk_fma_f32 v[58:59], v[58:59], v[12:13], v[12:13] op_sel:[0,1,0] op_sel_hi:[1,1,0]
    v_pk_fma_f32 v[60:61], v[60:61], v[12:13], v[12:13] op_sel:[0,1,0] op_sel_hi:[1,1,0]
    v_pk_fma_f32 v[62:63], v[62:63], v[12:13], v[12:13] op_sel:[0,1,0] op_sel_hi:[1,1,0]
    v_pk_fma_f32 v[64:65], v[64:65], v[12:13], v[12:13] op_sel:[0,1,0] op_sel_hi:[1,1,0]
    v_pk_fma_f32 v[66:67], v[66:67], v[12:13], v[12:13] op_sel:[0,1,0] op_sel_hi:[1,1,0]
    v_pk_fma_f32 v[68:69], v[68:69], v[12:13], v[12:13] op_sel:[0,1,0] op_sel_hi:[1,1,0]
    v_pk_fma_f32 v[70:71], v[70:71], v[12:13], v[12:13] op_sel:[0,1,0] op_sel_hi:[1,1,0]
    v_pk_mul_f32 v[56:57], v[56:57], v[96:97]
    v_pk_mul_f32 v[58:59], v[58:59], v[98:99]
    v_pk_mul_f32 v[60:61], v[60:61], v[100:101]
    v_pk_mul_f32 v[62:63], v[62:63], v[102:103]
    v_pk_mul_f32 v[64:65], v[64:65], v[104:105]
    v_pk_mul_f32 v[66:67], v[66:67], v[106:107]
    v_pk_mul_f32 v[68:69], v[68:69], v[108:109]
    v_pk_mul_f32 v[70:71], v[70:71], v[110:111]
    v_exp_f32 v56, v56
    v_exp_f32 v57, v57
    v_exp_f32 v58, v58
    v_exp_f32 v59, v59
    v_exp_f32 v60, v60
    v_exp_f32 v61, v61
    v_exp_f32 v62, v62
    v_exp_f32 v63, v63
    v_exp_f32 v64, v64
    v_exp_f32 v65, v65
    v_exp_f32 v66, v66
    v_exp_f32 v67, v67
    v_exp_f32 v68, v68
    v_exp_f32 v69, v69
    v_exp_f32 v70, v70
    v_exp_f32 v71, v71
    v_pk_add_f32 v[56:57], v[56:57], 1.0 op_sel_hi:[1,0]
    v_pk_add_f32 v[58:59], v[58:59], 1.0 op_sel_hi:[1,0]
    v_pk_add_f32 v[60:61], v[60:61], 1.0 op_sel_hi:[1,0]
    v_pk_add_f32 v[62:63], v[62:63], 1.0 op_sel_hi:[1,0]
    v_pk_add_f32 v[64:65], v[64:65], 1.0 op_sel_hi:[1,0]
    v_pk_add_f32 v[66:67], v[66:67], 1.0 op_sel_hi:[1,0]
    v_pk_add_f32 v[68:69], v[68:69], 1.0 op_sel_hi:[1,0]
    v_pk_add_f32 v[70:71], v[70:71], 1.0 op_sel_hi:[1,0]
    v_rcp_f32 v56, v56
    v_rcp_f32 v57, v57
    v_rcp_f32 v58, v58
    v_rcp_f32 v59, v59
    v_rcp_f32 v60, v60
    v_rcp_f32 v61, v61
    v_rcp_f32 v62, v62
    v_rcp_f32 v63, v63
    v_rcp_f32 v64, v64
    v_rcp_f32 v65, v65
    v_rcp_f32 v66, v66
    v_rcp_f32 v67, v67
    v_rcp_f32 v68, v68
    v_rcp_f32 v69, v69
    v_rcp_f32 v70, v70
    v_rcp_f32 v71, v71
    v_pk_mul_f32 v[96:97], v[96:97], v[56:57]
    v_pk_mul_f32 v[98:99], v[98:99], v[58:59]
    v_pk_mul_f32 v[100:101], v[100:101], v[60:61]
    v_pk_mul_f32 v[102:103], v[102:103], v[62:63]
    v_pk_mul_f32 v[104:105], v[104:105], v[64:65]
    v_pk_mul_f32 v[106:107], v[106:107], v[66:67]
    v_pk_mul_f32 v[108:109], v[108:109], v[68:69]
    v_pk_mul_f32 v[110:111], v[110:111], v[70:71]
    v_cvt_pk_bf16_f32 v128, v96, v97
    v_cvt_pk_bf16_f32 v129, v98, v99
    v_cvt_pk_bf16_f32 v130, v100, v101
    v_cvt_pk_bf16_f32 v131, v102, v103
    v_cvt_pk_bf16_f32 v132, v104, v105
    v_cvt_pk_bf16_f32 v133, v106, v107
    v_cvt_pk_bf16_f32 v134, v108, v109
    v_cvt_pk_bf16_f32 v135, v110, v111
    s_waitcnt lgkmcnt(0)
    v_pk_fma_f32 v[56:57], v[8:9], v[160:161], v[176:177] op_sel:[1,0,0] op_sel_hi:[1,1,1]
    v_pk_fma_f32 v[58:59], v[8:9], v[162:163], v[178:179] op_sel:[1,0,0] op_sel_hi:[1,1,1]
    v_pk_fma_f32 v[60:61], v[8:9], v[164:165], v[180:181] op_sel:[1,0,0] op_sel_hi:[1,1,1]
    v_pk_fma_f32 v[62:63], v[8:9], v[166:167], v[182:183] op_sel:[1,0,0] op_sel_hi:[1,1,1]
    v_pk_fma_f32 v[64:65], v[8:9], v[168:169], v[184:185] op_sel:[1,0,0] op_sel_hi:[1,1,1]
    v_pk_fma_f32 v[66:67], v[8:9], v[170:171], v[186:187] op_sel:[1,0,0] op_sel_hi:[1,1,1]
    v_pk_fma_f32 v[68:69], v[8:9], v[172:173], v[188:189] op_sel:[1,0,0] op_sel_hi:[1,1,1]
    v_pk_fma_f32 v[70:71], v[8:9], v[174:175], v[190:191] op_sel:[1,0,0] op_sel_hi:[1,1,1]
    v_pk_fma_f32 v[112:113], v[112:113], v[8:9], v[56:57] op_sel_hi:[1,0,1]
    v_pk_fma_f32 v[114:115], v[114:115], v[8:9], v[58:59] op_sel_hi:[1,0,1]
    v_pk_fma_f32 v[116:117], v[116:117], v[8:9], v[60:61] op_sel_hi:[1,0,1]
    v_pk_fma_f32 v[118:119], v[118:119], v[8:9], v[62:63] op_sel_hi:[1,0,1]
    v_pk_fma_f32 v[120:121], v[120:121], v[8:9], v[64:65] op_sel_hi:[1,0,1]
    v_pk_fma_f32 v[122:123], v[122:123], v[8:9], v[66:67] op_sel_hi:[1,0,1]
    v_pk_fma_f32 v[124:125], v[124:125], v[8:9], v[68:69] op_sel_hi:[1,0,1]
    v_pk_fma_f32 v[126:127], v[126:127], v[8:9], v[70:71] op_sel_hi:[1,0,1]
    v_pk_mul_f32 v[56:57], v[112:113], v[112:113]
    v_pk_mul_f32 v[58:59], v[114:115], v[114:115]
    v_pk_mul_f32 v[60:61], v[116:117], v[116:117]
    v_pk_mul_f32 v[62:63], v[118:119], v[118:119]
    v_pk_mul_f32 v[64:65], v[120:121], v[120:121]
    v_pk_mul_f32 v[66:67], v[122:123], v[122:123]
    v_pk_mul_f32 v[68:69], v[124:125], v[124:125]
    v_pk_mul_f32 v[70:71], v[126:127], v[126:127]
    v_pk_fma_f32 v[56:57], v[56:57], v[12:13], v[12:13] op_sel:[0,1,0] op_sel_hi:[1,1,0]
    v_pk_fma_f32 v[58:59], v[58:59], v[12:13], v[12:13] op_sel:[0,1,0] op_sel_hi:[1,1,0]
    v_pk_fma_f32 v[60:61], v[60:61], v[12:13], v[12:13] op_sel:[0,1,0] op_sel_hi:[1,1,0]
    v_pk_fma_f32 v[62:63], v[62:63], v[12:13], v[12:13] op_sel:[0,1,0] op_sel_hi:[1,1,0]
    v_pk_fma_f32 v[64:65], v[64:65], v[12:13], v[12:13] op_sel:[0,1,0] op_sel_hi:[1,1,0]
    v_pk_fma_f32 v[66:67], v[66:67], v[12:13], v[12:13] op_sel:[0,1,0] op_sel_hi:[1,1,0]
    v_pk_fma_f32 v[68:69], v[68:69], v[12:13], v[12:13] op_sel:[0,1,0] op_sel_hi:[1,1,0]
    v_pk_fma_f32 v[70:71], v[70:71], v[12:13], v[12:13] op_sel:[0,1,0] op_sel_hi:[1,1,0]
    v_pk_mul_f32 v[56:57], v[56:57], v[112:113]
    v_pk_mul_f32 v[58:59], v[58:59], v[114:115]
    v_pk_mul_f32 v[60:61], v[60:61], v[116:117]
    v_pk_mul_f32 v[62:63], v[62:63], v[118:119]
    v_pk_mul_f32 v[64:65], v[64:65], v[120:121]
    v_pk_mul_f32 v[66:67], v[66:67], v[122:123]
    v_pk_mul_f32 v[68:69], v[68:69], v[124:125]
    v_pk_mul_f32 v[70:71], v[70:71], v[126:127]
    v_exp_f32 v56, v56
    v_exp_f32 v57, v57
    v_exp_f32 v58, v58
    v_exp_f32 v59, v59
    v_exp_f32 v60, v60
    v_exp_f32 v61, v61
    v_exp_f32 v62, v62
    v_exp_f32 v63, v63
    v_exp_f32 v64, v64
    v_exp_f32 v65, v65
    v_exp_f32 v66, v66
    v_exp_f32 v67, v67
    v_exp_f32 v68, v68
    v_exp_f32 v69, v69
    v_exp_f32 v70, v70
    v_exp_f32 v71, v71
    buffer_load_dwordx2 v[160:161], v4, s[60:63], s37 offen offset:0 sc1
    buffer_load_dwordx2 v[162:163], v4, s[60:63], s37 offen offset:1024 sc1
    buffer_load_dwordx2 v[164:165], v4, s[60:63], s37 offen offset:2048 sc1
    buffer_load_dwordx2 v[166:167], v4, s[60:63], s37 offen offset:3072 sc1
    buffer_load_dwordx2 v[168:169], v4, s[60:63], s38 offen offset:0 sc1
    buffer_load_dwordx2 v[170:171], v4, s[60:63], s38 offen offset:1024 sc1
    buffer_load_dwordx2 v[172:173], v4, s[60:63], s38 offen offset:2048 sc1
    buffer_load_dwordx2 v[174:175], v4, s[60:63], s38 offen offset:3072 sc1
    v_pk_add_f32 v[56:57], v[56:57], 1.0 op_sel_hi:[1,0]
    v_pk_add_f32 v[58:59], v[58:59], 1.0 op_sel_hi:[1,0]
    v_pk_add_f32 v[60:61], v[60:61], 1.0 op_sel_hi:[1,0]
    v_pk_add_f32 v[62:63], v[62:63], 1.0 op_sel_hi:[1,0]
    v_pk_add_f32 v[64:65], v[64:65], 1.0 op_sel_hi:[1,0]
    v_pk_add_f32 v[66:67], v[66:67], 1.0 op_sel_hi:[1,0]
    v_pk_add_f32 v[68:69], v[68:69], 1.0 op_sel_hi:[1,0]
    v_pk_add_f32 v[70:71], v[70:71], 1.0 op_sel_hi:[1,0]
    v_rcp_f32 v56, v56
    v_rcp_f32 v57, v57
    v_rcp_f32 v58, v58
    v_rcp_f32 v59, v59
    v_rcp_f32 v60, v60
    v_rcp_f32 v61, v61
    v_rcp_f32 v62, v62
    v_rcp_f32 v63, v63
    v_rcp_f32 v64, v64
    v_rcp_f32 v65, v65
    v_rcp_f32 v66, v66
    v_rcp_f32 v67, v67
    v_rcp_f32 v68, v68
    v_rcp_f32 v69, v69
    v_rcp_f32 v70, v70
    v_rcp_f32 v71, v71
    v_pk_mul_f32 v[112:113], v[112:113], v[56:57]
    v_pk_mul_f32 v[114:115], v[114:115], v[58:59]
    v_pk_mul_f32 v[116:117], v[116:117], v[60:61]
    v_pk_mul_f32 v[118:119], v[118:119], v[62:63]
    v_pk_mul_f32 v[120:121], v[120:121], v[64:65]
    v_pk_mul_f32 v[122:123], v[122:123], v[66:67]
    v_pk_mul_f32 v[124:125], v[124:125], v[68:69]
    v_pk_mul_f32 v[126:127], v[126:127], v[70:71]
    v_cvt_pk_bf16_f32 v136, v112, v113
    v_cvt_pk_bf16_f32 v137, v114, v115
    v_cvt_pk_bf16_f32 v138, v116, v117
    v_cvt_pk_bf16_f32 v139, v118, v119
    v_cvt_pk_bf16_f32 v140, v120, v121
    v_cvt_pk_bf16_f32 v141, v122, v123
    v_cvt_pk_bf16_f32 v142, v124, v125
    v_cvt_pk_bf16_f32 v143, v126, v127
    s_mov_b32 s42, 0
    s_branch k2_st1_in
k2_st1:
    buffer_load_dwordx2 v[160:161], v4, s[60:63], s37 offen offset:0 sc1
    buffer_load_dwordx2 v[162:163], v4, s[60:63], s37 offen offset:1024 sc1
    buffer_load_dwordx2 v[164:165], v4, s[60:63], s37 offen offset:2048 sc1
    buffer_load_dwordx2 v[166:167], v4, s[60:63], s37 offen offset:3072 sc1
    buffer_load_dwordx2 v[168:169], v4, s[60:63], s38 offen offset:0 sc1
    buffer_load_dwordx2 v[170:171], v4, s[60:63], s38 offen offset:1024 sc1
    buffer_load_dwordx2 v[172:173], v4, s[60:63], s38 offen offset:2048 sc1
    buffer_load_dwordx2 v[174:175], v4, s[60:63], s38 offen offset:3072 sc1
k2_st1_in:
    s_waitcnt vmcnt(0)
    s_add_u32 s42, s42, 1
    v_min3_u32 v5, v160, v161, v162
    v_min3_u32 v5, v5, v163, v164
    v_min3_u32 v5, v5, v165, v166
    v_min3_u32 v5, v5, v167, v168
    v_min3_u32 v5, v5, v169, v170
    v_min3_u32 v5, v5, v171, v172
    v_min3_u32 v5, v5, v173, v174
    v_min_u32 v5, v5, v175
    v_cmp_ne_u32 vcc, 0, v5
    s_cmp_eq_u64 vcc, -1
    s_cbranch_scc1 k2_st1_ok
    s_sleep 1
    s_cmp_lt_u32 s42, 200000
    s_cbranch_scc1 k2_st1
k2_st1_ok:
    buffer_store_dwordx4 v[128:131], v1, s[64:67], s39 offen offset:0 sc1
    buffer_store_dwordx4 v[132:135], v1, s[64:67], s39 offen offset:1024 sc1
    buffer_store_dwordx4 v[136:139], v1, s[64:67], s39 offen offset:2048 sc1
    buffer_store_dwordx4 v[140:143], v1, s[64:67], s39 offen offset:3072 sc1
    v_pk_add_f32 v[160:161], v[160:161], v[162:163]
    v_pk_add_f32 v[164:165], v[164:165], v[166:167]
    v_pk_add_f32 v[168:169], v[168:169], v[170:171]
    v_pk_add_f32 v[172:173], v[172:173], v[174:175]
    v_pk_add_f32 v[160:161], v[160:161], v[164:165]
    v_pk_add_f32 v[168:169], v[168:169], v[172:173]
    v_pk_add_f32 v[160:161], v[160:161], v[168:169]
    v_mov_b32 v162, v160
    v_mov_b32 v163, v161
    s_lshl_b32 s36, s5, 8
    s_add_u32 s36, s36, 2048
    v_permlane32_swap_b32 v160, v162
    v_permlane32_swap_b32 v161, v163
    v_pk_add_f32 v[160:161], v[160:161], v[162:163]
    v_lshl_add_u32 v10, v2, 2, s36
    v_mov_b32 v162, 0x3aaaaaab
    v_fmaak_f32 v8, v160, v162, 0xbeaaaaab
    v_fmaak_f32 v9, v161, v162, 0xbcaa95b2
    v_fma_f32 v9, -v8, v8, v9
    v_max_f32 v9, 0x3727c5ac, v9
    v_rsq_f32 v11, v9
    s_nop 0
    v_mul_f32 v9, v8, v11
    v_sub_f32 v9, 0, v9
    v_mov_b32 v8, v11
    ds_write_b32 v10, v8
    ds_write_b32 v10, v9 offset:128
    v_lshl_add_u32 v10, v3, 4, s36
    s_lshl_b32 s37, s25, 7
    s_lshl_b32 s38, s6, 1
    s_add_u32 s37, s37, s38
    s_mul_i32 s37, s37, 3072
    s_add_u32 s37, s37, 2048
    s_add_u32 s38, s37, 3072
    s_waitcnt lgkmcnt(0)
    ds_read_b128 v[16:19], v10 offset:0
    ds_read_b128 v[32:35], v10 offset:128
    ds_read_b128 v[20:23], v10 offset:32
    ds_read_b128 v[36:39], v10 offset:160
    ds_read_b128 v[24:27], v10 offset:64
    ds_read_b128 v[40:43], v10 offset:192
    ds_read_b128 v[28:31], v10 offset:96
    ds_read_b128 v[44:47], v10 offset:224
    s_waitcnt lgkmcnt(0)
    v_pk_fma_f32 v[80:81], v[80:81], v[16:17], v[32:33]
    v_pk_fma_f32 v[82:83], v[82:83], v[18:19], v[34:35]
    v_pk_fma_f32 v[84:85], v[84:85], v[20:21], v[36:37]
    v_pk_fma_f32 v[86:87], v[86:87], v[22:23], v[38:39]
    v_pk_fma_f32 v[88:89], v[88:89], v[24:25], v[40:41]
    v_pk_fma_f32 v[90:91], v[90:91], v[26:27], v[42:43]
    v_pk_fma_f32 v[92:93], v[92:93], v[28:29], v[44:45]
    v_pk_fma_f32 v[94:95], v[94:95], v[30:31], v[46:47]
    v_cvt_pk_bf16_f32 v56, v80, v81
    v_cvt_pk_bf16_f32 v57, v82, v83
    v_cvt_pk_bf16_f32 v58, v84, v85
    v_cvt_pk_bf16_f32 v59, v86, v87
    v_cvt_pk_bf16_f32 v60, v88, v89
    v_cvt_pk_bf16_f32 v61, v90, v91
    v_cvt_pk_bf16_f32 v62, v92, v93
    v_cvt_pk_bf16_f32 v63, v94, v95
    s_nop 0
    v_permlane32_swap_b32 v56, v58
    v_permlane32_swap_b32 v57, v59
    buffer_store_dwordx4 v[56:59], v1, s[68:71], s37 offen offset:0 sc1
    v_permlane32_swap_b32 v60, v62
    v_permlane32_swap_b32 v61, v63
    buffer_store_dwordx4 v[60:63], v1, s[68:71], s38 offen offset:0 sc1
k2_zdone:
    s_lshl_b32 s37, s28, 4
    s_add_u32 s37, s37, s29
    s_lshl_b32 s37, s37, 7
    s_add_u32 s37, s37, 397312
    s_waitcnt vmcnt(0)
    s_barrier
    s_cmp_lg_u32 s5, 0
    s_cbranch_scc1 k2_f4done
    v_mov_b32 v10, 1
    s_mov_b64 exec, 1
    buffer_store_dword v10, off, s[16:19], s37 sc1
    s_mov_b64 exec, -1
k2_f4done:
k5_compute:
    s_mov_b32 s3, s24
    s_mov_b32 s4, s25
    v_and_b32 v2, 31, v0
    v_bfe_u32 v3, v0, 5, 1
    s_and_b32 s6, s5, 1
    s_lshl_b32 s34, s3, 1
    s_add_u32 s34, s34, s6
    s_lshr_b32 s33, s5, 1
    s_mul_i32 s36, s34, 24
    s_mul_i32 s37, s4, 3
    s_add_u32 s36, s36, s37
    s_lshl_b32 s36, s36, 11
    s_lshl_b32 s37, s33, 12
    s_add_u32 s36, s36, s37
    s_lshl_b32 s38, s34, 6
    v_lshlrev_b32 v5, 1, v2
    s_lshl_b32 s39, s33, 11
    v_add_u32 v6, s39, v1
    v_add_u32 v7, 40960, v6
    s_lshl_b32 s39, s6, 10
    s_add_u32 s39, s39, 3072
    v_add_u32 v8, s39, v1
    v_add_u32 v9, 40960, v8
    s_add_u32 s52, s8, 0x1500000
    s_addc_u32 s53, s9, 0
    s_mov_b32 s54, 0x300000
    s_mov_b32 s55, 0x20000
    s_mov_b32 s60, s44
    s_mov_b32 s61, s45
    s_mov_b32 s62, 0x1000
    s_mov_b32 s63, 0x20000
    buffer_load_ushort v176, v5, s[60:63], s38 offen
    v_bfe_u32 v204, v0, 4, 2
    v_lshlrev_b32 v207, 4, v204
    s_mul_i32 s41, s4, 320
    s_add_u32 s56, s8, 0x3200
    s_addc_u32 s57, s9, 0
    s_mov_b32 s58, 0xa00
    s_mov_b32 s59, 0x20000
    buffer_load_dwordx4 v[184:187], v207, s[56:59], s41 offen offset:0 sc1
    buffer_load_dwordx4 v[188:191], v207, s[56:59], s41 offen offset:64 sc1
    buffer_load_dwordx4 v[192:195], v207, s[56:59], s41 offen offset:128 sc1
    buffer_load_dwordx4 v[196:199], v207, s[56:59], s41 offen offset:192 sc1
    buffer_load_dwordx4 v[200:203], v207, s[56:59], s41 offen offset:256 sc1
    s_mul_i32 s7, s3, 98304
    s_mul_i32 s37, s4, 12288
    s_add_u32 s40, s7, s37
    s_lshl_b32 s37, s6, 11
    s_add_u32 s40, s40, s37
    s_lshl_b32 s37, s33, 13
    s_add_u32 s40, s40, s37
    s_add_u32 s41, s40, 4096
    v_lshrrev_b32 v12, 4, v2
    v_lshlrev_b32 v12, 10, v12
    v_lshl_add_u32 v12, v3, 8, v12
    v_and_b32 v13, 15, v0
    v_lshl_add_u32 v12, v13, 4, v12
    s_mov_b32 s43, 0
    s_cmp_eq_u32 s33, 0
    s_cbranch_scc0 k5_one
    s_barrier
    s_waitcnt vmcnt(5)
    v_lshlrev_b32 v16, 16, v176
    v_mov_b32 v17, v16
    v_mov_b32 v18, v16
    v_mov_b32 v19, v16
    v_mov_b32 v20, v16
    v_mov_b32 v21, v16
    v_mov_b32 v22, v16
    v_mov_b32 v23, v16
    v_mov_b32 v24, v16
    v_mov_b32 v25, v16
    v_mov_b32 v26, v16
    v_mov_b32 v27, v16
    v_mov_b32 v28, v16
    v_mov_b32 v29, v16
    v_mov_b32 v30, v16
    v_mov_b32 v31, v16
    v_mov_b32 v32, v16
    v_mov_b32 v33, v16
    v_mov_b32 v34, v16
    v_mov_b32 v35, v16
    v_mov_b32 v36, v16
    v_mov_b32 v37, v16
    v_mov_b32 v38, v16
    v_mov_b32 v39, v16
    v_mov_b32 v40, v16
    v_mov_b32 v41, v16
    v_mov_b32 v42, v16
    v_mov_b32 v43, v16
    v_mov_b32 v44, v16
    v_mov_b32 v45, v16
    v_mov_b32 v46, v16
    v_mov_b32 v47, v16
    s_barrier
    ds_read_b128 v[72:75], v8 offset:0
    ds_read_b128 v[64:67], v6 offset:0
    ds_read_b128 v[68:71], v6 offset:1024
    ds_read_b128 v[84:87], v8 offset:5120
    ds_read_b128 v[76:79], v6 offset:5120
    ds_read_b128 v[80:83], v6 offset:6144
    ds_read_b128 v[96:99], v8 offset:10240
    ds_read_b128 v[88:91], v6 offset:10240
    ds_read_b128 v[92:95], v6 offset:11264
    ds_read_b128 v[108:111], v8 offset:15360
    ds_read_b128 v[100:103], v6 offset:15360
    ds_read_b128 v[104:107], v6 offset:16384
    buffer_load_dwordx4 v[160:163], v1, s[52:55], s36 offen offset:0 sc1
    buffer_load_dwordx4 v[164:167], v1, s[52:55], s36 offen offset:1024 sc1
    buffer_load_dwordx4 v[168:171], v1, s[52:55], s36 offen offset:2048 sc1
    buffer_load_dwordx4 v[172:175], v1, s[52:55], s36 offen offset:3072 sc1
.p2align 6
k5_loop2:
    s_waitcnt lgkmcnt(0)
    s_barrier
    v_mfma_f32_32x32x16_bf16 v[16:31], v[64:67], v[72:75], v[16:31]
    ds_read_b128 v[120:123], v8 offset:20480
    ds_read_b128 v[112:115], v6 offset:20480
    ds_read_b128 v[116:119], v6 offset:21504
    v_mfma_f32_32x32x16_bf16 v[32:47], v[68:71], v[72:75], v[32:47]
    ds_read_b128 v[132:135], v8 offset:25600
    ds_read_b128 v[124:127], v6 offset:25600
    ds_read_b128 v[128:131], v6 offset:26624
    v_mfma_f32_32x32x16_bf16 v[16:31], v[76:79], v[84:87], v[16:31]
    ds_read_b128 v[144:147], v8 offset:30720
    ds_read_b128 v[136:139], v6 offset:30720
    ds_read_b128 v[140:143], v6 offset:31744
    v_mfma_f32_32x32x16_bf16 v[32:47], v[80:83], v[84:87], v[32:47]
    ds_read_b128 v[156:159], v8 offset:35840
    ds_read_b128 v[148:151], v6 offset:35840
    ds_read_b128 v[152:155], v6 offset:36864
    v_mfma_f32_32x32x16_bf16 v[16:31], v[88:91], v[96:99], v[16:31]
    v_mfma_f32_32x32x16_bf16 v[32:47], v[92:95], v[96:99], v[32:47]
    v_mfma_f32_32x32x16_bf16 v[16:31], v[100:103], v[108:111], v[16:31]
    v_mfma_f32_32x32x16_bf16 v[32:47], v[104:107], v[108:111], v[32:47]
    s_waitcnt lgkmcnt(0)
    s_barrier
    v_mfma_f32_32x32x16_bf16 v[16:31], v[112:115], v[120:123], v[16:31]
    ds_read_b128 v[72:75], v9 offset:0
    ds_read_b128 v[64:67], v7 offset:0
    ds_read_b128 v[68:71], v7 offset:1024
    v_mfma_f32_32x32x16_bf16 v[32:47], v[116:119], v[120:123], v[32:47]
    ds_read_b128 v[84:87], v9 offset:5120
    ds_read_b128 v[76:79], v7 offset:5120
    ds_read_b128 v[80:83], v7 offset:6144
    v_mfma_f32_32x32x16_bf16 v[16:31], v[124:127], v[132:135], v[16:31]
    ds_read_b128 v[96:99], v9 offset:10240
    ds_read_b128 v[88:91], v7 offset:10240
    ds_read_b128 v[92:95], v7 offset:11264
    v_mfma_f32_32x32x16_bf16 v[32:47], v[128:131], v[132:135], v[32:47]
    ds_read_b128 v[108:111], v9 offset:15360
    ds_read_b128 v[100:103], v7 offset:15360
    ds_read_b128 v[104:107], v7 offset:16384
    v_mfma_f32_32x32x16_bf16 v[16:31], v[136:139], v[144:147], v[16:31]
    v_mfma_f32_32x32x16_bf16 v[32:47], v[140:143], v[144:147], v[32:47]
    v_mfma_f32_32x32x16_bf16 v[16:31], v[148:151], v[156:159], v[16:31]
    v_mfma_f32_32x32x16_bf16 v[32:47], v[152:155], v[156:159], v[32:47]
    s_waitcnt lgkmcnt(0)
    s_barrier
    v_mfma_f32_32x32x16_bf16 v[16:31], v[64:67], v[72:75], v[16:31]
    ds_read_b128 v[120:123], v9 offset:20480
    ds_read_b128 v[112:115], v7 offset:20480
    ds_read_b128 v[116:119], v7 offset:21504
    v_mfma_f32_32x32x16_bf16 v[32:47], v[68:71], v[72:75], v[32:47]
    ds_read_b128 v[132:135], v9 offset:25600
    ds_read_b128 v[124:127], v7 offset:25600
    ds_read_b128 v[128:131], v7 offset:26624
    v_mfma_f32_32x32x16_bf16 v[16:31], v[76:79], v[84:87], v[16:31]
    ds_read_b128 v[144:147], v9 offset:30720
    ds_read_b128 v[136:139], v7 offset:30720
    ds_read_b128 v[140:143], v7 offset:31744
    v_mfma_f32_32x32x16_bf16 v[32:47], v[80:83], v[84:87], v[32:47]
    ds_read_b128 v[156:159], v9 offset:35840
    ds_read_b128 v[148:151], v7 offset:35840
    ds_read_b128 v[152:155], v7 offset:36864
    v_mfma_f32_32x32x16_bf16 v[16:31], v[88:91], v[96:99], v[16:31]
    v_mfma_f32_32x32x16_bf16 v[32:47], v[92:95], v[96:99], v[32:47]
    v_mfma_f32_32x32x16_bf16 v[16:31], v[100:103], v[108:111], v[16:31]
    v_mfma_f32_32x32x16_bf16 v[32:47], v[104:107], v[108:111], v[32:47]
    s_waitcnt lgkmcnt(0)
    s_add_u32 s43, s43, 1
    s_cmp_eq_u32 s43, 8
    s_cbranch_scc1 k5_last2
    s_barrier
    v_mfma_f32_32x32x16_bf16 v[16:31], v[112:115], v[120:123], v[16:31]
    ds_read_b128 v[72:75], v8 offset:0
    ds_read_b128 v[64:67], v6 offset:0
    ds_read_b128 v[68:71], v6 offset:1024
    v_mfma_f32_32x32x16_bf16 v[32:47], v[116:119], v[120:123], v[32:47]
    ds_read_b128 v[84:87], v8 offset:5120
    ds_read_b128 v[76:79], v6 offset:5120
    ds_read_b128 v[80:83], v6 offset:6144
    v_mfma_f32_32x32x16_bf16 v[16:31], v[124:127], v[132:135], v[16:31]
    ds_read_b128 v[96:99], v8 offset:10240
    ds_read_b128 v[88:91], v6 offset:10240
    ds_read_b128 v[92:95], v6 offset:11264
    v_mfma_f32_32x32x16_bf16 v[32:47], v[128:131], v[132:135], v[32:47]
    ds_read_b128 v[108:111], v8 offset:15360
    ds_read_b128 v[100:103], v6 offset:15360
    ds_read_b128 v[104:107], v6 offset:16384
    v_mfma_f32_32x32x16_bf16 v[16:31], v[136:139], v[144:147], v[16:31]
    v_mfma_f32_32x32x16_bf16 v[32:47], v[140:143], v[144:147], v[32:47]
    v_mfma_f32_32x32x16_bf16 v[16:31], v[148:151], v[156:159], v[16:31]
    v_mfma_f32_32x32x16_bf16 v[32:47], v[152:155], v[156:159], v[32:47]
    s_branch k5_loop2
k5_last2:
    v_mfma_f32_32x32x16_bf16 v[16:31], v[112:115], v[120:123], v[16:31]
    v_mfma_f32_32x32x16_bf16 v[32:47], v[116:119], v[120:123], v[32:47]
    v_mfma_f32_32x32x16_bf16 v[16:31], v[124:127], v[132:135], v[16:31]
    v_mfma_f32_32x32x16_bf16 v[32:47], v[128:131], v[132:135], v[32:47]
    v_mfma_f32_32x32x16_bf16 v[16:31], v[136:139], v[144:147], v[16:31]
    v_mfma_f32_32x32x16_bf16 v[32:47], v[140:143], v[144:147], v[32:47]
    v_mfma_f32_32x32x16_bf16 v[16:31], v[148:151], v[156:159], v[16:31]
    v_mfma_f32_32x32x16_bf16 v[32:47], v[152:155], v[156:159], v[32:47]
    s_add_u32 s52, s8, 0x11c0000
    s_addc_u32 s53, s9, 0
    s_mov_b32 s54, 0x300000
    s_mov_b32 s55, 0x20000
    s_waitcnt vmcnt(0)
    v_lshlrev_b32 v64, 16, v160
    v_and_b32 v65, 0xffff0000, v160
    v_lshlrev_b32 v66, 16, v161
    v_and_b32 v67, 0xffff0000, v161
    v_lshlrev_b32 v68, 16, v162
    v_and_b32 v69, 0xffff0000, v162
    v_lshlrev_b32 v70, 16, v163
    v_and_b32 v71, 0xffff0000, v163
    v_lshlrev_b32 v72, 16, v164
    v_and_b32 v73, 0xffff0000, v164
    v_lshlrev_b32 v74, 16, v165
    v_and_b32 v75, 0xffff0000, v165
    v_lshlrev_b32 v76, 16, v166
    v_and_b32 v77, 0xffff0000, v166
    v_lshlrev_b32 v78, 16, v167
    v_and_b32 v79, 0xffff0000, v167
    v_lshlrev_b32 v80, 16, v168
    v_and_b32 v81, 0xffff0000, v168
    v_lshlrev_b32 v82, 16, v169
    v_and_b32 v83, 0xffff0000, v169
    v_lshlrev_b32 v84, 16, v170
    v_and_b32 v85, 0xffff0000, v170
    v_lshlrev_b32 v86, 16, v171
    v_and_b32 v87, 0xffff0000, v171
    v_lshlrev_b32 v88, 16, v172
    v_and_b32 v89, 0xffff0000, v172
    v_lshlrev_b32 v90, 16, v173
    v_and_b32 v91, 0xffff0000, v173
    v_lshlrev_b32 v92, 16, v174
    v_and_b32 v93, 0xffff0000, v174
    v_lshlrev_b32 v94, 16, v175
    v_and_b32 v95, 0xffff0000, v175
    v_pk_mul_f32 v[16:17], v[16:17], v[64:65]
    v_pk_mul_f32 v[18:19], v[18:19], v[66:67]
    v_pk_mul_f32 v[20:21], v[20:21], v[68:69]
    v_pk_mul_f32 v[22:23], v[22:23], v[70:71]
    v_cvt_pk_bf16_f32 v160, v16, v17
    v_cvt_pk_bf16_f32 v161, v18, v19
    v_cvt_pk_bf16_f32 v162, v20, v21
    v_cvt_pk_bf16_f32 v163, v22, v23
    v_pk_mul_f32 v[24:25], v[24:25], v[72:73]
    v_pk_mul_f32 v[26:27], v[26:27], v[74:75]
    v_pk_mul_f32 v[28:29], v[28:29], v[76:77]
    v_pk_mul_f32 v[30:31], v[30:31], v[78:79]
    v_cvt_pk_bf16_f32 v164, v24, v25
    v_cvt_pk_bf16_f32 v165, v26, v27
    v_cvt_pk_bf16_f32 v166, v28, v29
    v_cvt_pk_bf16_f32 v167, v30, v31
    v_pk_mul_f32 v[32:33], v[32:33], v[80:81]
    v_pk_mul_f32 v[34:35], v[34:35], v[82:83]
    v_pk_mul_f32 v[36:37], v[36:37], v[84:85]
    v_pk_mul_f32 v[38:39], v[38:39], v[86:87]
    v_cvt_pk_bf16_f32 v168, v32, v33
    v_cvt_pk_bf16_f32 v169, v34, v35
    v_cvt_pk_bf16_f32 v170, v36, v37
    v_cvt_pk_bf16_f32 v171, v38, v39
    v_pk_mul_f32 v[40:41], v[40:41], v[88:89]
    v_pk_mul_f32 v[42:43], v[42:43], v[90:91]
    v_pk_mul_f32 v[44:45], v[44:45], v[92:93]
    v_pk_mul_f32 v[46:47], v[46:47], v[94:95]
    v_cvt_pk_bf16_f32 v172, v40, v41
    v_cvt_pk_bf16_f32 v173, v42, v43
    v_cvt_pk_bf16_f32 v174, v44, v45
    v_cvt_pk_bf16_f32 v175, v46, v47
    s_nop 0
    v_permlane32_swap_b32 v160, v162
    v_permlane32_swap_b32 v161, v163
    v_permlane32_swap_b32 v164, v166
    v_permlane32_swap_b32 v165, v167
    v_permlane32_swap_b32 v168, v170
    v_permlane32_swap_b32 v169, v171
    v_permlane32_swap_b32 v172, v174
    v_permlane32_swap_b32 v173, v175
    s_cmp_eq_u32 s30, 0
    s_cbranch_scc1 adaLN_cond__grouped_kv_mqa__mixer_gmlp__prompt_kernel_sl15
    buffer_store_dwordx4 v[160:163], v12, s[52:55], s40 offen offset:0
    buffer_store_dwordx4 v[164:167], v12, s[52:55], s40 offen offset:512
    buffer_store_dwordx4 v[168:171], v12, s[52:55], s41 offen offset:0
    buffer_store_dwordx4 v[172:175], v12, s[52:55], s41 offen offset:512
    s_branch adaLN_cond__grouped_kv_mqa__mixer_gmlp__prompt_kernel_sd16
adaLN_cond__grouped_kv_mqa__mixer_gmlp__prompt_kernel_sl15:
    buffer_store_dwordx4 v[160:163], v12, s[52:55], s40 offen offset:0 sc1
    buffer_store_dwordx4 v[164:167], v12, s[52:55], s40 offen offset:512 sc1
    buffer_store_dwordx4 v[168:171], v12, s[52:55], s41 offen offset:0 sc1
    buffer_store_dwordx4 v[172:175], v12, s[52:55], s41 offen offset:512 sc1
adaLN_cond__grouped_kv_mqa__mixer_gmlp__prompt_kernel_sd16:
    s_branch k5_p6
k5_one:
    s_barrier
    s_waitcnt vmcnt(5)
    v_lshlrev_b32 v16, 16, v176
    v_mov_b32 v17, v16
    v_mov_b32 v18, v16
    v_mov_b32 v19, v16
    v_mov_b32 v20, v16
    v_mov_b32 v21, v16
    v_mov_b32 v22, v16
    v_mov_b32 v23, v16
    v_mov_b32 v24, v16
    v_mov_b32 v25, v16
    v_mov_b32 v26, v16
    v_mov_b32 v27, v16
    v_mov_b32 v28, v16
    v_mov_b32 v29, v16
    v_mov_b32 v30, v16
    v_mov_b32 v31, v16
    s_barrier
    ds_read_b128 v[72:75], v8 offset:0
    ds_read_b128 v[64:67], v6 offset:0
    ds_read_b128 v[84:87], v8 offset:5120
    ds_read_b128 v[76:79], v6 offset:5120
    ds_read_b128 v[96:99], v8 offset:10240
    ds_read_b128 v[88:91], v6 offset:10240
    ds_read_b128 v[108:111], v8 offset:15360
    ds_read_b128 v[100:103], v6 offset:15360
    buffer_load_dwordx4 v[160:163], v1, s[52:55], s36 offen offset:0 sc1
    buffer_load_dwordx4 v[164:167], v1, s[52:55], s36 offen offset:1024 sc1
.p2align 6
k5_loop1:
    s_waitcnt lgkmcnt(0)
    s_barrier
    v_mfma_f32_32x32x16_bf16 v[16:31], v[64:67], v[72:75], v[16:31]
    ds_read_b128 v[120:123], v8 offset:20480
    ds_read_b128 v[112:115], v6 offset:20480
    v_mfma_f32_32x32x16_bf16 v[16:31], v[76:79], v[84:87], v[16:31]
    ds_read_b128 v[132:135], v8 offset:25600
    ds_read_b128 v[124:127], v6 offset:25600
    v_mfma_f32_32x32x16_bf16 v[16:31], v[88:91], v[96:99], v[16:31]
    ds_read_b128 v[144:147], v8 offset:30720
    ds_read_b128 v[136:139], v6 offset:30720
    v_mfma_f32_32x32x16_bf16 v[16:31], v[100:103], v[108:111], v[16:31]
    ds_read_b128 v[156:159], v8 offset:35840
    ds_read_b128 v[148:151], v6 offset:35840
    s_waitcnt lgkmcnt(0)
    s_barrier
    v_mfma_f32_32x32x16_bf16 v[16:31], v[112:115], v[120:123], v[16:31]
    ds_read_b128 v[72:75], v9 offset:0
    ds_read_b128 v[64:67], v7 offset:0
    v_mfma_f32_32x32x16_bf16 v[16:31], v[124:127], v[132:135], v[16:31]
    ds_read_b128 v[84:87], v9 offset:5120
    ds_read_b128 v[76:79], v7 offset:5120
    v_mfma_f32_32x32x16_bf16 v[16:31], v[136:139], v[144:147], v[16:31]
    ds_read_b128 v[96:99], v9 offset:10240
    ds_read_b128 v[88:91], v7 offset:10240
    v_mfma_f32_32x32x16_bf16 v[16:31], v[148:151], v[156:159], v[16:31]
    ds_read_b128 v[108:111], v9 offset:15360
    ds_read_b128 v[100:103], v7 offset:15360
    s_waitcnt lgkmcnt(0)
    s_barrier
    v_mfma_f32_32x32x16_bf16 v[16:31], v[64:67], v[72:75], v[16:31]
    ds_read_b128 v[120:123], v9 offset:20480
    ds_read_b128 v[112:115], v7 offset:20480
    v_mfma_f32_32x32x16_bf16 v[16:31], v[76:79], v[84:87], v[16:31]
    ds_read_b128 v[132:135], v9 offset:25600
    ds_read_b128 v[124:127], v7 offset:25600
    v_mfma_f32_32x32x16_bf16 v[16:31], v[88:91], v[96:99], v[16:31]
    ds_read_b128 v[144:147], v9 offset:30720
    ds_read_b128 v[136:139], v7 offset:30720
    v_mfma_f32_32x32x16_bf16 v[16:31], v[100:103], v[108:111], v[16:31]
    ds_read_b128 v[156:159], v9 offset:35840
    ds_read_b128 v[148:151], v7 offset:35840
    s_waitcnt lgkmcnt(0)
    s_add_u32 s43, s43, 1
    s_cmp_eq_u32 s43, 8
    s_cbranch_scc1 k5_last1
    s_barrier
    v_mfma_f32_32x32x16_bf16 v[16:31], v[112:115], v[120:123], v[16:31]
    ds_read_b128 v[72:75], v8 offset:0
    ds_read_b128 v[64:67], v6 offset:0
    v_mfma_f32_32x32x16_bf16 v[16:31], v[124:127], v[132:135], v[16:31]
    ds_read_b128 v[84:87], v8 offset:5120
    ds_read_b128 v[76:79], v6 offset:5120
    v_mfma_f32_32x32x16_bf16 v[16:31], v[136:139], v[144:147], v[16:31]
    ds_read_b128 v[96:99], v8 offset:10240
    ds_read_b128 v[88:91], v6 offset:10240
    v_mfma_f32_32x32x16_bf16 v[16:31], v[148:151], v[156:159], v[16:31]
    ds_read_b128 v[108:111], v8 offset:15360
    ds_read_b128 v[100:103], v6 offset:15360
    s_branch k5_loop1
k5_last1:
    v_mfma_f32_32x32x16_bf16 v[16:31], v[112:115], v[120:123], v[16:31]
    v_mfma_f32_32x32x16_bf16 v[16:31], v[124:127], v[132:135], v[16:31]
    v_mfma_f32_32x32x16_bf16 v[16:31], v[136:139], v[144:147], v[16:31]
    v_mfma_f32_32x32x16_bf16 v[16:31], v[148:151], v[156:159], v[16:31]
    s_add_u32 s52, s8, 0x11c0000
    s_addc_u32 s53, s9, 0
    s_mov_b32 s54, 0x300000
    s_mov_b32 s55, 0x20000
    s_waitcnt vmcnt(0)
    v_lshlrev_b32 v64, 16, v160
    v_and_b32 v65, 0xffff0000, v160
    v_lshlrev_b32 v66, 16, v161
    v_and_b32 v67, 0xffff0000, v161
    v_lshlrev_b32 v68, 16, v162
    v_and_b32 v69, 0xffff0000, v162
    v_lshlrev_b32 v70, 16, v163
    v_and_b32 v71, 0xffff0000, v163
    v_lshlrev_b32 v72, 16, v164
    v_and_b32 v73, 0xffff0000, v164
    v_lshlrev_b32 v74, 16, v165
    v_and_b32 v75, 0xffff0000, v165
    v_lshlrev_b32 v76, 16, v166
    v_and_b32 v77, 0xffff0000, v166
    v_lshlrev_b32 v78, 16, v167
    v_and_b32 v79, 0xffff0000, v167
    v_pk_mul_f32 v[16:17], v[16:17], v[64:65]
    v_pk_mul_f32 v[18:19], v[18:19], v[66:67]
    v_pk_mul_f32 v[20:21], v[20:21], v[68:69]
    v_pk_mul_f32 v[22:23], v[22:23], v[70:71]
    v_cvt_pk_bf16_f32 v160, v16, v17
    v_cvt_pk_bf16_f32 v161, v18, v19
    v_cvt_pk_bf16_f32 v162, v20, v21
    v_cvt_pk_bf16_f32 v163, v22, v23
    v_pk_mul_f32 v[24:25], v[24:25], v[72:73]
    v_pk_mul_f32 v[26:27], v[26:27], v[74:75]
    v_pk_mul_f32 v[28:29], v[28:29], v[76:77]
    v_pk_mul_f32 v[30:31], v[30:31], v[78:79]
    v_cvt_pk_bf16_f32 v164, v24, v25
    v_cvt_pk_bf16_f32 v165, v26, v27
    v_cvt_pk_bf16_f32 v166, v28, v29
    v_cvt_pk_bf16_f32 v167, v30, v31
    s_nop 0
    v_permlane32_swap_b32 v160, v162
    v_permlane32_swap_b32 v161, v163
    v_permlane32_swap_b32 v164, v166
    v_permlane32_swap_b32 v165, v167
    s_cmp_eq_u32 s30, 0
    s_cbranch_scc1 adaLN_cond__grouped_kv_mqa__mixer_gmlp__prompt_kernel_sl17
    buffer_store_dwordx4 v[160:163], v12, s[52:55], s40 offen offset:0
    buffer_store_dwordx4 v[164:167], v12, s[52:55], s40 offen offset:512
    s_branch adaLN_cond__grouped_kv_mqa__mixer_gmlp__prompt_kernel_sd18
adaLN_cond__grouped_kv_mqa__mixer_gmlp__prompt_kernel_sl17:
    buffer_store_dwordx4 v[160:163], v12, s[52:55], s40 offen offset:0 sc1
    buffer_store_dwordx4 v[164:167], v12, s[52:55], s40 offen offset:512 sc1
adaLN_cond__grouped_kv_mqa__mixer_gmlp__prompt_kernel_sd18:
k5_p6:
    s_lshl_b32 s36, s3, 10
    s_add_u32 s36, s36, 364544
    s_lshl_b32 s37, s4, 7
    s_add_u32 s37, s37, s36
    s_waitcnt vmcnt(0)
    s_barrier
    s_cmp_lg_u32 s5, 0
    s_cbranch_scc1 k5_f5done
    v_mov_b32 v10, 1
    s_mov_b64 exec, 1
    s_cmp_eq_u32 s30, 0
    s_cbranch_scc1 adaLN_cond__grouped_kv_mqa__mixer_gmlp__prompt_kernel_sl19
    buffer_store_dword v10, off, s[16:19], s37
    s_branch adaLN_cond__grouped_kv_mqa__mixer_gmlp__prompt_kernel_sd20
adaLN_cond__grouped_kv_mqa__mixer_gmlp__prompt_kernel_sl19:
    buffer_store_dword v10, off, s[16:19], s37 sc1
adaLN_cond__grouped_kv_mqa__mixer_gmlp__prompt_kernel_sd20:
    s_mov_b64 exec, -1
k5_f5done:
    v_bfe_u32 v3, v0, 4, 2
    v_and_b32 v5, 15, v0
    s_lshl_b32 s6, s3, 2
    s_add_u32 s6, s6, s5
    s_lshl_b32 s10, s5, 10
    s_add_u32 s7, s7, s10
    s_mov_b32 s60, s46
    s_mov_b32 s61, s47
    s_mov_b32 s62, 0x280000
    s_mov_b32 s63, 0x20000
    s_mul_i32 s39, s5, 2816
    s_add_u32 s39, s39, 69632
    v_mul_u32_u24 v6, 176, v5
    v_lshl_add_u32 v6, v3, 3, v6
    v_add_u32 v204, s39, v6
    v_lshrrev_b32 v6, 4, v1
    v_add_u32 v6, 0, v6
    v_mul_u32_u24 v7, 205, v6
    v_lshrrev_b32 v7, 11, v7
    v_mul_u32_u24 v2, 10, v7
    v_sub_u32 v6, v6, v2
    v_lshlrev_b32 v6, 4, v6
    v_mul_u32_u24 v2, 176, v7
    v_add3_u32 v205, v2, v6, s39
    v_mul_u32_u24 v2, 1280, v7
    v_add_u32 v208, v6, v2
    v_lshrrev_b32 v6, 4, v1
    v_add_u32 v6, 64, v6
    v_mul_u32_u24 v7, 205, v6
    v_lshrrev_b32 v7, 11, v7
    v_mul_u32_u24 v2, 10, v7
    v_sub_u32 v6, v6, v2
    v_lshlrev_b32 v6, 4, v6
    v_mul_u32_u24 v2, 176, v7
    v_add3_u32 v206, v2, v6, s39
    v_mul_u32_u24 v2, 1280, v7
    v_add_u32 v209, v6, v2
    v_lshrrev_b32 v6, 4, v1
    v_add_u32 v6, 128, v6
    v_mul_u32_u24 v7, 205, v6
    v_lshrrev_b32 v7, 11, v7
    v_mul_u32_u24 v2, 10, v7
    v_sub_u32 v6, v6, v2
    v_lshlrev_b32 v6, 4, v6
    v_mul_u32_u24 v2, 176, v7
    v_add3_u32 v207, v2, v6, s39
    v_mul_u32_u24 v2, 1280, v7
    v_add_u32 v210, v6, v2
    v_lshrrev_b32 v7, 4, v7
    v_lshl_add_u32 v210, v7, 30, v210
    s_mul_i32 s40, s6, 20480
    s_mul_i32 s41, s4, 160
    s_add_u32 s40, s40, s41
    v_add_u32 v8, 0xf000, v1
    v_add_u32 v9, 0x1e000, v1
    ds_read_b128 v[132:135], v1 offset:0
    ds_read_b128 v[136:139], v1 offset:1024
    ds_read_b128 v[140:143], v1 offset:2048
    ds_read_b128 v[144:147], v1 offset:3072
    ds_read_b128 v[148:151], v1 offset:4096
    ds_read_b128 v[152:155], v1 offset:5120
    ds_read_b128 v[156:159], v1 offset:6144
    ds_read_b128 v[160:163], v1 offset:7168
    ds_read_b128 v[164:167], v1 offset:8192
    ds_read_b128 v[168:171], v1 offset:9216
    v_and_b32 v10, 7, v0
    v_lshlrev_b32 v10, 7, v10
    s_mov_b32 s38, 0
    buffer_load_dword v11, v10, s[16:19], s36 offen sc1
    s_sleep 1
k5_p5:
    buffer_load_dword v12, v10, s[16:19], s36 offen sc1
    s_waitcnt vmcnt(1)
    v_cmp_ne_u32 vcc, 0, v11
    s_cmp_eq_u64 vcc, -1
    s_cbranch_scc1 k5_p5_ok
    buffer_load_dword v11, v10, s[16:19], s36 offen sc1
    s_waitcnt vmcnt(1)
    v_cmp_ne_u32 vcc, 0, v12
    s_cmp_eq_u64 vcc, -1
    s_cbranch_scc1 k5_p5_ok
    s_add_u32 s38, s38, 1
    s_cmp_lt_u32 s38, 200000
    s_cbranch_scc1 k5_p5
k5_p5_ok:
    s_add_u32 s38, s7, 0
    buffer_load_dwordx4 v[16:19], v1, s[52:55], s38 offen sc1
    s_add_u32 s38, s7, 4096
    buffer_load_dwordx4 v[20:23], v1, s[52:55], s38 offen sc1
    s_add_u32 s38, s7, 8192
    buffer_load_dwordx4 v[24:27], v1, s[52:55], s38 offen sc1
    s_add_u32 s38, s7, 12288
    buffer_load_dwordx4 v[28:31], v1, s[52:55], s38 offen sc1
    s_add_u32 s38, s7, 16384
    buffer_load_dwordx4 v[32:35], v1, s[52:55], s38 offen sc1
    s_add_u32 s38, s7, 20480
    buffer_load_dwordx4 v[36:39], v1, s[52:55], s38 offen sc1
    s_add_u32 s38, s7, 24576
    buffer_load_dwordx4 v[40:43], v1, s[52:55], s38 offen sc1
    s_add_u32 s38, s7, 28672
    buffer_load_dwordx4 v[44:47], v1, s[52:55], s38 offen sc1
    s_add_u32 s38, s7, 32768
    buffer_load_dwordx4 v[48:51], v1, s[52:55], s38 offen sc1
    s_add_u32 s38, s7, 36864
    buffer_load_dwordx4 v[52:55], v1, s[52:55], s38 offen sc1
    s_add_u32 s38, s7, 40960
    buffer_load_dwordx4 v[56:59], v1, s[52:55], s38 offen sc1
    s_waitcnt vmcnt(10) lgkmcnt(5)
    v_mfma_f32_16x16x32_bf16 v[112:115], v[132:135], v[16:19], 0
    ds_read_b128 v[212:215], v1 offset:10240
    v_mfma_f32_16x16x32_bf16 v[116:119], v[136:139], v[16:19], 0
    ds_read_b128 v[216:219], v1 offset:11264
    v_mfma_f32_16x16x32_bf16 v[120:123], v[140:143], v[16:19], 0
    ds_read_b128 v[220:223], v1 offset:12288
    v_mfma_f32_16x16x32_bf16 v[124:127], v[144:147], v[16:19], 0
    ds_read_b128 v[224:227], v1 offset:13312
    v_mfma_f32_16x16x32_bf16 v[128:131], v[148:151], v[16:19], 0
    ds_read_b128 v[228:231], v1 offset:14336
    s_add_u32 s38, s7, 45056
    buffer_load_dwordx4 v[60:63], v1, s[52:55], s38 offen sc1
    s_waitcnt vmcnt(10) lgkmcnt(5)
    v_mfma_f32_16x16x32_bf16 v[112:115], v[152:155], v[20:23], v[112:115]
    ds_read_b128 v[132:135], v1 offset:15360
    v_mfma_f32_16x16x32_bf16 v[116:119], v[156:159], v[20:23], v[116:119]
    ds_read_b128 v[136:139], v1 offset:16384
    v_mfma_f32_16x16x32_bf16 v[120:123], v[160:163], v[20:23], v[120:123]
    ds_read_b128 v[140:143], v1 offset:17408
    v_mfma_f32_16x16x32_bf16 v[124:127], v[164:167], v[20:23], v[124:127]
    ds_read_b128 v[144:147], v1 offset:18432
    v_mfma_f32_16x16x32_bf16 v[128:131], v[168:171], v[20:23], v[128:131]
    ds_read_b128 v[148:151], v1 offset:19456
    s_add_u32 s38, s7, 49152
    buffer_load_dwordx4 v[64:67], v1, s[52:55], s38 offen sc1
    s_waitcnt vmcnt(10) lgkmcnt(5)
    v_mfma_f32_16x16x32_bf16 v[112:115], v[212:215], v[24:27], v[112:115]
    ds_read_b128 v[152:155], v1 offset:20480
    v_mfma_f32_16x16x32_bf16 v[116:119], v[216:219], v[24:27], v[116:119]
    ds_read_b128 v[156:159], v1 offset:21504
    v_mfma_f32_16x16x32_bf16 v[120:123], v[220:223], v[24:27], v[120:123]
    ds_read_b128 v[160:163], v1 offset:22528
    v_mfma_f32_16x16x32_bf16 v[124:127], v[224:227], v[24:27], v[124:127]
    ds_read_b128 v[164:167], v1 offset:23552
    v_mfma_f32_16x16x32_bf16 v[128:131], v[228:231], v[24:27], v[128:131]
    ds_read_b128 v[168:171], v1 offset:24576
    s_add_u32 s38, s7, 53248
    buffer_load_dwordx4 v[68:71], v1, s[52:55], s38 offen sc1
    s_waitcnt vmcnt(10) lgkmcnt(5)
    v_mfma_f32_16x16x32_bf16 v[112:115], v[132:135], v[28:31], v[112:115]
    ds_read_b128 v[212:215], v1 offset:25600
    v_mfma_f32_16x16x32_bf16 v[116:119], v[136:139], v[28:31], v[116:119]
    ds_read_b128 v[216:219], v1 offset:26624
    v_mfma_f32_16x16x32_bf16 v[120:123], v[140:143], v[28:31], v[120:123]
    ds_read_b128 v[220:223], v1 offset:27648
    v_mfma_f32_16x16x32_bf16 v[124:127], v[144:147], v[28:31], v[124:127]
    ds_read_b128 v[224:227], v1 offset:28672
    v_mfma_f32_16x16x32_bf16 v[128:131], v[148:151], v[28:31], v[128:131]
    ds_read_b128 v[228:231], v1 offset:29696
    s_add_u32 s38, s7, 57344
    buffer_load_dwordx4 v[72:75], v1, s[52:55], s38 offen sc1
    s_waitcnt vmcnt(10) lgkmcnt(5)
    v_mfma_f32_16x16x32_bf16 v[112:115], v[152:155], v[32:35], v[112:115]
    ds_read_b128 v[132:135], v1 offset:30720
    v_mfma_f32_16x16x32_bf16 v[116:119], v[156:159], v[32:35], v[116:119]
    ds_read_b128 v[136:139], v1 offset:31744
    v_mfma_f32_16x16x32_bf16 v[120:123], v[160:163], v[32:35], v[120:123]
    ds_read_b128 v[140:143], v1 offset:32768
    v_mfma_f32_16x16x32_bf16 v[124:127], v[164:167], v[32:35], v[124:127]
    ds_read_b128 v[144:147], v1 offset:33792
    v_mfma_f32_16x16x32_bf16 v[128:131], v[168:171], v[32:35], v[128:131]
    ds_read_b128 v[148:151], v1 offset:34816
    s_add_u32 s38, s7, 61440
    buffer_load_dwordx4 v[76:79], v1, s[52:55], s38 offen sc1
    s_waitcnt vmcnt(10) lgkmcnt(5)
    v_mfma_f32_16x16x32_bf16 v[112:115], v[212:215], v[36:39], v[112:115]
    ds_read_b128 v[152:155], v1 offset:35840
    v_mfma_f32_16x16x32_bf16 v[116:119], v[216:219], v[36:39], v[116:119]
    ds_read_b128 v[156:159], v1 offset:36864
    v_mfma_f32_16x16x32_bf16 v[120:123], v[220:223], v[36:39], v[120:123]
    ds_read_b128 v[160:163], v1 offset:37888
    v_mfma_f32_16x16x32_bf16 v[124:127], v[224:227], v[36:39], v[124:127]
    ds_read_b128 v[164:167], v1 offset:38912
    v_mfma_f32_16x16x32_bf16 v[128:131], v[228:231], v[36:39], v[128:131]
    ds_read_b128 v[168:171], v1 offset:39936
    s_add_u32 s38, s7, 65536
    buffer_load_dwordx4 v[80:83], v1, s[52:55], s38 offen sc1
    s_waitcnt vmcnt(10) lgkmcnt(5)
    v_mfma_f32_16x16x32_bf16 v[112:115], v[132:135], v[40:43], v[112:115]
    ds_read_b128 v[212:215], v8 offset:20480
    v_mfma_f32_16x16x32_bf16 v[116:119], v[136:139], v[40:43], v[116:119]
    ds_read_b128 v[216:219], v8 offset:21504
    v_mfma_f32_16x16x32_bf16 v[120:123], v[140:143], v[40:43], v[120:123]
    ds_read_b128 v[220:223], v8 offset:22528
    v_mfma_f32_16x16x32_bf16 v[124:127], v[144:147], v[40:43], v[124:127]
    ds_read_b128 v[224:227], v8 offset:23552
    v_mfma_f32_16x16x32_bf16 v[128:131], v[148:151], v[40:43], v[128:131]
    ds_read_b128 v[228:231], v8 offset:24576
    s_add_u32 s38, s7, 69632
    buffer_load_dwordx4 v[84:87], v1, s[52:55], s38 offen sc1
    s_waitcnt vmcnt(10) lgkmcnt(5)
    v_mfma_f32_16x16x32_bf16 v[112:115], v[152:155], v[44:47], v[112:115]
    ds_read_b128 v[132:135], v8 offset:25600
    v_mfma_f32_16x16x32_bf16 v[116:119], v[156:159], v[44:47], v[116:119]
    ds_read_b128 v[136:139], v8 offset:26624
    v_mfma_f32_16x16x32_bf16 v[120:123], v[160:163], v[44:47], v[120:123]
    ds_read_b128 v[140:143], v8 offset:27648
    v_mfma_f32_16x16x32_bf16 v[124:127], v[164:167], v[44:47], v[124:127]
    ds_read_b128 v[144:147], v8 offset:28672
    v_mfma_f32_16x16x32_bf16 v[128:131], v[168:171], v[44:47], v[128:131]
    ds_read_b128 v[148:151], v8 offset:29696
    s_add_u32 s38, s7, 73728
    buffer_load_dwordx4 v[88:91], v1, s[52:55], s38 offen sc1
    s_waitcnt vmcnt(10) lgkmcnt(5)
    v_mfma_f32_16x16x32_bf16 v[112:115], v[212:215], v[48:51], v[112:115]
    ds_read_b128 v[152:155], v8 offset:30720
    v_mfma_f32_16x16x32_bf16 v[116:119], v[216:219], v[48:51], v[116:119]
    ds_read_b128 v[156:159], v8 offset:31744
    v_mfma_f32_16x16x32_bf16 v[120:123], v[220:223], v[48:51], v[120:123]
    ds_read_b128 v[160:163], v8 offset:32768
    v_mfma_f32_16x16x32_bf16 v[124:127], v[224:227], v[48:51], v[124:127]
    ds_read_b128 v[164:167], v8 offset:33792
    v_mfma_f32_16x16x32_bf16 v[128:131], v[228:231], v[48:51], v[128:131]
    ds_read_b128 v[168:171], v8 offset:34816
    s_add_u32 s38, s7, 77824
    buffer_load_dwordx4 v[92:95], v1, s[52:55], s38 offen sc1
    s_waitcnt vmcnt(10) lgkmcnt(5)
    v_mfma_f32_16x16x32_bf16 v[112:115], v[132:135], v[52:55], v[112:115]
    ds_read_b128 v[212:215], v8 offset:35840
    v_mfma_f32_16x16x32_bf16 v[116:119], v[136:139], v[52:55], v[116:119]
    ds_read_b128 v[216:219], v8 offset:36864
    v_mfma_f32_16x16x32_bf16 v[120:123], v[140:143], v[52:55], v[120:123]
    ds_read_b128 v[220:223], v8 offset:37888
    v_mfma_f32_16x16x32_bf16 v[124:127], v[144:147], v[52:55], v[124:127]
    ds_read_b128 v[224:227], v8 offset:38912
    v_mfma_f32_16x16x32_bf16 v[128:131], v[148:151], v[52:55], v[128:131]
    ds_read_b128 v[228:231], v8 offset:39936
    s_add_u32 s38, s7, 81920
    buffer_load_dwordx4 v[96:99], v1, s[52:55], s38 offen sc1
    s_waitcnt vmcnt(10) lgkmcnt(5)
    v_mfma_f32_16x16x32_bf16 v[112:115], v[152:155], v[56:59], v[112:115]
    ds_read_b128 v[132:135], v8 offset:40960
    v_mfma_f32_16x16x32_bf16 v[116:119], v[156:159], v[56:59], v[116:119]
    ds_read_b128 v[136:139], v8 offset:41984
    v_mfma_f32_16x16x32_bf16 v[120:123], v[160:163], v[56:59], v[120:123]
    ds_read_b128 v[140:143], v8 offset:43008
    v_mfma_f32_16x16x32_bf16 v[124:127], v[164:167], v[56:59], v[124:127]
    ds_read_b128 v[144:147], v8 offset:44032
    v_mfma_f32_16x16x32_bf16 v[128:131], v[168:171], v[56:59], v[128:131]
    ds_read_b128 v[148:151], v8 offset:45056
    s_add_u32 s38, s7, 86016
    buffer_load_dwordx4 v[100:103], v1, s[52:55], s38 offen sc1
    s_waitcnt vmcnt(10) lgkmcnt(5)
    v_mfma_f32_16x16x32_bf16 v[112:115], v[212:215], v[60:63], v[112:115]
    ds_read_b128 v[152:155], v8 offset:46080
    v_mfma_f32_16x16x32_bf16 v[116:119], v[216:219], v[60:63], v[116:119]
    ds_read_b128 v[156:159], v8 offset:47104
    v_mfma_f32_16x16x32_bf16 v[120:123], v[220:223], v[60:63], v[120:123]
    ds_read_b128 v[160:163], v8 offset:48128
    v_mfma_f32_16x16x32_bf16 v[124:127], v[224:227], v[60:63], v[124:127]
    ds_read_b128 v[164:167], v8 offset:49152
    v_mfma_f32_16x16x32_bf16 v[128:131], v[228:231], v[60:63], v[128:131]
    ds_read_b128 v[168:171], v8 offset:50176
    s_add_u32 s38, s7, 90112
    buffer_load_dwordx4 v[104:107], v1, s[52:55], s38 offen sc1
    s_waitcnt vmcnt(10) lgkmcnt(5)
    v_mfma_f32_16x16x32_bf16 v[112:115], v[132:135], v[64:67], v[112:115]
    ds_read_b128 v[212:215], v8 offset:51200
    v_mfma_f32_16x16x32_bf16 v[116:119], v[136:139], v[64:67], v[116:119]
    ds_read_b128 v[216:219], v8 offset:52224
    v_mfma_f32_16x16x32_bf16 v[120:123], v[140:143], v[64:67], v[120:123]
    ds_read_b128 v[220:223], v8 offset:53248
    v_mfma_f32_16x16x32_bf16 v[124:127], v[144:147], v[64:67], v[124:127]
    ds_read_b128 v[224:227], v8 offset:54272
    v_mfma_f32_16x16x32_bf16 v[128:131], v[148:151], v[64:67], v[128:131]
    ds_read_b128 v[228:231], v8 offset:55296
    s_add_u32 s38, s7, 94208
    buffer_load_dwordx4 v[108:111], v1, s[52:55], s38 offen sc1
    s_waitcnt vmcnt(10) lgkmcnt(5)
    v_mfma_f32_16x16x32_bf16 v[112:115], v[152:155], v[68:71], v[112:115]
    ds_read_b128 v[132:135], v8 offset:56320
    v_mfma_f32_16x16x32_bf16 v[116:119], v[156:159], v[68:71], v[116:119]
    ds_read_b128 v[136:139], v8 offset:57344
    v_mfma_f32_16x16x32_bf16 v[120:123], v[160:163], v[68:71], v[120:123]
    ds_read_b128 v[140:143], v8 offset:58368
    v_mfma_f32_16x16x32_bf16 v[124:127], v[164:167], v[68:71], v[124:127]
    ds_read_b128 v[144:147], v8 offset:59392
    v_mfma_f32_16x16x32_bf16 v[128:131], v[168:171], v[68:71], v[128:131]
    ds_read_b128 v[148:151], v8 offset:60416
    s_waitcnt vmcnt(9) lgkmcnt(5)
    v_mfma_f32_16x16x32_bf16 v[112:115], v[212:215], v[72:75], v[112:115]
    ds_read_b128 v[152:155], v9 offset:0
    v_mfma_f32_16x16x32_bf16 v[116:119], v[216:219], v[72:75], v[116:119]
    ds_read_b128 v[156:159], v9 offset:1024
    v_mfma_f32_16x16x32_bf16 v[120:123], v[220:223], v[72:75], v[120:123]
    ds_read_b128 v[160:163], v9 offset:2048
    v_mfma_f32_16x16x32_bf16 v[124:127], v[224:227], v[72:75], v[124:127]
    ds_read_b128 v[164:167], v9 offset:3072
    v_mfma_f32_16x16x32_bf16 v[128:131], v[228:231], v[72:75], v[128:131]
    ds_read_b128 v[168:171], v9 offset:4096
    s_waitcnt vmcnt(8) lgkmcnt(5)
    v_mfma_f32_16x16x32_bf16 v[112:115], v[132:135], v[76:79], v[112:115]
    ds_read_b128 v[212:215], v9 offset:5120
    v_mfma_f32_16x16x32_bf16 v[116:119], v[136:139], v[76:79], v[116:119]
    ds_read_b128 v[216:219], v9 offset:6144
    v_mfma_f32_16x16x32_bf16 v[120:123], v[140:143], v[76:79], v[120:123]
    ds_read_b128 v[220:223], v9 offset:7168
    v_mfma_f32_16x16x32_bf16 v[124:127], v[144:147], v[76:79], v[124:127]
    ds_read_b128 v[224:227], v9 offset:8192
    v_mfma_f32_16x16x32_bf16 v[128:131], v[148:151], v[76:79], v[128:131]
    ds_read_b128 v[228:231], v9 offset:9216
    s_waitcnt vmcnt(7) lgkmcnt(5)
    v_mfma_f32_16x16x32_bf16 v[112:115], v[152:155], v[80:83], v[112:115]
    ds_read_b128 v[132:135], v9 offset:10240
    v_mfma_f32_16x16x32_bf16 v[116:119], v[156:159], v[80:83], v[116:119]
    ds_read_b128 v[136:139], v9 offset:11264
    v_mfma_f32_16x16x32_bf16 v[120:123], v[160:163], v[80:83], v[120:123]
    ds_read_b128 v[140:143], v9 offset:12288
    v_mfma_f32_16x16x32_bf16 v[124:127], v[164:167], v[80:83], v[124:127]
    ds_read_b128 v[144:147], v9 offset:13312
    v_mfma_f32_16x16x32_bf16 v[128:131], v[168:171], v[80:83], v[128:131]
    ds_read_b128 v[148:151], v9 offset:14336
    s_waitcnt vmcnt(6) lgkmcnt(5)
    v_mfma_f32_16x16x32_bf16 v[112:115], v[212:215], v[84:87], v[112:115]
    ds_read_b128 v[152:155], v9 offset:15360
    v_mfma_f32_16x16x32_bf16 v[116:119], v[216:219], v[84:87], v[116:119]
    ds_read_b128 v[156:159], v9 offset:16384
    v_mfma_f32_16x16x32_bf16 v[120:123], v[220:223], v[84:87], v[120:123]
    ds_read_b128 v[160:163], v9 offset:17408
    v_mfma_f32_16x16x32_bf16 v[124:127], v[224:227], v[84:87], v[124:127]
    ds_read_b128 v[164:167], v9 offset:18432
    v_mfma_f32_16x16x32_bf16 v[128:131], v[228:231], v[84:87], v[128:131]
    ds_read_b128 v[168:171], v9 offset:19456
    s_waitcnt vmcnt(5) lgkmcnt(5)
    v_mfma_f32_16x16x32_bf16 v[112:115], v[132:135], v[88:91], v[112:115]
    ds_read_b128 v[212:215], v9 offset:20480
    v_mfma_f32_16x16x32_bf16 v[116:119], v[136:139], v[88:91], v[116:119]
    ds_read_b128 v[216:219], v9 offset:21504
    v_mfma_f32_16x16x32_bf16 v[120:123], v[140:143], v[88:91], v[120:123]
    ds_read_b128 v[220:223], v9 offset:22528
    v_mfma_f32_16x16x32_bf16 v[124:127], v[144:147], v[88:91], v[124:127]
    ds_read_b128 v[224:227], v9 offset:23552
    v_mfma_f32_16x16x32_bf16 v[128:131], v[148:151], v[88:91], v[128:131]
    ds_read_b128 v[228:231], v9 offset:24576
    s_waitcnt vmcnt(4) lgkmcnt(5)
    v_mfma_f32_16x16x32_bf16 v[112:115], v[152:155], v[92:95], v[112:115]
    ds_read_b128 v[132:135], v9 offset:25600
    v_mfma_f32_16x16x32_bf16 v[116:119], v[156:159], v[92:95], v[116:119]
    ds_read_b128 v[136:139], v9 offset:26624
    v_mfma_f32_16x16x32_bf16 v[120:123], v[160:163], v[92:95], v[120:123]
    ds_read_b128 v[140:143], v9 offset:27648
    v_mfma_f32_16x16x32_bf16 v[124:127], v[164:167], v[92:95], v[124:127]
    ds_read_b128 v[144:147], v9 offset:28672
    v_mfma_f32_16x16x32_bf16 v[128:131], v[168:171], v[92:95], v[128:131]
    ds_read_b128 v[148:151], v9 offset:29696
    s_waitcnt vmcnt(3) lgkmcnt(5)
    v_mfma_f32_16x16x32_bf16 v[112:115], v[212:215], v[96:99], v[112:115]
    ds_read_b128 v[152:155], v9 offset:30720
    v_mfma_f32_16x16x32_bf16 v[116:119], v[216:219], v[96:99], v[116:119]
    ds_read_b128 v[156:159], v9 offset:31744
    v_mfma_f32_16x16x32_bf16 v[120:123], v[220:223], v[96:99], v[120:123]
    ds_read_b128 v[160:163], v9 offset:32768
    v_mfma_f32_16x16x32_bf16 v[124:127], v[224:227], v[96:99], v[124:127]
    ds_read_b128 v[164:167], v9 offset:33792
    v_mfma_f32_16x16x32_bf16 v[128:131], v[228:231], v[96:99], v[128:131]
    ds_read_b128 v[168:171], v9 offset:34816
    s_waitcnt vmcnt(2) lgkmcnt(5)
    v_mfma_f32_16x16x32_bf16 v[112:115], v[132:135], v[100:103], v[112:115]
    ds_read_b128 v[212:215], v9 offset:35840
    v_mfma_f32_16x16x32_bf16 v[116:119], v[136:139], v[100:103], v[116:119]
    ds_read_b128 v[216:219], v9 offset:36864
    v_mfma_f32_16x16x32_bf16 v[120:123], v[140:143], v[100:103], v[120:123]
    ds_read_b128 v[220:223], v9 offset:37888
    v_mfma_f32_16x16x32_bf16 v[124:127], v[144:147], v[100:103], v[124:127]
    ds_read_b128 v[224:227], v9 offset:38912
    v_mfma_f32_16x16x32_bf16 v[128:131], v[148:151], v[100:103], v[128:131]
    ds_read_b128 v[228:231], v9 offset:39936
    s_waitcnt vmcnt(1) lgkmcnt(5)
    v_mfma_f32_16x16x32_bf16 v[112:115], v[152:155], v[104:107], v[112:115]
    v_mfma_f32_16x16x32_bf16 v[116:119], v[156:159], v[104:107], v[116:119]
    v_mfma_f32_16x16x32_bf16 v[120:123], v[160:163], v[104:107], v[120:123]
    v_mfma_f32_16x16x32_bf16 v[124:127], v[164:167], v[104:107], v[124:127]
    v_mfma_f32_16x16x32_bf16 v[128:131], v[168:171], v[104:107], v[128:131]
    s_waitcnt vmcnt(0) lgkmcnt(0)
    v_mfma_f32_16x16x32_bf16 v[112:115], v[212:215], v[108:111], v[112:115]
    v_mfma_f32_16x16x32_bf16 v[116:119], v[216:219], v[108:111], v[116:119]
    v_mfma_f32_16x16x32_bf16 v[120:123], v[220:223], v[108:111], v[120:123]
    v_mfma_f32_16x16x32_bf16 v[124:127], v[224:227], v[108:111], v[124:127]
    v_mfma_f32_16x16x32_bf16 v[128:131], v[228:231], v[108:111], v[128:131]
    s_nop 3
    v_lshlrev_b32 v132, 16, v232
    v_and_b32 v133, 0xffff0000, v232
    v_lshlrev_b32 v134, 16, v233
    v_and_b32 v135, 0xffff0000, v233
    v_lshlrev_b32 v136, 16, v234
    v_and_b32 v137, 0xffff0000, v234
    v_lshlrev_b32 v138, 16, v235
    v_and_b32 v139, 0xffff0000, v235
    v_lshlrev_b32 v140, 16, v236
    v_and_b32 v141, 0xffff0000, v236
    v_lshlrev_b32 v142, 16, v237
    v_and_b32 v143, 0xffff0000, v237
    v_lshlrev_b32 v144, 16, v238
    v_and_b32 v145, 0xffff0000, v238
    v_lshlrev_b32 v146, 16, v239
    v_and_b32 v147, 0xffff0000, v239
    v_lshlrev_b32 v148, 16, v240
    v_and_b32 v149, 0xffff0000, v240
    v_lshlrev_b32 v150, 16, v241
    v_and_b32 v151, 0xffff0000, v241
    v_pk_fma_f32 v[112:113], v[112:113], v[184:185], v[132:133]
    v_pk_fma_f32 v[114:115], v[114:115], v[186:187], v[134:135]
    v_pk_fma_f32 v[116:117], v[116:117], v[188:189], v[136:137]
    v_pk_fma_f32 v[118:119], v[118:119], v[190:191], v[138:139]
    v_pk_fma_f32 v[120:121], v[120:121], v[192:193], v[140:141]
    v_pk_fma_f32 v[122:123], v[122:123], v[194:195], v[142:143]
    v_pk_fma_f32 v[124:125], v[124:125], v[196:197], v[144:145]
    v_pk_fma_f32 v[126:127], v[126:127], v[198:199], v[146:147]
    v_pk_fma_f32 v[128:129], v[128:129], v[200:201], v[148:149]
    v_pk_fma_f32 v[130:131], v[130:131], v[202:203], v[150:151]
    v_cvt_pk_bf16_f32 v232, v112, v113
    v_cvt_pk_bf16_f32 v233, v114, v115
    v_cvt_pk_bf16_f32 v234, v116, v117
    v_cvt_pk_bf16_f32 v235, v118, v119
    v_cvt_pk_bf16_f32 v236, v120, v121
    v_cvt_pk_bf16_f32 v237, v122, v123
    v_cvt_pk_bf16_f32 v238, v124, v125
    v_cvt_pk_bf16_f32 v239, v126, v127
    v_cvt_pk_bf16_f32 v240, v128, v129
    v_cvt_pk_bf16_f32 v241, v130, v131
    ds_write_b64 v204, v[232:233] offset:0
    ds_write_b64 v204, v[234:235] offset:32
    ds_write_b64 v204, v[236:237] offset:64
    ds_write_b64 v204, v[238:239] offset:96
    ds_write_b64 v204, v[240:241] offset:128
    s_waitcnt lgkmcnt(0)
    ds_read_b128 v[132:135], v205
    ds_read_b128 v[136:139], v206
    ds_read_b128 v[140:143], v207
    s_waitcnt lgkmcnt(2)
    buffer_store_dwordx4 v[132:135], v208, s[60:63], s40 offen
    s_waitcnt lgkmcnt(1)
    buffer_store_dwordx4 v[136:139], v209, s[60:63], s40 offen
    s_waitcnt lgkmcnt(0)
    buffer_store_dwordx4 v[140:143], v210, s[60:63], s40 offen
    s_or_b32 s36, s2, s5
    s_cmp_lg_u32 s36, 0
    s_cbranch_scc1 k5_noep
    s_add_u32 s56, s8, 0xb08000
    s_addc_u32 s57, s9, 0
    s_mov_b32 s58, 0x4
    s_mov_b32 s59, 0x20000
    v_mov_b32 v10, s31
    buffer_store_dword v10, off, s[56:59], 0
k5_noep:
    s_endpgm
k5_loader:
    s_mov_b32 s3, s24
    s_mov_b32 s4, s25
    s_mov_b32 s5, s26
    s_mul_i32 s34, s4, 393216
    s_add_u32 s34, s34, 25165824
    s_lshl_b32 s35, s3, 18
    s_add_u32 s35, s35, 28311552
    s_mul_i32 s11, s5, 5120
    s_mul_i32 s33, s4, 122880
    s_add_u32 s33, s33, 2490368
    s_lshl_b32 s10, s5, 10
    s_add_u32 s52, s8, s34
    s_addc_u32 s53, s9, 0
    s_mov_b32 s54, 0x60000
    s_mov_b32 s55, 0x20000
    s_add_u32 s56, s8, s35
    s_addc_u32 s57, s9, 0
    s_mov_b32 s58, 0x40000
    s_mov_b32 s59, 0x20000
    s_add_u32 s60, s8, s33
    s_addc_u32 s61, s9, 0
    s_mov_b32 s62, 0x1e000
    s_mov_b32 s63, 0x20000
    s_and_b32 s45, s3, 28
    s_mul_i32 s37, s5, 3072
    s_mul_i32 s46, s45, 12288
    s_add_u32 s37, s37, s46
    s_lshl_b32 s36, s5, 11
    s_lshl_b32 s46, s45, 13
    s_add_u32 s36, s36, s46
    s_lshl_b32 s46, 15, s45
    s_mov_b32 s45, -1
    s_add_u32 m0, s11, 3072
    s_nop 0
    buffer_load_dwordx4 v1, s[56:59], s36 offen offset:0 sc1 lds
    buffer_load_dwordx4 v1, s[56:59], s36 offen offset:1024 sc1 lds
    s_add_u32 s36, s36, 8192
    s_and_b32 s36, s36, 0x3ffff
    s_add_u32 m0, s11, 23552
    s_nop 0
    buffer_load_dwordx4 v1, s[56:59], s36 offen offset:0 sc1 lds
    buffer_load_dwordx4 v1, s[56:59], s36 offen offset:1024 sc1 lds
    s_add_u32 s36, s36, 8192
    s_and_b32 s36, s36, 0x3ffff
    s_add_u32 m0, s11, 44032
    s_nop 0
    buffer_load_dwordx4 v1, s[56:59], s36 offen offset:0 sc1 lds
    buffer_load_dwordx4 v1, s[56:59], s36 offen offset:1024 sc1 lds
    s_add_u32 s36, s36, 8192
    s_and_b32 s36, s36, 0x3ffff
    s_add_u32 s44, s10, 40960
    s_add_u32 m0, s44, 40960
    s_nop 0
    buffer_load_dwordx4 v1, s[60:63], s44 offen sc1 lds
    s_add_u32 s44, s44, 4096
    s_waitcnt vmcnt(5)
    s_add_u32 m0, s44, 40960
    s_nop 0
    buffer_load_dwordx4 v1, s[60:63], s44 offen sc1 lds
    s_add_u32 s44, s44, 4096
    s_waitcnt vmcnt(5)
    s_add_u32 m0, s44, 40960
    s_nop 0
    buffer_load_dwordx4 v1, s[60:63], s44 offen sc1 lds
    s_add_u32 s44, s44, 4096
    s_waitcnt vmcnt(5)
    s_add_u32 m0, s44, 40960
    s_nop 0
    buffer_load_dwordx4 v1, s[60:63], s44 offen sc1 lds
    s_add_u32 s44, s44, 4096
    s_waitcnt vmcnt(5)
    s_add_u32 m0, s44, 40960
    s_nop 0
    buffer_load_dwordx4 v1, s[60:63], s44 offen sc1 lds
    s_add_u32 s44, s44, 4096
    s_waitcnt vmcnt(5)
    s_add_u32 m0, s44, 40960
    s_nop 0
    buffer_load_dwordx4 v1, s[60:63], s44 offen sc1 lds
    s_add_u32 s44, s44, 4096
    s_waitcnt vmcnt(5)
    s_add_u32 m0, s44, 40960
    s_nop 0
    buffer_load_dwordx4 v1, s[60:63], s44 offen sc1 lds
    s_add_u32 s44, s44, 4096
    s_waitcnt vmcnt(5)
    s_add_u32 m0, s44, 40960
    s_nop 0
    buffer_load_dwordx4 v1, s[60:63], s44 offen sc1 lds
    s_add_u32 s44, s44, 4096
    s_waitcnt vmcnt(5)
    s_add_u32 m0, s44, 40960
    s_nop 0
    buffer_load_dwordx4 v1, s[60:63], s44 offen sc1 lds
    s_add_u32 s44, s44, 4096
    s_waitcnt vmcnt(5)
    s_add_u32 m0, s44, 40960
    s_nop 0
    buffer_load_dwordx4 v1, s[60:63], s44 offen sc1 lds
    s_add_u32 s44, s44, 4096
    s_waitcnt vmcnt(5)
    s_add_u32 m0, s44, 40960
    s_nop 0
    buffer_load_dwordx4 v1, s[60:63], s44 offen sc1 lds
    s_add_u32 s44, s44, 4096
    s_waitcnt vmcnt(5)
    s_add_u32 m0, s44, 40960
    s_nop 0
    buffer_load_dwordx4 v1, s[60:63], s44 offen sc1 lds
    s_add_u32 s44, s44, 4096
    s_waitcnt vmcnt(5)
    s_add_u32 m0, s44, 40960
    s_nop 0
    buffer_load_dwordx4 v1, s[60:63], s44 offen sc1 lds
    s_add_u32 s44, s44, 4096
    s_waitcnt vmcnt(5)
    s_add_u32 m0, s44, 40960
    s_nop 0
    buffer_load_dwordx4 v1, s[60:63], s44 offen sc1 lds
    s_add_u32 s44, s44, 4096
    s_waitcnt vmcnt(5)
    s_add_u32 m0, s44, 40960
    s_nop 0
    buffer_load_dwordx4 v1, s[60:63], s44 offen sc1 lds
    s_add_u32 s44, s44, 4096
    s_waitcnt vmcnt(5)
    s_add_u32 m0, s44, 40960
    s_nop 0
    buffer_load_dwordx4 v1, s[60:63], s44 offen sc1 lds
    s_add_u32 s44, s44, 4096
    s_waitcnt vmcnt(5)
    s_add_u32 m0, s44, 40960
    s_nop 0
    buffer_load_dwordx4 v1, s[60:63], s44 offen sc1 lds
    s_add_u32 s44, s44, 4096
    s_waitcnt vmcnt(5)
    s_add_u32 m0, s44, 40960
    s_nop 0
    buffer_load_dwordx4 v1, s[60:63], s44 offen sc1 lds
    s_add_u32 s44, s44, 4096
    s_waitcnt vmcnt(5)
    s_add_u32 m0, s44, 40960
    s_nop 0
    buffer_load_dwordx4 v1, s[60:63], s44 offen sc1 lds
    s_add_u32 s44, s44, 4096
    s_waitcnt vmcnt(5)
    s_add_u32 m0, s44, 40960
    s_nop 0
    buffer_load_dwordx4 v1, s[60:63], s44 offen sc1 lds
    s_add_u32 s44, s44, 4096
    s_waitcnt vmcnt(5)
    v_and_b32 v12, 1, v0
    v_bfe_u32 v13, v0, 1, 4
    v_lshlrev_b32 v12, 7, v12
    v_lshl_add_u32 v12, v13, 11, v12
    v_mov_b32 v13, 0
    s_lshl_b32 s39, s4, 8
    s_add_u32 s39, s39, 397312
    s_barrier
    s_cmp_lg_u32 s5, 0
    s_cbranch_scc1 adaLN_cond__grouped_kv_mqa__mixer_gmlp__prompt_kernel_nd21_x
    s_cmp_eq_u32 s45, 0
    s_cbranch_scc1 adaLN_cond__grouped_kv_mqa__mixer_gmlp__prompt_kernel_nd21_x
    s_mov_b32 s38, 0
adaLN_cond__grouped_kv_mqa__mixer_gmlp__prompt_kernel_nd21:
    v_cmp_eq_u32 vcc, 0, v13
    s_add_u32 s38, s38, 1
    s_mov_b32 s45, vcc_lo
    s_cmp_eq_u32 s45, 0
    s_cbranch_scc1 adaLN_cond__grouped_kv_mqa__mixer_gmlp__prompt_kernel_nd21_x
    s_mov_b32 exec_lo, s45
    s_mov_b32 exec_hi, 0
    buffer_load_dword v13, v12, s[16:19], s39 offen sc1
    s_mov_b64 exec, -1
    s_and_b32 s47, s45, s46
    s_cbranch_scc0 adaLN_cond__grouped_kv_mqa__mixer_gmlp__prompt_kernel_nd21_ok
    s_waitcnt vmcnt(0)
    s_cmp_lt_u32 s38, 200000
    s_cbranch_scc1 adaLN_cond__grouped_kv_mqa__mixer_gmlp__prompt_kernel_nd21
adaLN_cond__grouped_kv_mqa__mixer_gmlp__prompt_kernel_nd21_ok:
    s_lshr_b32 s47, s46, 30
    s_lshl_b32 s46, s46, 2
    s_or_b32 s46, s46, s47
adaLN_cond__grouped_kv_mqa__mixer_gmlp__prompt_kernel_nd21_x:
    s_barrier
    s_add_u32 m0, s11, 0
    s_nop 0
    buffer_load_dwordx4 v1, s[52:55], s37 offen offset:0 sc1 lds
    buffer_load_dwordx4 v1, s[52:55], s37 offen offset:1024 sc1 lds
    buffer_load_dwordx4 v1, s[52:55], s37 offen offset:2048 sc1 lds
    s_add_u32 s37, s37, 12288
    s_cmp_ge_u32 s37, 393216
    s_cselect_b32 s47, 393216, 0
    s_sub_u32 s37, s37, s47
    s_add_u32 m0, s11, 20480
    s_nop 0
    buffer_load_dwordx4 v1, s[52:55], s37 offen offset:0 sc1 lds
    buffer_load_dwordx4 v1, s[52:55], s37 offen offset:1024 sc1 lds
    buffer_load_dwordx4 v1, s[52:55], s37 offen offset:2048 sc1 lds
    s_add_u32 s37, s37, 12288
    s_cmp_ge_u32 s37, 393216
    s_cselect_b32 s47, 393216, 0
    s_sub_u32 s37, s37, s47
    s_add_u32 m0, s11, 40960
    s_nop 0
    buffer_load_dwordx4 v1, s[52:55], s37 offen offset:0 sc1 lds
    buffer_load_dwordx4 v1, s[52:55], s37 offen offset:1024 sc1 lds
    buffer_load_dwordx4 v1, s[52:55], s37 offen offset:2048 sc1 lds
    s_add_u32 s37, s37, 12288
    s_cmp_ge_u32 s37, 393216
    s_cselect_b32 s47, 393216, 0
    s_sub_u32 s37, s37, s47
    s_waitcnt vmcnt(6)
    s_barrier
    s_add_u32 m0, s11, 61440
    s_nop 0
    buffer_load_dwordx4 v1, s[52:55], s37 offen offset:0 sc1 lds
    buffer_load_dwordx4 v1, s[52:55], s37 offen offset:1024 sc1 lds
    buffer_load_dwordx4 v1, s[52:55], s37 offen offset:2048 sc1 lds
    s_add_u32 s37, s37, 12288
    s_cmp_ge_u32 s37, 393216
    s_cselect_b32 s47, 393216, 0
    s_sub_u32 s37, s37, s47
    s_add_u32 m0, s11, 64512
    s_nop 0
    buffer_load_dwordx4 v1, s[56:59], s36 offen offset:0 sc1 lds
    buffer_load_dwordx4 v1, s[56:59], s36 offen offset:1024 sc1 lds
    s_add_u32 s36, s36, 8192
    s_and_b32 s36, s36, 0x3ffff
    s_cmp_lg_u32 s5, 0
    s_cbranch_scc1 adaLN_cond__grouped_kv_mqa__mixer_gmlp__prompt_kernel_nd22_x
    s_cmp_eq_u32 s45, 0
    s_cbranch_scc1 adaLN_cond__grouped_kv_mqa__mixer_gmlp__prompt_kernel_nd22_x
    s_mov_b32 s38, 0
adaLN_cond__grouped_kv_mqa__mixer_gmlp__prompt_kernel_nd22:
    v_cmp_eq_u32 vcc, 0, v13
    s_add_u32 s38, s38, 1
    s_mov_b32 s45, vcc_lo
    s_cmp_eq_u32 s45, 0
    s_cbranch_scc1 adaLN_cond__grouped_kv_mqa__mixer_gmlp__prompt_kernel_nd22_x
    s_mov_b32 exec_lo, s45
    s_mov_b32 exec_hi, 0
    buffer_load_dword v13, v12, s[16:19], s39 offen sc1
    s_mov_b64 exec, -1
    s_and_b32 s47, s45, s46
    s_cbranch_scc0 adaLN_cond__grouped_kv_mqa__mixer_gmlp__prompt_kernel_nd22_ok
    s_waitcnt vmcnt(0)
    s_cmp_lt_u32 s38, 200000
    s_cbranch_scc1 adaLN_cond__grouped_kv_mqa__mixer_gmlp__prompt_kernel_nd22
adaLN_cond__grouped_kv_mqa__mixer_gmlp__prompt_kernel_nd22_ok:
    s_lshr_b32 s47, s46, 30
    s_lshl_b32 s46, s46, 2
    s_or_b32 s46, s46, s47
adaLN_cond__grouped_kv_mqa__mixer_gmlp__prompt_kernel_nd22_x:
    s_waitcnt vmcnt(8)
    s_barrier
    s_add_u32 m0, s11, 0
    s_nop 0
    buffer_load_dwordx4 v1, s[52:55], s37 offen offset:0 sc1 lds
    buffer_load_dwordx4 v1, s[52:55], s37 offen offset:1024 sc1 lds
    buffer_load_dwordx4 v1, s[52:55], s37 offen offset:2048 sc1 lds
    s_add_u32 s37, s37, 12288
    s_cmp_ge_u32 s37, 393216
    s_cselect_b32 s47, 393216, 0
    s_sub_u32 s37, s37, s47
    s_add_u32 m0, s11, 3072
    s_nop 0
    buffer_load_dwordx4 v1, s[56:59], s36 offen offset:0 sc1 lds
    buffer_load_dwordx4 v1, s[56:59], s36 offen offset:1024 sc1 lds
    s_add_u32 s36, s36, 8192
    s_and_b32 s36, s36, 0x3ffff
    s_waitcnt vmcnt(10)
    s_barrier
    s_add_u32 m0, s11, 20480
    s_nop 0
    buffer_load_dwordx4 v1, s[52:55], s37 offen offset:0 sc1 lds
    buffer_load_dwordx4 v1, s[52:55], s37 offen offset:1024 sc1 lds
    buffer_load_dwordx4 v1, s[52:55], s37 offen offset:2048 sc1 lds
    s_add_u32 s37, s37, 12288
    s_cmp_ge_u32 s37, 393216
    s_cselect_b32 s47, 393216, 0
    s_sub_u32 s37, s37, s47
    s_add_u32 m0, s11, 23552
    s_nop 0
    buffer_load_dwordx4 v1, s[56:59], s36 offen offset:0 sc1 lds
    buffer_load_dwordx4 v1, s[56:59], s36 offen offset:1024 sc1 lds
    s_add_u32 s36, s36, 8192
    s_and_b32 s36, s36, 0x3ffff
    s_cmp_lg_u32 s5, 0
    s_cbranch_scc1 adaLN_cond__grouped_kv_mqa__mixer_gmlp__prompt_kernel_nd23_x
    s_cmp_eq_u32 s45, 0
    s_cbranch_scc1 adaLN_cond__grouped_kv_mqa__mixer_gmlp__prompt_kernel_nd23_x
    s_mov_b32 s38, 0
adaLN_cond__grouped_kv_mqa__mixer_gmlp__prompt_kernel_nd23:
    v_cmp_eq_u32 vcc, 0, v13
    s_add_u32 s38, s38, 1
    s_mov_b32 s45, vcc_lo
    s_cmp_eq_u32 s45, 0
    s_cbranch_scc1 adaLN_cond__grouped_kv_mqa__mixer_gmlp__prompt_kernel_nd23_x
    s_mov_b32 exec_lo, s45
    s_mov_b32 exec_hi, 0
    buffer_load_dword v13, v12, s[16:19], s39 offen sc1
    s_mov_b64 exec, -1
    s_and_b32 s47, s45, s46
    s_cbranch_scc0 adaLN_cond__grouped_kv_mqa__mixer_gmlp__prompt_kernel_nd23_ok
    s_waitcnt vmcnt(0)
    s_cmp_lt_u32 s38, 200000
    s_cbranch_scc1 adaLN_cond__grouped_kv_mqa__mixer_gmlp__prompt_kernel_nd23
adaLN_cond__grouped_kv_mqa__mixer_gmlp__prompt_kernel_nd23_ok:
    s_lshr_b32 s47, s46, 30
    s_lshl_b32 s46, s46, 2
    s_or_b32 s46, s46, s47
adaLN_cond__grouped_kv_mqa__mixer_gmlp__prompt_kernel_nd23_x:
    s_waitcnt vmcnt(10)
    s_barrier
    s_add_u32 m0, s11, 40960
    s_nop 0
    buffer_load_dwordx4 v1, s[52:55], s37 offen offset:0 sc1 lds
    buffer_load_dwordx4 v1, s[52:55], s37 offen offset:1024 sc1 lds
    buffer_load_dwordx4 v1, s[52:55], s37 offen offset:2048 sc1 lds
    s_add_u32 s37, s37, 12288
    s_cmp_ge_u32 s37, 393216
    s_cselect_b32 s47, 393216, 0
    s_sub_u32 s37, s37, s47
    s_add_u32 m0, s11, 44032
    s_nop 0
    buffer_load_dwordx4 v1, s[56:59], s36 offen offset:0 sc1 lds
    buffer_load_dwordx4 v1, s[56:59], s36 offen offset:1024 sc1 lds
    s_add_u32 s36, s36, 8192
    s_and_b32 s36, s36, 0x3ffff
    s_mov_b32 s42, 0
.p2align 6
k5_lloop:
    s_waitcnt vmcnt(10)
    s_barrier
    s_add_u32 m0, s11, 61440
    s_nop 0
    buffer_load_dwordx4 v1, s[52:55], s37 offen offset:0 sc1 lds
    buffer_load_dwordx4 v1, s[52:55], s37 offen offset:1024 sc1 lds
    buffer_load_dwordx4 v1, s[52:55], s37 offen offset:2048 sc1 lds
    s_add_u32 s37, s37, 12288
    s_cmp_ge_u32 s37, 393216
    s_cselect_b32 s47, 393216, 0
    s_sub_u32 s37, s37, s47
    s_add_u32 m0, s11, 64512
    s_nop 0
    buffer_load_dwordx4 v1, s[56:59], s36 offen offset:0 sc1 lds
    buffer_load_dwordx4 v1, s[56:59], s36 offen offset:1024 sc1 lds
    s_add_u32 s36, s36, 8192
    s_and_b32 s36, s36, 0x3ffff
    s_cmp_lg_u32 s5, 0
    s_cbranch_scc1 adaLN_cond__grouped_kv_mqa__mixer_gmlp__prompt_kernel_nd24_x
    s_cmp_eq_u32 s45, 0
    s_cbranch_scc1 adaLN_cond__grouped_kv_mqa__mixer_gmlp__prompt_kernel_nd24_x
    s_mov_b32 s38, 0
adaLN_cond__grouped_kv_mqa__mixer_gmlp__prompt_kernel_nd24:
    v_cmp_eq_u32 vcc, 0, v13
    s_add_u32 s38, s38, 1
    s_mov_b32 s45, vcc_lo
    s_cmp_eq_u32 s45, 0
    s_cbranch_scc1 adaLN_cond__grouped_kv_mqa__mixer_gmlp__prompt_kernel_nd24_x
    s_mov_b32 exec_lo, s45
    s_mov_b32 exec_hi, 0
    buffer_load_dword v13, v12, s[16:19], s39 offen sc1
    s_mov_b64 exec, -1
    s_and_b32 s47, s45, s46
    s_cbranch_scc0 adaLN_cond__grouped_kv_mqa__mixer_gmlp__prompt_kernel_nd24_ok
    s_waitcnt vmcnt(0)
    s_cmp_lt_u32 s38, 200000
    s_cbranch_scc1 adaLN_cond__grouped_kv_mqa__mixer_gmlp__prompt_kernel_nd24
adaLN_cond__grouped_kv_mqa__mixer_gmlp__prompt_kernel_nd24_ok:
    s_lshr_b32 s47, s46, 30
    s_lshl_b32 s46, s46, 2
    s_or_b32 s46, s46, s47
adaLN_cond__grouped_kv_mqa__mixer_gmlp__prompt_kernel_nd24_x:
    s_waitcnt vmcnt(10)
    s_barrier
    s_add_u32 m0, s11, 0
    s_nop 0
    buffer_load_dwordx4 v1, s[52:55], s37 offen offset:0 sc1 lds
    buffer_load_dwordx4 v1, s[52:55], s37 offen offset:1024 sc1 lds
    buffer_load_dwordx4 v1, s[52:55], s37 offen offset:2048 sc1 lds
    s_add_u32 s37, s37, 12288
    s_cmp_ge_u32 s37, 393216
    s_cselect_b32 s47, 393216, 0
    s_sub_u32 s37, s37, s47
    s_add_u32 m0, s11, 3072
    s_nop 0
    buffer_load_dwordx4 v1, s[56:59], s36 offen offset:0 sc1 lds
    buffer_load_dwordx4 v1, s[56:59], s36 offen offset:1024 sc1 lds
    s_add_u32 s36, s36, 8192
    s_and_b32 s36, s36, 0x3ffff
    s_waitcnt vmcnt(10)
    s_barrier
    s_add_u32 m0, s11, 20480
    s_nop 0
    buffer_load_dwordx4 v1, s[52:55], s37 offen offset:0 sc1 lds
    buffer_load_dwordx4 v1, s[52:55], s37 offen offset:1024 sc1 lds
    buffer_load_dwordx4 v1, s[52:55], s37 offen offset:2048 sc1 lds
    s_add_u32 s37, s37, 12288
    s_cmp_ge_u32 s37, 393216
    s_cselect_b32 s47, 393216, 0
    s_sub_u32 s37, s37, s47
    s_add_u32 m0, s11, 23552
    s_nop 0
    buffer_load_dwordx4 v1, s[56:59], s36 offen offset:0 sc1 lds
    buffer_load_dwordx4 v1, s[56:59], s36 offen offset:1024 sc1 lds
    s_add_u32 s36, s36, 8192
    s_and_b32 s36, s36, 0x3ffff
    s_cmp_lg_u32 s5, 0
    s_cbranch_scc1 adaLN_cond__grouped_kv_mqa__mixer_gmlp__prompt_kernel_nd25_x
    s_cmp_eq_u32 s45, 0
    s_cbranch_scc1 adaLN_cond__grouped_kv_mqa__mixer_gmlp__prompt_kernel_nd25_x
    s_mov_b32 s38, 0
adaLN_cond__grouped_kv_mqa__mixer_gmlp__prompt_kernel_nd25:
    v_cmp_eq_u32 vcc, 0, v13
    s_add_u32 s38, s38, 1
    s_mov_b32 s45, vcc_lo
    s_cmp_eq_u32 s45, 0
    s_cbranch_scc1 adaLN_cond__grouped_kv_mqa__mixer_gmlp__prompt_kernel_nd25_x
    s_mov_b32 exec_lo, s45
    s_mov_b32 exec_hi, 0
    buffer_load_dword v13, v12, s[16:19], s39 offen sc1
    s_mov_b64 exec, -1
    s_and_b32 s47, s45, s46
    s_cbranch_scc0 adaLN_cond__grouped_kv_mqa__mixer_gmlp__prompt_kernel_nd25_ok
    s_waitcnt vmcnt(0)
    s_cmp_lt_u32 s38, 200000
    s_cbranch_scc1 adaLN_cond__grouped_kv_mqa__mixer_gmlp__prompt_kernel_nd25
adaLN_cond__grouped_kv_mqa__mixer_gmlp__prompt_kernel_nd25_ok:
    s_lshr_b32 s47, s46, 30
    s_lshl_b32 s46, s46, 2
    s_or_b32 s46, s46, s47
adaLN_cond__grouped_kv_mqa__mixer_gmlp__prompt_kernel_nd25_x:
    s_waitcnt vmcnt(10)
    s_barrier
    s_add_u32 m0, s11, 40960
    s_nop 0
    buffer_load_dwordx4 v1, s[52:55], s37 offen offset:0 sc1 lds
    buffer_load_dwordx4 v1, s[52:55], s37 offen offset:1024 sc1 lds
    buffer_load_dwordx4 v1, s[52:55], s37 offen offset:2048 sc1 lds
    s_add_u32 s37, s37, 12288
    s_cmp_ge_u32 s37, 393216
    s_cselect_b32 s47, 393216, 0
    s_sub_u32 s37, s37, s47
    s_add_u32 m0, s11, 44032
    s_nop 0
    buffer_load_dwordx4 v1, s[56:59], s36 offen offset:0 sc1 lds
    buffer_load_dwordx4 v1, s[56:59], s36 offen offset:1024 sc1 lds
    s_add_u32 s36, s36, 8192
    s_and_b32 s36, s36, 0x3ffff
    s_cmp_lg_u32 s42, 3
    s_cbranch_scc1 k5_noy
    s_add_u32 s64, s8, 0x11c0000
    s_addc_u32 s65, s9, 0
    s_mov_b32 s66, 0x300000
    s_mov_b32 s67, 0x20000
    s_mul_i32 s48, s3, 98304
    s_mul_i32 s49, s4, 12288
    s_add_u32 s48, s48, s49
    s_mul_i32 s49, s5, 3072
    s_add_u32 s48, s48, s49
    v_lshrrev_b32 v10, 4, v1
    v_min_u32 v10, 23, v10
    v_lshlrev_b32 v10, 7, v10
    buffer_load_dword v11, v10, s[64:67], s48 offen sc1
k5_noy:
    s_add_u32 s42, s42, 1
    s_cmp_lt_u32 s42, 6
    s_cbranch_scc1 k5_lloop
    s_waitcnt vmcnt(10)
    s_barrier
    s_add_u32 m0, s11, 61440
    s_nop 0
    buffer_load_dwordx4 v1, s[52:55], s37 offen offset:0 sc1 lds
    buffer_load_dwordx4 v1, s[52:55], s37 offen offset:1024 sc1 lds
    buffer_load_dwordx4 v1, s[52:55], s37 offen offset:2048 sc1 lds
    s_add_u32 s37, s37, 12288
    s_cmp_ge_u32 s37, 393216
    s_cselect_b32 s47, 393216, 0
    s_sub_u32 s37, s37, s47
    s_add_u32 m0, s11, 64512
    s_nop 0
    buffer_load_dwordx4 v1, s[56:59], s36 offen offset:0 sc1 lds
    buffer_load_dwordx4 v1, s[56:59], s36 offen offset:1024 sc1 lds
    s_add_u32 s36, s36, 8192
    s_and_b32 s36, s36, 0x3ffff
    s_waitcnt vmcnt(10)
    s_barrier
    s_add_u32 m0, s10, 0
    s_nop 0
    buffer_load_dwordx4 v1, s[60:63], m0 offen sc1 lds
    s_add_u32 m0, m0, 4096
    s_nop 0
    buffer_load_dwordx4 v1, s[60:63], m0 offen sc1 lds
    s_add_u32 m0, m0, 4096
    s_nop 0
    buffer_load_dwordx4 v1, s[60:63], m0 offen sc1 lds
    s_add_u32 m0, m0, 4096
    s_nop 0
    buffer_load_dwordx4 v1, s[60:63], m0 offen sc1 lds
    s_add_u32 m0, m0, 4096
    s_nop 0
    buffer_load_dwordx4 v1, s[60:63], m0 offen sc1 lds
    s_waitcnt vmcnt(10)
    s_barrier
    s_add_u32 m0, s10, 20480
    s_nop 0
    buffer_load_dwordx4 v1, s[60:63], m0 offen sc1 lds
    s_add_u32 m0, m0, 4096
    s_nop 0
    buffer_load_dwordx4 v1, s[60:63], m0 offen sc1 lds
    s_add_u32 m0, m0, 4096
    s_nop 0
    buffer_load_dwordx4 v1, s[60:63], m0 offen sc1 lds
    s_add_u32 m0, m0, 4096
    s_nop 0
    buffer_load_dwordx4 v1, s[60:63], m0 offen sc1 lds
    s_add_u32 m0, m0, 4096
    s_nop 0
    buffer_load_dwordx4 v1, s[60:63], m0 offen sc1 lds
    s_waitcnt vmcnt(10)
    s_barrier
    s_waitcnt vmcnt(0)
    s_barrier
    s_endpgm
k2_loader:
    s_add_u32 s56, s8, 0x4000
    s_addc_u32 s57, s9, 0
    s_mov_b32 s58, 0x3000
    s_mov_b32 s59, 0x20000
    s_lshl_b32 s10, s26, 10
    s_waitcnt vmcnt(0) lgkmcnt(0)
    s_barrier
    s_barrier
    s_add_u32 m0, s10, 143360
    s_nop 0
    buffer_load_dwordx4 v1, s[72:75], m0 offen sc1 lds
    s_add_u32 m0, m0, 4096
    s_nop 0
    buffer_load_dwordx4 v1, s[72:75], m0 offen sc1 lds
    s_add_u32 m0, m0, 4096
    s_nop 0
    buffer_load_dwordx4 v1, s[72:75], m0 offen sc1 lds
    s_add_u32 m0, m0, 4096
    s_nop 0
    buffer_load_dwordx4 v1, s[72:75], m0 offen sc1 lds
    s_add_u32 m0, m0, 4096
    s_nop 0
    buffer_load_dwordx4 v1, s[72:75], m0 offen sc1 lds
    s_barrier
    s_add_u32 m0, s10, 40960
    s_nop 0
    buffer_load_dwordx4 v1, s[72:75], m0 offen sc1 lds
    s_add_u32 m0, m0, 4096
    s_nop 0
    buffer_load_dwordx4 v1, s[72:75], m0 offen sc1 lds
    s_add_u32 m0, m0, 4096
    s_nop 0
    buffer_load_dwordx4 v1, s[72:75], m0 offen sc1 lds
    s_add_u32 m0, m0, 4096
    s_nop 0
    buffer_load_dwordx4 v1, s[72:75], m0 offen sc1 lds
    s_add_u32 m0, m0, 4096
    s_nop 0
    buffer_load_dwordx4 v1, s[72:75], m0 offen sc1 lds
    s_add_u32 m0, m0, 4096
    s_nop 0
    buffer_load_dwordx4 v1, s[72:75], m0 offen sc1 lds
    s_add_u32 m0, m0, 4096
    s_nop 0
    buffer_load_dwordx4 v1, s[72:75], m0 offen sc1 lds
    s_add_u32 m0, m0, 4096
    s_nop 0
    buffer_load_dwordx4 v1, s[72:75], m0 offen sc1 lds
    s_add_u32 m0, m0, 4096
    s_nop 0
    buffer_load_dwordx4 v1, s[72:75], m0 offen sc1 lds
    s_add_u32 m0, m0, 4096
    s_nop 0
    buffer_load_dwordx4 v1, s[72:75], m0 offen sc1 lds
    s_add_u32 m0, m0, 4096
    s_nop 0
    buffer_load_dwordx4 v1, s[72:75], m0 offen sc1 lds
    s_add_u32 m0, m0, 4096
    s_nop 0
    buffer_load_dwordx4 v1, s[72:75], m0 offen sc1 lds
    s_add_u32 m0, m0, 4096
    s_nop 0
    buffer_load_dwordx4 v1, s[72:75], m0 offen sc1 lds
    s_add_u32 m0, m0, 4096
    s_nop 0
    buffer_load_dwordx4 v1, s[72:75], m0 offen sc1 lds
    s_add_u32 m0, m0, 4096
    s_nop 0
    buffer_load_dwordx4 v1, s[72:75], m0 offen sc1 lds
    s_mul_i32 s11, s29, 384
    s_and_b32 s36, s5, 1
    s_mul_i32 s37, s36, 6144
    s_add_u32 s11, s11, s37
    s_lshl_b32 m0, s36, 10
    s_barrier
    buffer_load_dwordx4 v1, s[56:59], s11 offen sc1 lds
    s_waitcnt vmcnt(0)
    s_barrier
    s_barrier
    s_branch k5_loader
k2_end:
    s_endpgm
k2_blk5:
    s_lshl_b32 s37, s2, 2
    s_add_u32 s37, s37, 0
    s_waitcnt vmcnt(0)
    s_barrier
    s_cmp_lg_u32 s5, 0
    s_cbranch_scc1 k2_fsdone
    v_mov_b32 v172, 1
    s_mov_b64 exec, 1
    buffer_store_dword v172, off, s[16:19], s37 sc1
    s_mov_b64 exec, -1
k2_fsdone:
    s_cmp_ge_u32 s5, 4
    s_cbranch_scc1 k2_blk5b
    s_lshl_b32 m0, s26, 10
    s_add_u32 m0, m0, 0
    s_nop 0
    buffer_load_dwordx4 v1, s[32:35], m0 offen sc1 lds
    s_add_u32 m0, m0, 4096
    s_nop 0
    buffer_load_dwordx4 v1, s[32:35], m0 offen sc1 lds
    s_add_u32 m0, m0, 4096
    s_nop 0
    buffer_load_dwordx4 v1, s[32:35], m0 offen sc1 lds
    s_add_u32 m0, m0, 4096
    s_nop 0
    buffer_load_dwordx4 v1, s[32:35], m0 offen sc1 lds
    s_add_u32 m0, m0, 4096
    s_nop 0
    buffer_load_dwordx4 v1, s[32:35], m0 offen sc1 lds
    s_add_u32 m0, m0, 4096
    s_nop 0
    buffer_load_dwordx4 v1, s[32:35], m0 offen sc1 lds
    s_add_u32 m0, m0, 4096
    s_nop 0
    buffer_load_dwordx4 v1, s[32:35], m0 offen sc1 lds
    s_add_u32 m0, m0, 4096
    s_nop 0
    buffer_load_dwordx4 v1, s[32:35], m0 offen sc1 lds
    s_add_u32 m0, m0, 4096
    s_nop 0
    buffer_load_dwordx4 v1, s[32:35], m0 offen sc1 lds
    s_add_u32 m0, m0, 4096
    s_nop 0
    buffer_load_dwordx4 v1, s[32:35], m0 offen sc1 lds
    s_add_u32 m0, m0, 4096
    s_nop 0
    buffer_load_dwordx4 v1, s[32:35], m0 offen sc1 lds
    s_add_u32 m0, m0, 4096
    s_nop 0
    buffer_load_dwordx4 v1, s[32:35], m0 offen sc1 lds
    s_add_u32 m0, m0, 4096
    s_nop 0
    buffer_load_dwordx4 v1, s[32:35], m0 offen sc1 lds
    s_branch k2_loop
k2_blk5b:
    s_mov_b32 s68, s8
    s_mov_b32 s69, s9
    s_mov_b32 s70, 0x2300000
    s_mov_b32 s71, 0x20000
    v_lshrrev_b32 v176, 4, v1
    s_mul_i32 s54, s25, 10
    v_min_u32 v177, 19, v176
    v_lshrrev_b32 v178, 1, v177
    v_add_u32 v178, s54, v178
    v_and_b32 v177, 1, v177
    v_lshlrev_b32 v177, 7, v177
    v_and_b32 v179, 3, v178
    v_lshl_add_u32 v177, v179, 8, v177
    v_lshrrev_b32 v178, 2, v178
    v_lshl_add_u32 v177, v178, 12, v177
    s_mul_i32 s54, s24, 81920
    s_lshl_b32 s55, s26, 10
    s_add_u32 s54, s54, s55
    s_add_u32 s54, s54, 13369344
    buffer_load_dword v172, v177, s[68:71], s54 offen sc1
    s_mul_i32 s54, s26, 20
    v_min_u32 v178, 19, v176
    v_add_u32 v178, s54, v178
    v_and_b32 v179, 15, v178
    v_lshlrev_b32 v179, 7, v179
    v_lshrrev_b32 v178, 4, v178
    v_lshl_add_u32 v178, v178, 12, v179
    s_mul_i32 s54, s28, 40
    s_mul_i32 s55, s25, 5
    s_add_u32 s54, s54, s55
    s_lshl_b32 s54, s54, 1
    s_add_u32 s54, s54, s27
    s_lshl_b32 s54, s54, 11
    s_add_u32 s54, s54, 15990784
    buffer_load_dword v173, v178, s[68:71], s54 offen sc1
    s_lshl_b32 s54, s24, 3
    s_add_u32 s54, s54, s25
    s_lshl_b32 s54, s54, 2
    s_add_u32 s54, s54, s26
    s_lshl_b32 s54, s54, 7
    s_add_u32 s54, s54, 21757952
    buffer_load_dword v174, off, s[68:71], s54 sc1
    s_lshl_b32 s54, s28, 4
    s_add_u32 s54, s54, s29
    s_lshl_b32 s54, s54, 2
    s_add_u32 s54, s54, s26
    s_lshl_b32 s54, s54, 8
    s_add_u32 s54, s54, 65536
    buffer_load_dword v175, off, s[68:71], s54 sc1
    buffer_load_dword v175, off, s[68:71], s54 offset:128 sc1
    s_branch k2_loop
k2_blk6:
    s_add_u32 s68, s8, 0x350000
    s_addc_u32 s69, s9, 0
    s_mov_b32 s70, 0x1e0000
    s_mov_b32 s71, 0x20000
    s_mul_i32 s53, s53, 7680
    s_add_u32 s54, s53, 4096
    s_cmp_lt_u32 s5, 4
    s_cbranch_scc1 k2_blk6a
    s_lshl_b32 m0, s26, 10
    s_add_u32 m0, m0, 53248
    s_nop 0
    buffer_load_dwordx4 v1, s[32:35], m0 offen sc1 lds
    s_add_u32 m0, m0, 4096
    s_nop 0
    buffer_load_dwordx4 v1, s[32:35], m0 offen sc1 lds
    s_add_u32 m0, m0, 4096
    s_nop 0
    buffer_load_dwordx4 v1, s[32:35], m0 offen sc1 lds
    s_add_u32 m0, m0, 4096
    s_nop 0
    buffer_load_dwordx4 v1, s[32:35], m0 offen sc1 lds
    s_add_u32 m0, m0, 4096
    s_nop 0
    buffer_load_dwordx4 v1, s[32:35], m0 offen sc1 lds
    s_add_u32 m0, m0, 4096
    s_nop 0
    buffer_load_dwordx4 v1, s[32:35], m0 offen sc1 lds
    s_add_u32 m0, m0, 4096
    s_nop 0
    buffer_load_dwordx4 v1, s[32:35], m0 offen sc1 lds
    s_add_u32 m0, m0, 4096
    s_nop 0
    buffer_load_dwordx4 v1, s[32:35], m0 offen sc1 lds
    s_add_u32 m0, m0, 4096
    s_nop 0
    buffer_load_dwordx4 v1, s[32:35], m0 offen sc1 lds
    s_add_u32 m0, m0, 4096
    s_nop 0
    buffer_load_dwordx4 v1, s[32:35], m0 offen sc1 lds
    s_add_u32 m0, m0, 4096
    s_nop 0
    buffer_load_dwordx4 v1, s[32:35], m0 offen sc1 lds
    s_add_u32 m0, m0, 4096
    s_nop 0
    buffer_load_dwordx4 v1, s[32:35], m0 offen sc1 lds
    s_branch k2_loop
k2_blk6a:
    v_bfe_u32 v176, v0, 4, 2
    v_and_b32 v177, 15, v0
    s_lshl_b32 s59, s24, 2
    s_add_u32 s59, s59, s5
    v_mul_u32_u24 v178, 1280, v177
    v_lshl_add_u32 v178, v176, 3, v178
    s_mul_i32 s60, s59, 20480
    s_mul_i32 s61, s25, 160
    s_add_u32 s60, s60, s61
    v_lshlrev_b32 v179, 4, v176
    s_mul_i32 s38, s25, 320
    s_mov_b32 s52, s44
    s_mov_b32 s53, s45
    s_mov_b32 s54, 0x280000
    s_mov_b32 s55, 0x20000
    s_add_u32 s56, s8, 0x1400
    s_addc_u32 s57, s9, 0
    s_mov_b32 s58, 0xa00
    s_mov_b32 s59, 0x20000
    buffer_load_dwordx2 v[120:121], v178, s[52:55], s60 offen offset:0
    buffer_load_dwordx2 v[122:123], v178, s[52:55], s60 offen offset:32
    buffer_load_dwordx2 v[124:125], v178, s[52:55], s60 offen offset:64
    buffer_load_dwordx2 v[126:127], v178, s[52:55], s60 offen offset:96
    buffer_load_dwordx2 v[128:129], v178, s[52:55], s60 offen offset:128
    buffer_load_dwordx4 v[132:135], v179, s[56:59], s38 offen offset:0 sc1
    buffer_load_dwordx4 v[136:139], v179, s[56:59], s38 offen offset:64 sc1
    buffer_load_dwordx4 v[140:143], v179, s[56:59], s38 offen offset:128 sc1
    buffer_load_dwordx4 v[144:147], v179, s[56:59], s38 offen offset:192 sc1
    buffer_load_dwordx4 v[148:151], v179, s[56:59], s38 offen offset:256 sc1
    s_cmp_lg_u32 s5, 0
    s_cbranch_scc1 k2_loop
    s_movk_i32 s37, 0x0
    buffer_load_dwordx4 v[168:171], v1, s[16:19], s37 offen sc1
    s_branch k2_loop
k2_sideld:
    s_lshl_b32 s52, s2, 3
    s_add_u32 s52, s52, s5
    s_lshr_b32 s53, s2, 3
    s_lshl_b32 s53, s53, 3
    s_add_u32 s53, s53, s5
    s_mov_b32 s56, s48
    s_mov_b32 s57, s49
    s_mov_b32 s58, 0x1e0000
    s_mov_b32 s59, 0x20000
    s_add_u32 s64, s8, 0x1e00
    s_addc_u32 s65, s9, 0
    s_mov_b32 s66, 0x1400
    s_mov_b32 s67, 0x20000
    s_mul_i32 s62, s52, 1639
    s_lshr_b32 s62, s62, 16
    s_mul_i32 s63, s62, 40
    s_sub_u32 s63, s52, s63
    s_mul_i32 s68, s63, 49152
    s_lshl_b32 s69, s62, 6
    s_add_u32 s68, s68, s69
    s_cmp_lt_u32 s52, 1920
    s_cselect_b32 s70, 0, 0x40000000
    s_add_u32 s68, s68, s70
    v_mul_u32_u24 v15, 24576, v3
    v_lshl_add_u32 v15, v2, 1, v15
    buffer_load_ushort v136, v15, s[56:59], s68 offen
    s_add_u32 s68, s68, 3072
    buffer_load_ushort v137, v15, s[56:59], s68 offen
    s_add_u32 s68, s68, 3072
    buffer_load_ushort v138, v15, s[56:59], s68 offen
    s_add_u32 s68, s68, 3072
    buffer_load_ushort v139, v15, s[56:59], s68 offen
    s_add_u32 s68, s68, 3072
    buffer_load_ushort v140, v15, s[56:59], s68 offen
    s_add_u32 s68, s68, 3072
    buffer_load_ushort v141, v15, s[56:59], s68 offen
    s_add_u32 s68, s68, 3072
    buffer_load_ushort v142, v15, s[56:59], s68 offen
    s_add_u32 s68, s68, 3072
    buffer_load_ushort v143, v15, s[56:59], s68 offen
    s_lshl_b32 s68, s63, 6
    v_lshlrev_b32 v15, 5, v3
    buffer_load_dwordx4 v[144:147], v15, s[64:67], s68 offen sc1
    buffer_load_dwordx4 v[148:151], v15, s[64:67], s68 offen offset:16 sc1
    buffer_load_dwordx4 v[152:155], v15, s[64:67], s68 offen offset:2560 sc1
    buffer_load_dwordx4 v[156:159], v15, s[64:67], s68 offen offset:2576 sc1
    s_cmp_ge_u32 s62, 24
    s_cselect_b32 s68, 24, 0
    s_cselect_b32 s71, 0x310, 0
    s_cselect_b32 s72, 0, 0x542
    s_or_b32 s71, s71, s72
    s_sub_u32 s62, s62, s68
    s_mul_i32 s68, s62, 86
    s_lshr_b32 s68, s68, 8
    s_mul_i32 s69, s68, 3
    s_sub_u32 s69, s62, s69
    s_lshl_b32 s69, s69, 2
    s_lshr_b32 s71, s71, s69
    s_and_b32 s71, s71, 15
    s_mul_i32 s62, s68, 6
    s_add_u32 s62, s62, s71
    s_mul_i32 s68, s62, 86
    s_lshr_b32 s68, s68, 8
    s_mul_i32 s69, s68, 3
    s_sub_u32 s69, s62, s69
    s_mul_i32 s68, s68, 40
    s_add_u32 s68, s68, s63
    s_mul_i32 s68, s68, 3
    s_add_u32 s68, s68, s69
    s_lshl_b32 s68, s68, 10
    s_add_u32 s63, s68, s70
    s_lshl_b32 s62, s62, 7
    s_add_u32 s62, s62, s70
    s_mov_b32 s56, s46
    s_mov_b32 s57, s47
    s_mov_b32 s58, 0xf0000
    s_mov_b32 s59, 0x20000
    s_mul_i32 s69, s52, 2731
    s_lshr_b32 s69, s69, 16
    s_mul_i32 s73, s69, 24
    s_sub_u32 s68, s52, s73
    s_cmp_lt_u32 s52, 960
    s_cselect_b32 s70, 0, 0x40000000
    s_mul_i32 s73, s68, 40960
    s_lshl_b32 s74, s69, 5
    s_add_u32 s73, s73, s74
    s_add_u32 s73, s73, s70
    s_add_u32 s74, s73, 5120
    v_bfe_u32 v15, v0, 4, 2
    v_mul_u32_u24 v15, 10240, v15
    v_and_b32 v160, 15, v0
    v_lshl_add_u32 v15, v160, 1, v15
    buffer_load_ushort v160, v15, s[56:59], s73 offen offset:0
    buffer_load_ushort v161, v15, s[56:59], s73 offen offset:1280
    buffer_load_ushort v162, v15, s[56:59], s73 offen offset:2560
    buffer_load_ushort v163, v15, s[56:59], s73 offen offset:3840
    buffer_load_ushort v164, v15, s[56:59], s74 offen offset:0
    buffer_load_ushort v165, v15, s[56:59], s74 offen offset:1280
    buffer_load_ushort v166, v15, s[56:59], s74 offen offset:2560
    buffer_load_ushort v167, v15, s[56:59], s74 offen offset:3840
    s_mul_i32 s73, s69, 52
    s_lshr_b32 s73, s73, 8
    s_mul_i32 s74, s73, 5
    s_sub_u32 s74, s69, s74
    s_mul_i32 s73, s73, 24
    s_add_u32 s73, s73, s68
    s_mul_i32 s73, s73, 5
    s_add_u32 s73, s73, s74
    s_lshl_b32 s73, s73, 10
    s_add_u32 s60, s73, s70
    s_mov_b32 s56, s50
    s_mov_b32 s57, s51
    s_mov_b32 s58, 0x800000
    s_mov_b32 s59, 0x20000
    s_lshl_b32 s54, s3, 3
    s_lshr_b32 s55, s53, 5
    s_add_u32 s54, s54, s55
    s_and_b32 s55, s53, 31
    s_lshl_b32 s68, s54, 17
    s_lshl_b32 s69, s55, 7
    s_add_u32 s68, s68, s69
    s_lshr_b32 s61, s54, 1
    s_lshl_b32 s61, s61, 18
    s_lshl_b32 s69, s55, 13
    s_add_u32 s61, s61, s69
    s_and_b32 s69, s54, 1
    s_lshl_b32 s69, s69, 10
    s_add_u32 s61, s61, s69
    v_lshlrev_b32 v15, 12, v2
    v_lshl_add_u32 v15, v3, 4, v15
    buffer_load_dwordx4 v[120:123], v15, s[56:59], s68 offen offset:0
    buffer_load_dwordx4 v[124:127], v15, s[56:59], s68 offen offset:32
    buffer_load_dwordx4 v[128:131], v15, s[56:59], s68 offen offset:64
    buffer_load_dwordx4 v[132:135], v15, s[56:59], s68 offen offset:96
    s_branch k2_cont
k2_side:
    s_add_u32 s64, s8, 0x1b00000
    s_addc_u32 s65, s9, 0
    s_mov_b32 s66, 0x800000
    s_mov_b32 s67, 0x20000
    s_add_u32 s68, s8, 0x350000
    s_addc_u32 s69, s9, 0
    s_mov_b32 s70, 0x1e0000
    s_mov_b32 s71, 0x20000
    s_add_u32 s72, s8, 0x4000
    s_addc_u32 s73, s9, 0
    s_mov_b32 s74, 0x3000
    s_mov_b32 s75, 0x20000
    s_add_u32 s56, s8, 0x260000
    s_addc_u32 s57, s9, 0
    s_mov_b32 s58, 0xf0000
    s_mov_b32 s59, 0x20000
    s_add_u32 s54, s61, 4096
    s_waitcnt vmcnt(0)
    v_lshl_or_b32 v160, v161, 16, v160
    v_lshl_or_b32 v161, v163, 16, v162
    v_lshl_or_b32 v162, v165, 16, v164
    v_lshl_or_b32 v163, v167, 16, v166
    buffer_store_dwordx4 v[160:163], v1, s[56:59], s60 offen sc1
    v_lshlrev_b32 v136, 16, v136
    v_lshlrev_b32 v137, 16, v137
    v_lshlrev_b32 v138, 16, v138
    v_lshlrev_b32 v139, 16, v139
    v_lshlrev_b32 v140, 16, v140
    v_lshlrev_b32 v141, 16, v141
    v_lshlrev_b32 v142, 16, v142
    v_lshlrev_b32 v143, 16, v143
    v_mul_f32 v165, v136, v144
    v_fmac_f32 v165, v137, v145
    v_fmac_f32 v165, v138, v146
    v_fmac_f32 v165, v139, v147
    v_fmac_f32 v165, v140, v148
    v_fmac_f32 v165, v141, v149
    v_fmac_f32 v165, v142, v150
    v_fmac_f32 v165, v143, v151
    v_mul_f32 v136, v136, v152
    v_mul_f32 v137, v137, v153
    v_mul_f32 v138, v138, v154
    v_mul_f32 v139, v139, v155
    v_mul_f32 v140, v140, v156
    v_mul_f32 v141, v141, v157
    v_mul_f32 v142, v142, v158
    v_mul_f32 v143, v143, v159
    v_cvt_pk_bf16_f32 v144, v136, v137
    v_cvt_pk_bf16_f32 v145, v138, v139
    v_cvt_pk_bf16_f32 v146, v140, v141
    v_cvt_pk_bf16_f32 v147, v142, v143
    buffer_store_dwordx4 v[144:147], v1, s[68:71], s63 offen sc1
    v_lshlrev_b32 v136, 16, v144
    v_and_b32 v137, 0xffff0000, v144
    v_lshlrev_b32 v138, 16, v145
    v_and_b32 v139, 0xffff0000, v145
    v_lshlrev_b32 v140, 16, v146
    v_and_b32 v141, 0xffff0000, v146
    v_lshlrev_b32 v142, 16, v147
    v_and_b32 v143, 0xffff0000, v147
    v_add_f32 v136, v136, v137
    v_add_f32 v138, v138, v139
    v_add_f32 v140, v140, v141
    v_add_f32 v142, v142, v143
    v_add_f32 v136, v136, v138
    v_add_f32 v140, v140, v142
    v_add_f32 v164, v136, v140
    v_mul_u32_u24 v166, 6144, v3
    v_lshl_add_u32 v166, v2, 2, v166
    v_permlane32_swap_b32 v164, v165
    v_add_f32 v164, v164, v165
    buffer_atomic_add_f32 v164, v166, s[72:75], s62 offen
    buffer_store_dwordx4 v[120:123], v1, s[64:67], s61 offen offset:0 sc1
    buffer_store_dwordx4 v[124:127], v1, s[64:67], s61 offen offset:2048 sc1
    buffer_store_dwordx4 v[128:131], v1, s[64:67], s54 offen offset:0 sc1
    buffer_store_dwordx4 v[132:135], v1, s[64:67], s54 offen offset:2048 sc1
    s_branch k2_cont
k2_slow:
    v_subrev_u32 v13, 143360, v13
    v_subrev_u32 v14, 143360, v14
    v_mov_b32 v48, 0xff800000
    s_mov_b32 s42, 0
k2_slow1:
    buffer_load_dwordx4 v[88:91], v1, s[20:23], s42 offen sc1
    buffer_load_dwordx2 v[96:97], v13, s[20:23], s42 offen sc1
    s_waitcnt vmcnt(0)
    v_mfma_f32_32x32x16_bf16 v[32:47], v[88:91], v[4:7], 0
    v_mfma_f32_32x32x16_bf16 v[32:47], v[96:99], v[8:11], v[32:47]
    s_nop 11
    v_max3_f32 v48, v48, v32, v33
    v_max3_f32 v48, v48, v34, v35
    v_max3_f32 v48, v48, v36, v37
    v_max3_f32 v48, v48, v38, v39
    v_max3_f32 v48, v48, v40, v41
    v_max3_f32 v48, v48, v42, v43
    v_max3_f32 v48, v48, v44, v45
    v_max3_f32 v48, v48, v46, v47
    s_add_u32 s42, s42, 2560
    s_cmp_lt_u32 s42, 163840
    s_cbranch_scc1 k2_slow1
    v_mov_b32 v49, v48
    s_mov_b32 s42, 0
    s_nop 0
    v_permlane32_swap_b32 v48, v49
    v_max_f32 v48, v48, v49
    v_sub_f32 v16, 0, v48
    v_sub_f32 v17, 0, v48
    v_sub_f32 v18, 0, v48
    v_sub_f32 v19, 0, v48
    v_sub_f32 v20, 0, v48
    v_sub_f32 v21, 0, v48
    v_sub_f32 v22, 0, v48
    v_sub_f32 v23, 0, v48
    v_sub_f32 v24, 0, v48
    v_sub_f32 v25, 0, v48
    v_sub_f32 v26, 0, v48
    v_sub_f32 v27, 0, v48
    v_sub_f32 v28, 0, v48
    v_sub_f32 v29, 0, v48
    v_sub_f32 v30, 0, v48
    v_sub_f32 v31, 0, v48
    v_mov_b32 v64, 0
    v_mov_b32 v65, 0
    v_mov_b32 v66, 0
    v_mov_b32 v67, 0
    v_mov_b32 v68, 0
    v_mov_b32 v69, 0
    v_mov_b32 v70, 0
    v_mov_b32 v71, 0
    v_mov_b32 v72, 0
    v_mov_b32 v73, 0
    v_mov_b32 v74, 0
    v_mov_b32 v75, 0
    v_mov_b32 v76, 0
    v_mov_b32 v77, 0
    v_mov_b32 v78, 0
    v_mov_b32 v79, 0
k2_slow2:
    buffer_load_dwordx4 v[88:91], v1, s[20:23], s42 offen sc1
    buffer_load_dwordx2 v[96:97], v13, s[20:23], s42 offen sc1
    s_mov_b64 exec, s[40:41]
    buffer_load_dwordx4 v[104:107], v14, s[20:23], s42 offen sc1
    buffer_load_dwordx4 v[108:111], v14, s[20:23], s42 offen offset:640 sc1
    s_mov_b64 exec, -1
    s_waitcnt vmcnt(0)
    v_mfma_f32_32x32x16_bf16 v[32:47], v[88:91], v[4:7], v[16:31]
    v_mfma_f32_32x32x16_bf16 v[32:47], v[96:99], v[8:11], v[32:47]
    s_nop 11
    v_exp_f32 v32, v32
    v_exp_f32 v33, v33
    v_exp_f32 v34, v34
    v_exp_f32 v35, v35
    v_exp_f32 v36, v36
    v_exp_f32 v37, v37
    v_exp_f32 v38, v38
    v_exp_f32 v39, v39
    v_exp_f32 v40, v40
    v_exp_f32 v41, v41
    v_exp_f32 v42, v42
    v_exp_f32 v43, v43
    v_exp_f32 v44, v44
    v_exp_f32 v45, v45
    v_exp_f32 v46, v46
    v_exp_f32 v47, v47
    s_nop 0
    v_cvt_pk_bf16_f32 v80, v32, v33
    v_cvt_pk_bf16_f32 v81, v34, v35
    v_cvt_pk_bf16_f32 v82, v36, v37
    v_cvt_pk_bf16_f32 v83, v38, v39
    v_cvt_pk_bf16_f32 v84, v40, v41
    v_cvt_pk_bf16_f32 v85, v42, v43
    v_cvt_pk_bf16_f32 v86, v44, v45
    v_cvt_pk_bf16_f32 v87, v46, v47
    s_nop 1
    v_mfma_f32_32x32x16_bf16 v[64:79], v[104:107], v[80:83], v[64:79]
    v_mfma_f32_32x32x16_bf16 v[64:79], v[108:111], v[84:87], v[64:79]
    s_add_u32 s42, s42, 2560
    s_cmp_lt_u32 s42, 163840
    s_cbranch_scc1 k2_slow2
    s_nop 11
    s_branch k2_epi
.p2align 8
code_end:
    s_endpgm
.section .rodata,"a"
.p2align 6
.amdhsa_kernel adaLN_cond__grouped_kv_mqa__mixer_gmlp__prompt_kernel
  .amdhsa_next_free_vgpr 244
  .amdhsa_next_free_sgpr 100
  .amdhsa_accum_offset 244
  .amdhsa_group_segment_fixed_size 0
  .amdhsa_kernarg_size 120
  .amdhsa_user_sgpr_count 2
  .amdhsa_user_sgpr_kernarg_segment_ptr 1
  .amdhsa_system_sgpr_workgroup_id_x 1
.end_amdhsa_kernel
```
